```python
import torch

def _softmax(x, axis=-1):
    return torch.softmax(x, dim=axis)

def _gelu(x):
    return torch.nn.functional.gelu(x, approximate='tanh')

def _silu(x):
    return torch.nn.functional.silu(x)

def _sigmoid(x):
    return torch.sigmoid(x)

def _layernorm(x, axis=-1, eps=1e-05):
    m = x.mean(dim=axis, keepdim=True)
    v = x.var(dim=axis, keepdim=True, unbiased=False)
    return (x - m) / torch.sqrt(v + eps)

def _scatter_add(tgt, idx, src, axis=0):
    return tgt.clone().index_add_(axis, idx, src)

def _segment_sum(src, seg, n):
    out = torch.zeros((n,) + src.shape[1:], dtype=src.dtype)
    return out.index_add_(0, seg, src)

def _pad(x, pw):
    flat = tuple((v for pair in reversed(pw) for v in pair))
    return torch.nn.functional.pad(x, flat)
kernel_name = 'adaLN_cond__linear_kernel_hedgehog__glu_gated_geglu__prompt'

def setup_inputs():

    _w = lambda a: (lambda t: t.to(torch.bfloat16) if t.is_floating_point() else t)(torch.as_tensor(a))

    def _A_setup():
        B, S, D, H = (1, 2048, 512, 32)
        Dh = D // H
        return {'x': _w((lambda *s: torch.randn(*s, dtype=torch.bfloat16) * 0.1)(B, S, D)), 'wqkv': _w((lambda *s: torch.randn(*s, dtype=torch.bfloat16) * 0.2)(D, 3 * D)), 'w_phi': _w((lambda *s: torch.randn(*s, dtype=torch.bfloat16) * 0.2)(H, Dh, Dh) * Dh ** (-0.5)), 'wo': _w((lambda *s: torch.randn(*s, dtype=torch.bfloat16) * 0.2)(D, D))}
    _A_in = _A_setup()

    def _B_setup():
        B, S, Dm, Df = (1, 2048, 512, 1376)
        return {'x': _w((lambda *s: torch.randn(*s, dtype=torch.bfloat16) * 0.1)(B, S, Dm)), 'w_gate': _w((lambda *s: torch.randn(*s, dtype=torch.bfloat16) * 3.2)(Dm, Df) * Dm ** (-0.5)), 'w_up': _w((lambda *s: torch.randn(*s, dtype=torch.bfloat16) * 3.2)(Dm, Df) * Dm ** (-0.5)), 'w_down': _w((lambda *s: torch.randn(*s, dtype=torch.bfloat16) * 3.2)(Df, Dm) * Df ** (-0.5))}
    _B_in = _B_setup()
    return {'A_x': _A_in['x'], 'A_wqkv': _A_in['wqkv'], 'A_w_phi': _A_in['w_phi'], 'A_wo': _A_in['wo'], 'B_x': _B_in['x'], 'B_w_gate': _B_in['w_gate'], 'B_w_up': _B_in['w_up'], 'B_w_down': _B_in['w_down'], 'c': _w((lambda *s: torch.randn(*s, dtype=torch.bfloat16) * 0.4)(1, 512) * 8.0), 'w_mod': _w((lambda *s: torch.randn(*s, dtype=torch.bfloat16) * 0.4)(512, 6 * 512) * 512 ** (-0.5) * 8.0)}

def reference(A_x, A_wqkv, A_w_phi, A_wo, B_x, B_w_gate, B_w_up, B_w_down, c, w_mod):

    def _A_ref(x, wqkv, w_phi, wo):
        B, S, D = x.shape
        H = 32
        Dh = D // H
        qkv = (lambda x, *d: x.permute(*d))((x @ wqkv).reshape(B, S, 3, H, Dh), 2, 0, 3, 1, 4)
        q, k, v = (qkv[0], qkv[1], qkv[2])
        pq = torch.einsum('bhsd,hdf->bhsf', q, w_phi)
        pk = torch.einsum('bhsd,hdf->bhsf', k, w_phi)
        phi_q = torch.concatenate([_softmax(pq, axis=-1), _softmax(-pq, axis=-1)], axis=-1)
        phi_k = torch.concatenate([_softmax(pk, axis=-1), _softmax(-pk, axis=-1)], axis=-1)
        kv = torch.einsum('bhsf,bhsd->bhfd', phi_k, v)
        z = torch.einsum('bhsf->bhf', phi_k)
        num = torch.einsum('bhqf,bhfd->bhqd', phi_q, kv)
        den = torch.einsum('bhqf,bhf->bhq', phi_q, z)[..., None] + 1e-06
        o = num / den
        return (lambda x, *d: x.permute(*d))(o, 0, 2, 1, 3).reshape(B, S, D) @ wo

    def _B_ref(x, w_gate, w_up, w_down):
        g = torch.einsum('bsd,df->bsf', x, w_gate)
        u = torch.einsum('bsd,df->bsf', x, w_up)
        h = _gelu(g) * u
        return torch.einsum('bsf,fd->bsd', h, w_down)
    x = A_x
    mod = (_silu(c) @ w_mod).reshape(c.shape[0], 6, 1, -1)
    sa, ca, ga, sb, cb, gb = (mod[:, 0].clone(), mod[:, 1].clone(), mod[:, 2].clone(), mod[:, 3].clone(), mod[:, 4].clone(), mod[:, 5].clone())
    h = _layernorm(x, axis=-1) * (1 + ca) + sa
    x = x + ga * _A_ref(h, A_wqkv, A_w_phi, A_wo)
    h = _layernorm(x, axis=-1) * (1 + cb) + sb
    x = x + gb * _B_ref(h, B_w_gate, B_w_up, B_w_down)
    return x
```

```asm
; @launch kernel=mk_kernel grid=(256,1,1) block=(256,1,1) lds=163840
.amdgcn_target "amdgcn-amd-amdhsa--gfx950"
.text
.globl mk_kernel
.p2align 8
.type mk_kernel,@function
mk_kernel:
    s_cmp_ge_u32 s2, 256
    s_cbranch_scc1 MK_END
    s_load_dwordx2 s[4:5], s[0:1], 96
    s_load_dwordx2 s[8:9], s[0:1], 0
    s_load_dwordx2 s[10:11], s[0:1], 8
    s_load_dwordx2 s[12:13], s[0:1], 64
    s_load_dwordx2 s[14:15], s[0:1], 72
    s_load_dwordx2 s[16:17], s[0:1], 88
    s_load_dwordx2 s[18:19], s[0:1], 16
    v_lshrrev_b32 v1, 6, v0
    s_nop 0
    v_readfirstlane_b32 s3, v1
    s_getreg_b32 s71, hwreg(HW_REG_XCC_ID)
    s_and_b32 s71, s71, 15
    s_add_u32 s71, s71, 1
    s_getpc_b64 s[64:65]
CP_PC:
    s_sub_u32 s64, s64, CP_PC-mk_kernel
    s_subb_u32 s65, s65, 0
    s_and_b32 s65, s65, 0xffff
    s_mov_b32 s66, MK_END-mk_kernel
    s_mov_b32 s67, 0x00020000
    s_lshr_b32 s48, s2, 3
    s_lshl_b32 s48, s48, 2
    s_add_u32 s48, s48, s3
    s_lshl_b32 s48, s48, 9
    v_and_b32 v12, 63, v0
    v_lshlrev_b32 v12, 6, v12
    s_mov_b64 exec, 0xff
    buffer_load_dword v63, v12, s[64:67], s48 offen
    s_mov_b64 exec, -1
    s_and_b32 s48, s2, 7
    s_lshr_b32 s49, s2, 3
    s_lshl_b32 s6, s48, 2
    s_lshr_b32 s50, s49, 3
    s_add_u32 s6, s6, s50
    s_and_b32 s7, s49, 7
    s_lshl_b32 s45, s50, 2
    v_and_b32 v1, 63, v0
    v_lshrrev_b32 v2, 4, v1
    v_bfe_u32 v3, v1, 2, 2
    v_and_b32 v4, 3, v1
    v_and_b32 v5, 15, v1
    v_lshlrev_b32 v8, 4, v1
    v_lshrrev_b32 v9, 3, v1
    v_and_b32 v10, 7, v1
    v_and_b32 v11, 3, v9
    v_mul_u32_u24 v9, 3072, v9
    v_xor_b32 v12, 1, v11
    v_lshlrev_b32 v12, 1, v12
    v_xor_b32 v12, v12, v10
    v_lshl_add_u32 v6, v12, 4, v9
    s_and_b32 s51, s3, 1
    v_xor_b32 v12, s51, v11
    v_lshlrev_b32 v12, 1, v12
    v_xor_b32 v12, v12, v10
    v_lshl_add_u32 v9, v12, 4, v9
    s_and_b32 s46, s2, 3
    s_lshr_b32 s47, s2, 2
    v_and_b32 v10, 7, v0
    v_lshrrev_b32 v11, 3, v0
    v_mul_u32_u24 v12, 6144, v11
    v_lshl_add_u32 v12, v10, 4, v12
    v_lshlrev_b32 v13, 1, v11
    s_mul_i32 s52, s46, 128*6144
    s_lshl_b32 s53, s47, 7
    s_add_u32 s52, s52, s53
    s_mov_b32 s68, s52
    v_mov_b32 v60, v12
    s_mul_i32 s69, s46, 3072*4
    s_lshl_b32 s53, s47, 8
    s_add_u32 s69, s69, s53
    s_lshl_b32 s53, s46, 8
    s_lshl_b32 s54, s6, 6
    s_lshl_b32 s55, s3, 4
    s_add_u32 s54, s54, s55
    s_lshl_b32 s55, s7, 1
    s_add_u32 s54, s54, s55
    s_lshl_b32 s54, s54, 10
    s_mul_i32 s48, s3, 8*3072
    s_lshl_b32 s49, s7, 7
    s_add_u32 s48, s48, s49
    s_lshl_b32 s49, s3, 10
    s_xor_b32 s55, s50, 0
    s_mul_i32 s56, s55, 196608
    s_add_u32 s56, s56, s48
    s_lshl_b32 s55, s55, 14
    s_add_u32 s60, s55, s49
    s_xor_b32 s55, s50, 1
    s_mul_i32 s57, s55, 196608
    s_add_u32 s57, s57, s48
    s_lshl_b32 s55, s55, 14
    s_add_u32 s61, s55, s49
    s_xor_b32 s55, s50, 2
    s_mul_i32 s58, s55, 196608
    s_add_u32 s58, s58, s48
    s_lshl_b32 s55, s55, 14
    s_add_u32 s62, s55, s49
    s_xor_b32 s55, s50, 3
    s_mul_i32 s59, s55, 196608
    s_add_u32 s59, s59, s48
    s_lshl_b32 s55, s55, 14
    s_add_u32 s63, s55, s49
    s_lshl_b32 s51, s7, 7
    s_add_u32 s51, s51, 74752
    s_waitcnt lgkmcnt(0)
    s_mov_b32 s32, s14
    s_mov_b32 s33, s15
    s_and_b32 s33, s33, 0xffff
    s_mov_b32 s34, 0x300000
    s_mov_b32 s35, 0x00020000
    s_mov_b32 s28, s12
    s_mov_b32 s29, s13
    s_and_b32 s29, s29, 0xffff
    s_mov_b32 s30, 0x400
    s_mov_b32 s31, 0x00020000
    s_cmp_ge_u32 s2, 192
    s_cbranch_scc1 F_L1
    buffer_load_ushort v52, v13, s[28:31], s53 offen offset:0
    buffer_load_ushort v53, v13, s[28:31], s53 offen offset:64
    buffer_load_ushort v54, v13, s[28:31], s53 offen offset:128
    buffer_load_ushort v55, v13, s[28:31], s53 offen offset:192
    s_cmp_ge_u32 s2, 64
    s_cbranch_scc1 F_L1
    s_add_u32 s55, s52, 0
    buffer_load_dwordx4 v[24:27], v12, s[32:35], s55 offen nt
    s_add_u32 s55, s52, 196608
    buffer_load_dwordx4 v[28:31], v12, s[32:35], s55 offen nt
    s_add_u32 s55, s52, 393216
    buffer_load_dwordx4 v[32:35], v12, s[32:35], s55 offen nt
    s_add_u32 s55, s52, 589824
    buffer_load_dwordx4 v[36:39], v12, s[32:35], s55 offen nt
F_L1:
    s_mov_b32 s20, s8
    s_mov_b32 s21, s9
    s_and_b32 s21, s21, 0xffff
    s_mov_b32 s22, 0x200000
    s_mov_b32 s23, 0x00020000
    s_xor_b32 s55, s54, 0
    buffer_load_dwordx4 v[192:195], v8, s[20:23], s55 offen offset:0
    buffer_load_dwordx4 v[196:199], v8, s[20:23], s55 offen offset:1024
    s_mov_b32 s24, s10
    s_mov_b32 s25, s11
    s_and_b32 s25, s25, 0xffff
    s_mov_b32 s26, 0x180000
    s_mov_b32 s27, 0x00020000
    s_mov_b32 s40, s4
    s_mov_b32 s41, s5
    s_and_b32 s41, s41, 0xffff
    s_mov_b32 s42, 0x2000000
    s_mov_b32 s43, 0x00020000
    s_mov_b32 s36, s16
    s_mov_b32 s37, s17
    s_and_b32 s37, s37, 0xffff
    s_mov_b32 s38, 0x100
    s_mov_b32 s39, 0x00020000
    s_mov_b32 s28, s18
    s_mov_b32 s29, s19
    s_and_b32 s29, s29, 0xffff
    s_mov_b32 s30, 0x4000
    s_mov_b32 s31, 0x00020000
    s_sub_u32 s53, s2, 64
    s_cmp_lt_u32 s53, 128
    s_cselect_b32 s34, s34, 0
    s_cselect_b32 s70, -1, 0
    s_cmp_eq_u32 s3, 3
    s_cselect_b32 s70, s70, 0
    s_cbranch_scc1 F_W3A
    s_add_u32 m0, s60, 0
    s_add_u32 s50, s56, 1024
    buffer_load_dwordx4 v9, s[24:27], s50 offen lds
    s_add_u32 m0, s60, 4096
    s_add_u32 s50, s56, 2048
    buffer_load_dwordx4 v9, s[24:27], s50 offen lds
    s_add_u32 m0, s60, 8192
    s_add_u32 s50, s56, 99328
    buffer_load_dwordx4 v9, s[24:27], s50 offen lds
    s_add_u32 m0, s60, 12288
    s_add_u32 s50, s56, 100352
    buffer_load_dwordx4 v9, s[24:27], s50 offen lds
    s_add_u32 s52, s3, 0
    s_xor_b32 s52, s52, s45
    s_lshr_b32 s53, s52, 1
    s_mul_i32 s53, s53, 98304
    s_and_b32 s50, s52, 1
    s_lshl_b32 s50, s50, 10
    s_add_u32 s50, s50, s53
    s_lshl_b32 s52, s52, 12
    s_add_u32 m0, s52, 3072
    s_add_u32 s50, s50, s51
    buffer_load_dwordx4 v6, s[24:27], s50 offen lds
    s_add_u32 m0, s60, 65536
    s_add_u32 s50, s56, 787456
    buffer_load_dwordx4 v9, s[24:27], s50 offen lds
    s_add_u32 m0, s60, 69632
    s_add_u32 s50, s56, 788480
    buffer_load_dwordx4 v9, s[24:27], s50 offen lds
    s_add_u32 m0, s60, 73728
    s_add_u32 s50, s56, 885760
    buffer_load_dwordx4 v9, s[24:27], s50 offen lds
    s_add_u32 m0, s60, 77824
    s_add_u32 s50, s56, 886784
    buffer_load_dwordx4 v9, s[24:27], s50 offen lds
    s_branch F_X2
F_W3A:
    v_lshrrev_b32 v12, 1, v1
    v_and_b32 v13, 1, v1
    s_lshr_b32 s56, s2, 3
    s_mul_i32 s56, s56, 16*3072
    s_add_u32 s56, s56, 1408
    s_mov_b32 exec_hi, 0
    v_mul_u32_u24 v12, 3072, v12
    v_lshl_add_u32 v12, v13, 10, v12
    buffer_load_dword v63, v12, s[24:27], s56 offen
    s_mov_b32 exec_lo, -1
    s_mov_b32 exec_hi, -1
    s_load_dwordx4 s[8:11], s[0:1], 40
    s_load_dwordx2 s[12:13], s[0:1], 24
    s_cmp_ge_u32 s2, 64
    s_cbranch_scc1 F_X2
    v_mov_b32 v48, 0
    v_mov_b32 v49, 0
    v_mov_b32 v50, 0
    v_mov_b32 v51, 0
    s_lshl_b32 s56, s2, 10
    s_add_u32 s56, s56, 65536
    buffer_store_dwordx4 v[48:51], v8, s[40:43], s56 offen sc1
    s_lshl_b32 s55, s2, 10
    s_add_u32 s55, s55, 393216
    buffer_store_dwordx4 v[48:51], v8, s[40:43], s55 offen sc1
    s_lshr_b32 s56, s2, 1
    s_lshl_b32 s56, s56, 10
    s_and_b32 s55, s2, 1
    s_lshl_b32 s55, s55, 6
    s_add_u32 s56, s56, s55
    s_add_u32 s56, s56, 130048
    s_mov_b64 exec, 15
    buffer_store_dwordx4 v[48:51], v8, s[40:43], s56 offen offset:1024 sc1
    s_mov_b64 exec, -1
F_X2:
    s_mov_b64 exec, 0
    s_cmp_eq_u32 s3, 0
    s_cbranch_scc1 PG16
    s_cmp_eq_u32 s3, 1
    s_cbranch_scc1 PG32
    s_cmp_eq_u32 s3, 2
    s_cbranch_scc1 PG48
    s_branch PG64
PW_S1:
    s_mov_b64 exec, -1
    s_xor_b32 s55, s54, 2048
    buffer_load_dwordx4 v[200:203], v8, s[20:23], s55 offen offset:0
    buffer_load_dwordx4 v[204:207], v8, s[20:23], s55 offen offset:1024
    s_xor_b32 s55, s54, 4096
    buffer_load_dwordx4 v[208:211], v8, s[20:23], s55 offen offset:0
    buffer_load_dwordx4 v[212:215], v8, s[20:23], s55 offen offset:1024
    s_xor_b32 s55, s54, 6144
    buffer_load_dwordx4 v[216:219], v8, s[20:23], s55 offen offset:0
    buffer_load_dwordx4 v[220:223], v8, s[20:23], s55 offen offset:1024
    s_xor_b32 s55, s54, 8192
    buffer_load_dwordx4 v[224:227], v8, s[20:23], s55 offen offset:0
    buffer_load_dwordx4 v[228:231], v8, s[20:23], s55 offen offset:1024
    s_xor_b32 s55, s54, 10240
    buffer_load_dwordx4 v[232:235], v8, s[20:23], s55 offen offset:0
    buffer_load_dwordx4 v[236:239], v8, s[20:23], s55 offen offset:1024
    s_xor_b32 s55, s54, 12288
    buffer_load_dwordx4 v[240:243], v8, s[20:23], s55 offen offset:0
    buffer_load_dwordx4 v[244:247], v8, s[20:23], s55 offen offset:1024
    s_xor_b32 s55, s54, 14336
    buffer_load_dwordx4 v[248:251], v8, s[20:23], s55 offen offset:0
    buffer_load_dwordx4 v[252:255], v8, s[20:23], s55 offen offset:1024
    s_cmp_ge_u32 s2, 64
    s_cbranch_scc1 F_NG
    s_waitcnt vmcnt(25)
    s_cmp_lg_u32 s3, 3
    s_cbranch_scc1 F_G1
    s_waitcnt vmcnt(16)
F_G1:
    v_lshlrev_b32 v64, 16, v52
    v_lshlrev_b32 v65, 16, v53
    v_lshlrev_b32 v66, 16, v54
    v_lshlrev_b32 v67, 16, v55
    v_mul_f32 v68, 0xbfb8aa3b, v64
    v_mul_f32 v69, 0xbfb8aa3b, v65
    v_mul_f32 v70, 0xbfb8aa3b, v66
    v_mul_f32 v71, 0xbfb8aa3b, v67
    v_exp_f32 v68, v68
    v_exp_f32 v69, v69
    v_exp_f32 v70, v70
    v_exp_f32 v71, v71
    s_nop 0
    v_add_f32 v68, 1.0, v68
    v_add_f32 v69, 1.0, v69
    v_add_f32 v70, 1.0, v70
    v_add_f32 v71, 1.0, v71
    v_rcp_f32 v68, v68
    v_rcp_f32 v69, v69
    v_rcp_f32 v70, v70
    v_rcp_f32 v71, v71
    s_nop 0
    v_mul_f32 v64, v64, v68
    v_mul_f32 v65, v65, v69
    v_mul_f32 v66, v66, v70
    v_mul_f32 v67, v67, v71
    v_cvt_pk_bf16_f32 v64, v64, v64
    v_cvt_pk_bf16_f32 v65, v65, v65
    v_cvt_pk_bf16_f32 v66, v66, v66
    v_cvt_pk_bf16_f32 v67, v67, v67
    v_lshlrev_b32 v64, 16, v64
    v_lshlrev_b32 v65, 16, v65
    v_lshlrev_b32 v66, 16, v66
    v_lshlrev_b32 v67, 16, v67
    v_lshlrev_b32 v80, 16, v24
    v_and_b32 v81, 0xffff0000, v24
    v_mul_f32 v72, v64, v80
    v_mul_f32 v73, v64, v81
    v_lshlrev_b32 v82, 16, v25
    v_and_b32 v83, 0xffff0000, v25
    v_mul_f32 v74, v64, v82
    v_mul_f32 v75, v64, v83
PG16:
    s_cbranch_execz PW_S1
    v_lshlrev_b32 v80, 16, v26
    v_and_b32 v81, 0xffff0000, v26
    v_mul_f32 v76, v64, v80
    v_mul_f32 v77, v64, v81
    v_lshlrev_b32 v82, 16, v27
    v_and_b32 v83, 0xffff0000, v27
    v_mul_f32 v78, v64, v82
    v_mul_f32 v79, v64, v83
    v_lshlrev_b32 v80, 16, v28
    v_and_b32 v81, 0xffff0000, v28
    v_fmac_f32 v72, v65, v80
    v_fmac_f32 v73, v65, v81
    v_lshlrev_b32 v82, 16, v29
    v_and_b32 v83, 0xffff0000, v29
    v_fmac_f32 v74, v65, v82
    v_fmac_f32 v75, v65, v83
    v_lshlrev_b32 v80, 16, v30
    v_and_b32 v81, 0xffff0000, v30
    v_fmac_f32 v76, v65, v80
    v_fmac_f32 v77, v65, v81
    v_lshlrev_b32 v82, 16, v31
    v_and_b32 v83, 0xffff0000, v31
    v_fmac_f32 v78, v65, v82
    v_fmac_f32 v79, v65, v83
    v_lshlrev_b32 v80, 16, v32
    v_and_b32 v81, 0xffff0000, v32
    v_fmac_f32 v72, v66, v80
    v_fmac_f32 v73, v66, v81
    v_lshlrev_b32 v82, 16, v33
    v_and_b32 v83, 0xffff0000, v33
    v_fmac_f32 v74, v66, v82
    v_fmac_f32 v75, v66, v83
    v_lshlrev_b32 v80, 16, v34
    v_and_b32 v81, 0xffff0000, v34
    v_fmac_f32 v76, v66, v80
    v_fmac_f32 v77, v66, v81
    v_lshlrev_b32 v82, 16, v35
    v_and_b32 v83, 0xffff0000, v35
    v_fmac_f32 v78, v66, v82
    v_fmac_f32 v79, v66, v83
    v_lshlrev_b32 v80, 16, v36
    v_and_b32 v81, 0xffff0000, v36
    v_fmac_f32 v72, v67, v80
    v_fmac_f32 v73, v67, v81
    v_lshlrev_b32 v82, 16, v37
    v_and_b32 v83, 0xffff0000, v37
    v_fmac_f32 v74, v67, v82
    v_fmac_f32 v75, v67, v83
    v_lshlrev_b32 v80, 16, v38
    v_and_b32 v81, 0xffff0000, v38
    v_fmac_f32 v76, v67, v80
    v_fmac_f32 v77, v67, v81
    v_lshlrev_b32 v82, 16, v39
    v_and_b32 v83, 0xffff0000, v39
    v_fmac_f32 v78, v67, v82
    v_fmac_f32 v79, v67, v83
    v_and_b32 v80, 7, v1
    v_bfe_u32 v81, v1, 3, 1
    v_lshlrev_b32 v80, 5, v80
    v_lshl_add_u32 v80, v81, 4, v80
    v_lshl_add_u32 v80, v2, 2, v80
    s_lshl_b32 s53, s3, 8
    s_add_u32 s53, s53, 147456
    v_add_u32 v80, s53, v80
    v_cmp_eq_u32 vcc, 1, v81
    s_nop 0
    v_permlane16_swap_b32 v72, v73
    v_permlane16_swap_b32 v74, v75
    v_permlane16_swap_b32 v76, v77
    v_permlane16_swap_b32 v78, v79
    s_nop 0
    v_add_f32 v72, v72, v73
    v_add_f32 v74, v74, v75
    v_add_f32 v76, v76, v77
    v_add_f32 v78, v78, v79
    s_nop 0
    v_permlane32_swap_b32 v72, v74
    v_permlane32_swap_b32 v76, v78
    s_nop 0
    v_add_f32 v72, v72, v74
    v_add_f32 v76, v76, v78
    s_nop 1
    v_add_f32_dpp v72, v72, v72 row_ror:8 row_mask:0xf bank_mask:0xf
    v_add_f32_dpp v76, v76, v76 row_ror:8 row_mask:0xf bank_mask:0xf
    s_nop 0
    v_cndmask_b32 v72, v72, v76, vcc
    ds_write_b32 v80, v72
    s_waitcnt lgkmcnt(0)
    s_barrier
F_NG:
    s_cmp_eq_u32 s3, 3
    s_cbranch_scc1 F_W3C
    s_mov_b32 s46, 0x3f803f80
    s_waitcnt vmcnt(0)
    v_dot2_f32_bf16 v16, v192, s46, 0
    v_dot2_f32_bf16 v20, v192, v192, 0
    v_dot2_f32_bf16 v17, v196, s46, 0
    v_dot2_f32_bf16 v21, v196, v196, 0
    v_dot2_f32_bf16 v16, v193, s46, v16
    v_dot2_f32_bf16 v20, v193, v193, v20
    v_dot2_f32_bf16 v17, v197, s46, v17
    v_dot2_f32_bf16 v21, v197, v197, v21
    v_dot2_f32_bf16 v16, v194, s46, v16
    v_dot2_f32_bf16 v20, v194, v194, v20
    s_add_u32 s52, s3, 3
    s_xor_b32 s52, s52, s45
    s_lshr_b32 s53, s52, 1
    s_mul_i32 s53, s53, 98304
    s_and_b32 s50, s52, 1
    s_lshl_b32 s50, s50, 10
    s_add_u32 s50, s50, s53
    s_lshl_b32 s52, s52, 12
    s_add_u32 m0, s52, 3072
    s_add_u32 s50, s50, s51
    buffer_load_dwordx4 v6, s[24:27], s50 offen lds
    v_dot2_f32_bf16 v17, v198, s46, v17
    v_dot2_f32_bf16 v21, v198, v198, v21
    v_dot2_f32_bf16 v16, v195, s46, v16
    v_dot2_f32_bf16 v20, v195, v195, v20
    v_dot2_f32_bf16 v17, v199, s46, v17
    v_dot2_f32_bf16 v21, v199, v199, v21
    v_dot2_f32_bf16 v18, v200, s46, 0
    v_dot2_f32_bf16 v22, v200, v200, 0
    v_dot2_f32_bf16 v19, v204, s46, 0
    s_add_u32 m0, s61, 0
    s_add_u32 s50, s57, 1024
    buffer_load_dwordx4 v9, s[24:27], s50 offen lds
    v_dot2_f32_bf16 v23, v204, v204, 0
    v_dot2_f32_bf16 v18, v201, s46, v18
    v_dot2_f32_bf16 v22, v201, v201, v22
    v_dot2_f32_bf16 v19, v205, s46, v19
    v_dot2_f32_bf16 v23, v205, v205, v23
    v_dot2_f32_bf16 v18, v202, s46, v18
    v_dot2_f32_bf16 v22, v202, v202, v22
    v_dot2_f32_bf16 v19, v206, s46, v19
    v_dot2_f32_bf16 v23, v206, v206, v23
    v_dot2_f32_bf16 v18, v203, s46, v18
    s_add_u32 m0, s61, 4096
    s_add_u32 s50, s57, 2048
    buffer_load_dwordx4 v9, s[24:27], s50 offen lds
    v_dot2_f32_bf16 v22, v203, v203, v22
    v_dot2_f32_bf16 v19, v207, s46, v19
    v_dot2_f32_bf16 v23, v207, v207, v23
    v_dot2_f32_bf16 v24, v208, s46, 0
    v_dot2_f32_bf16 v28, v208, v208, 0
    v_dot2_f32_bf16 v25, v212, s46, 0
    v_dot2_f32_bf16 v29, v212, v212, 0
    v_dot2_f32_bf16 v24, v209, s46, v24
    v_dot2_f32_bf16 v28, v209, v209, v28
    s_add_u32 m0, s61, 8192
    s_add_u32 s50, s57, 99328
    buffer_load_dwordx4 v9, s[24:27], s50 offen lds
    v_dot2_f32_bf16 v25, v213, s46, v25
    v_dot2_f32_bf16 v29, v213, v213, v29
    v_dot2_f32_bf16 v24, v210, s46, v24
    v_dot2_f32_bf16 v28, v210, v210, v28
    v_dot2_f32_bf16 v25, v214, s46, v25
    v_dot2_f32_bf16 v29, v214, v214, v29
    v_dot2_f32_bf16 v24, v211, s46, v24
    v_dot2_f32_bf16 v28, v211, v211, v28
    v_dot2_f32_bf16 v25, v215, s46, v25
    v_dot2_f32_bf16 v29, v215, v215, v29
    s_add_u32 m0, s61, 12288
    s_add_u32 s50, s57, 100352
    buffer_load_dwordx4 v9, s[24:27], s50 offen lds
    v_dot2_f32_bf16 v26, v216, s46, 0
    v_dot2_f32_bf16 v30, v216, v216, 0
    v_dot2_f32_bf16 v27, v220, s46, 0
    v_dot2_f32_bf16 v31, v220, v220, 0
    v_dot2_f32_bf16 v26, v217, s46, v26
    v_dot2_f32_bf16 v30, v217, v217, v30
    v_dot2_f32_bf16 v27, v221, s46, v27
    v_dot2_f32_bf16 v31, v221, v221, v31
    v_dot2_f32_bf16 v26, v218, s46, v26
    s_add_u32 s52, s3, 6
    s_xor_b32 s52, s52, s45
    s_lshr_b32 s53, s52, 1
    s_mul_i32 s53, s53, 98304
    s_and_b32 s50, s52, 1
    s_lshl_b32 s50, s50, 10
    s_add_u32 s50, s50, s53
    s_lshl_b32 s52, s52, 12
    s_add_u32 m0, s52, 3072
    s_add_u32 s50, s50, s51
    buffer_load_dwordx4 v6, s[24:27], s50 offen lds
    v_dot2_f32_bf16 v30, v218, v218, v30
    v_dot2_f32_bf16 v27, v222, s46, v27
    v_dot2_f32_bf16 v31, v222, v222, v31
    v_dot2_f32_bf16 v26, v219, s46, v26
    v_dot2_f32_bf16 v30, v219, v219, v30
    v_dot2_f32_bf16 v27, v223, s46, v27
    v_dot2_f32_bf16 v31, v223, v223, v31
    v_dot2_f32_bf16 v32, v224, s46, 0
    v_dot2_f32_bf16 v36, v224, v224, 0
    v_dot2_f32_bf16 v33, v228, s46, 0
    s_add_u32 m0, s62, 0
    s_add_u32 s50, s58, 1024
    buffer_load_dwordx4 v9, s[24:27], s50 offen lds
    v_dot2_f32_bf16 v37, v228, v228, 0
    v_dot2_f32_bf16 v32, v225, s46, v32
    v_dot2_f32_bf16 v36, v225, v225, v36
    v_dot2_f32_bf16 v33, v229, s46, v33
    v_dot2_f32_bf16 v37, v229, v229, v37
    v_dot2_f32_bf16 v32, v226, s46, v32
    v_dot2_f32_bf16 v36, v226, v226, v36
    v_dot2_f32_bf16 v33, v230, s46, v33
    v_dot2_f32_bf16 v37, v230, v230, v37
    s_add_u32 m0, s62, 4096
    s_add_u32 s50, s58, 2048
    buffer_load_dwordx4 v9, s[24:27], s50 offen lds
    v_dot2_f32_bf16 v32, v227, s46, v32
    v_dot2_f32_bf16 v36, v227, v227, v36
    v_dot2_f32_bf16 v33, v231, s46, v33
    v_dot2_f32_bf16 v37, v231, v231, v37
    v_dot2_f32_bf16 v34, v232, s46, 0
    v_dot2_f32_bf16 v38, v232, v232, 0
    v_dot2_f32_bf16 v35, v236, s46, 0
    v_dot2_f32_bf16 v39, v236, v236, 0
    v_dot2_f32_bf16 v34, v233, s46, v34
    s_add_u32 m0, s62, 8192
    s_add_u32 s50, s58, 99328
    buffer_load_dwordx4 v9, s[24:27], s50 offen lds
    v_dot2_f32_bf16 v38, v233, v233, v38
    v_dot2_f32_bf16 v35, v237, s46, v35
    v_dot2_f32_bf16 v39, v237, v237, v39
    v_dot2_f32_bf16 v34, v234, s46, v34
    v_dot2_f32_bf16 v38, v234, v234, v38
    v_dot2_f32_bf16 v35, v238, s46, v35
    v_dot2_f32_bf16 v39, v238, v238, v39
    v_dot2_f32_bf16 v34, v235, s46, v34
    v_dot2_f32_bf16 v38, v235, v235, v38
    v_dot2_f32_bf16 v35, v239, s46, v35
    s_add_u32 m0, s62, 12288
    s_add_u32 s50, s58, 100352
    buffer_load_dwordx4 v9, s[24:27], s50 offen lds
    v_dot2_f32_bf16 v39, v239, v239, v39
    v_dot2_f32_bf16 v40, v240, s46, 0
    v_dot2_f32_bf16 v44, v240, v240, 0
    v_dot2_f32_bf16 v41, v244, s46, 0
    v_dot2_f32_bf16 v45, v244, v244, 0
    v_dot2_f32_bf16 v40, v241, s46, v40
    v_dot2_f32_bf16 v44, v241, v241, v44
    v_dot2_f32_bf16 v41, v245, s46, v41
    v_dot2_f32_bf16 v45, v245, v245, v45
    s_add_u32 s52, s3, 9
    s_xor_b32 s52, s52, s45
    s_lshr_b32 s53, s52, 1
    s_mul_i32 s53, s53, 98304
    s_and_b32 s50, s52, 1
    s_lshl_b32 s50, s50, 10
    s_add_u32 s50, s50, s53
    s_lshl_b32 s52, s52, 12
    s_add_u32 m0, s52, 3072
    s_add_u32 s50, s50, s51
    buffer_load_dwordx4 v6, s[24:27], s50 offen lds
    v_dot2_f32_bf16 v40, v242, s46, v40
    v_dot2_f32_bf16 v44, v242, v242, v44
    v_dot2_f32_bf16 v41, v246, s46, v41
    v_dot2_f32_bf16 v45, v246, v246, v45
    v_dot2_f32_bf16 v40, v243, s46, v40
    v_dot2_f32_bf16 v44, v243, v243, v44
    v_dot2_f32_bf16 v41, v247, s46, v41
    v_dot2_f32_bf16 v45, v247, v247, v45
    v_dot2_f32_bf16 v42, v248, s46, 0
    v_dot2_f32_bf16 v46, v248, v248, 0
    s_add_u32 m0, s63, 0
    s_add_u32 s50, s59, 1024
    buffer_load_dwordx4 v9, s[24:27], s50 offen lds
    v_dot2_f32_bf16 v43, v252, s46, 0
    v_dot2_f32_bf16 v47, v252, v252, 0
    v_dot2_f32_bf16 v42, v249, s46, v42
    v_dot2_f32_bf16 v46, v249, v249, v46
    v_dot2_f32_bf16 v43, v253, s46, v43
    v_dot2_f32_bf16 v47, v253, v253, v47
    v_dot2_f32_bf16 v42, v250, s46, v42
    v_dot2_f32_bf16 v46, v250, v250, v46
    v_dot2_f32_bf16 v43, v254, s46, v43
    s_add_u32 m0, s63, 4096
    s_add_u32 s50, s59, 2048
    buffer_load_dwordx4 v9, s[24:27], s50 offen lds
    v_dot2_f32_bf16 v47, v254, v254, v47
    v_dot2_f32_bf16 v42, v251, s46, v42
    v_dot2_f32_bf16 v46, v251, v251, v46
    v_dot2_f32_bf16 v43, v255, s46, v43
    v_dot2_f32_bf16 v47, v255, v255, v47
    v_lshlrev_b32 v64, 16, v192
    v_and_b32 v65, 0xffff0000, v192
    v_lshlrev_b32 v66, 16, v193
    v_and_b32 v67, 0xffff0000, v193
    v_permlane32_swap_b32 v16, v32
    s_add_u32 m0, s63, 8192
    s_add_u32 s50, s59, 99328
    buffer_load_dwordx4 v9, s[24:27], s50 offen lds
    v_permlane32_swap_b32 v17, v33
    v_permlane32_swap_b32 v18, v34
    v_permlane32_swap_b32 v19, v35
    v_permlane32_swap_b32 v20, v36
    v_permlane32_swap_b32 v21, v37
    v_permlane32_swap_b32 v22, v38
    v_permlane32_swap_b32 v23, v39
    v_permlane32_swap_b32 v24, v40
    v_permlane32_swap_b32 v25, v41
    s_add_u32 m0, s63, 12288
    s_add_u32 s50, s59, 100352
    buffer_load_dwordx4 v9, s[24:27], s50 offen lds
    v_permlane32_swap_b32 v26, v42
    v_permlane32_swap_b32 v27, v43
    v_permlane32_swap_b32 v28, v44
    v_permlane32_swap_b32 v29, v45
    v_permlane32_swap_b32 v30, v46
    v_permlane32_swap_b32 v31, v47
    v_lshlrev_b32 v68, 16, v194
    v_and_b32 v69, 0xffff0000, v194
    v_add_f32 v16, v16, v32
    s_add_u32 s52, s3, 12
    s_xor_b32 s52, s52, s45
    s_lshr_b32 s53, s52, 1
    s_mul_i32 s53, s53, 98304
    s_and_b32 s50, s52, 1
    s_lshl_b32 s50, s50, 10
    s_add_u32 s50, s50, s53
    s_lshl_b32 s52, s52, 12
    s_add_u32 m0, s52, 3072
    s_add_u32 s50, s50, s51
    buffer_load_dwordx4 v6, s[24:27], s50 offen lds
    v_add_f32 v17, v17, v33
    v_add_f32 v18, v18, v34
    v_add_f32 v19, v19, v35
    v_add_f32 v20, v20, v36
    v_add_f32 v21, v21, v37
    v_add_f32 v22, v22, v38
    v_add_f32 v23, v23, v39
    v_add_f32 v24, v24, v40
    v_add_f32 v25, v25, v41
    v_add_f32 v26, v26, v42
    s_add_u32 s52, s3, 15
    s_min_u32 s52, s52, 15
    s_xor_b32 s52, s52, s45
    s_lshr_b32 s53, s52, 1
    s_mul_i32 s53, s53, 98304
    s_and_b32 s50, s52, 1
    s_lshl_b32 s50, s50, 10
    s_add_u32 s50, s50, s53
    s_lshl_b32 s52, s52, 12
    s_add_u32 m0, s52, 3072
    s_add_u32 s50, s50, s51
    buffer_load_dwordx4 v6, s[24:27], s50 offen lds
    v_add_f32 v27, v27, v43
    v_add_f32 v28, v28, v44
    v_add_f32 v29, v29, v45
    v_add_f32 v30, v30, v46
    v_add_f32 v31, v31, v47
    v_lshlrev_b32 v70, 16, v195
    v_and_b32 v71, 0xffff0000, v195
    v_permlane16_swap_b32 v16, v24
    v_permlane16_swap_b32 v17, v25
    s_add_u32 s52, s3, 0
    s_xor_b32 s52, s52, s45
    s_add_u32 s52, s52, 16
    s_lshr_b32 s53, s52, 1
    s_mul_i32 s53, s53, 98304
    s_and_b32 s50, s52, 1
    s_lshl_b32 s50, s50, 10
    s_add_u32 s50, s50, s53
    s_lshl_b32 s52, s52, 12
    s_add_u32 m0, s52, 3072
    s_add_u32 s50, s50, s51
    buffer_load_dwordx4 v6, s[24:27], s50 offen lds
    v_permlane16_swap_b32 v18, v26
    v_permlane16_swap_b32 v19, v27
    v_permlane16_swap_b32 v20, v28
    v_permlane16_swap_b32 v21, v29
    v_permlane16_swap_b32 v22, v30
    v_permlane16_swap_b32 v23, v31
    v_lshlrev_b32 v72, 16, v196
    v_and_b32 v73, 0xffff0000, v196
    v_add_f32 v16, v16, v24
    v_add_f32 v17, v17, v25
    s_add_u32 s52, s3, 3
    s_xor_b32 s52, s52, s45
    s_add_u32 s52, s52, 16
    s_lshr_b32 s53, s52, 1
    s_mul_i32 s53, s53, 98304
    s_and_b32 s50, s52, 1
    s_lshl_b32 s50, s50, 10
    s_add_u32 s50, s50, s53
    s_lshl_b32 s52, s52, 12
    s_add_u32 m0, s52, 3072
    s_add_u32 s50, s50, s51
    buffer_load_dwordx4 v6, s[24:27], s50 offen lds
    v_add_f32 v18, v18, v26
    v_add_f32 v19, v19, v27
    v_add_f32 v20, v20, v28
    v_add_f32 v21, v21, v29
    v_add_f32 v22, v22, v30
    v_add_f32 v23, v23, v31
    v_lshlrev_b32 v74, 16, v197
    v_and_b32 v75, 0xffff0000, v197
    v_add_f32_dpp v16, v16, v16 row_ror:8 row_mask:0xf bank_mask:0xf
    s_add_u32 m0, s61, 65536
    s_add_u32 s50, s57, 787456
    buffer_load_dwordx4 v9, s[24:27], s50 offen lds
    v_add_f32_dpp v17, v17, v17 row_ror:8 row_mask:0xf bank_mask:0xf
    v_add_f32_dpp v18, v18, v18 row_ror:8 row_mask:0xf bank_mask:0xf
    v_add_f32_dpp v19, v19, v19 row_ror:8 row_mask:0xf bank_mask:0xf
    v_add_f32_dpp v20, v20, v20 row_ror:8 row_mask:0xf bank_mask:0xf
    v_add_f32_dpp v21, v21, v21 row_ror:8 row_mask:0xf bank_mask:0xf
    v_add_f32_dpp v22, v22, v22 row_ror:8 row_mask:0xf bank_mask:0xf
    v_add_f32_dpp v23, v23, v23 row_ror:8 row_mask:0xf bank_mask:0xf
    v_lshlrev_b32 v76, 16, v198
    v_and_b32 v77, 0xffff0000, v198
    v_add_f32_dpp v16, v16, v16 row_ror:4 row_mask:0xf bank_mask:0xf
    s_add_u32 m0, s61, 69632
    s_add_u32 s50, s57, 788480
    buffer_load_dwordx4 v9, s[24:27], s50 offen lds
    v_add_f32_dpp v17, v17, v17 row_ror:4 row_mask:0xf bank_mask:0xf
    v_add_f32_dpp v18, v18, v18 row_ror:4 row_mask:0xf bank_mask:0xf
    v_add_f32_dpp v19, v19, v19 row_ror:4 row_mask:0xf bank_mask:0xf
    v_add_f32_dpp v20, v20, v20 row_ror:4 row_mask:0xf bank_mask:0xf
    v_add_f32_dpp v21, v21, v21 row_ror:4 row_mask:0xf bank_mask:0xf
    v_add_f32_dpp v22, v22, v22 row_ror:4 row_mask:0xf bank_mask:0xf
    v_add_f32_dpp v23, v23, v23 row_ror:4 row_mask:0xf bank_mask:0xf
    v_lshlrev_b32 v78, 16, v199
    v_and_b32 v79, 0xffff0000, v199
    s_add_u32 m0, s61, 73728
    s_add_u32 s50, s57, 885760
    buffer_load_dwordx4 v9, s[24:27], s50 offen lds
    v_add_f32_dpp v16, v16, v16 row_ror:2 row_mask:0xf bank_mask:0xf
    v_add_f32_dpp v17, v17, v17 row_ror:2 row_mask:0xf bank_mask:0xf
    v_add_f32_dpp v18, v18, v18 row_ror:2 row_mask:0xf bank_mask:0xf
    v_add_f32_dpp v19, v19, v19 row_ror:2 row_mask:0xf bank_mask:0xf
    v_add_f32_dpp v20, v20, v20 row_ror:2 row_mask:0xf bank_mask:0xf
    v_add_f32_dpp v21, v21, v21 row_ror:2 row_mask:0xf bank_mask:0xf
    v_add_f32_dpp v22, v22, v22 row_ror:2 row_mask:0xf bank_mask:0xf
    v_add_f32_dpp v23, v23, v23 row_ror:2 row_mask:0xf bank_mask:0xf
    v_lshlrev_b32 v80, 16, v200
    v_and_b32 v81, 0xffff0000, v200
    s_add_u32 m0, s61, 77824
    s_add_u32 s50, s57, 886784
    buffer_load_dwordx4 v9, s[24:27], s50 offen lds
    v_add_f32_dpp v16, v16, v16 row_ror:1 row_mask:0xf bank_mask:0xf
    v_add_f32_dpp v17, v17, v17 row_ror:1 row_mask:0xf bank_mask:0xf
    v_add_f32_dpp v18, v18, v18 row_ror:1 row_mask:0xf bank_mask:0xf
    v_add_f32_dpp v19, v19, v19 row_ror:1 row_mask:0xf bank_mask:0xf
    v_add_f32_dpp v20, v20, v20 row_ror:1 row_mask:0xf bank_mask:0xf
    v_add_f32_dpp v21, v21, v21 row_ror:1 row_mask:0xf bank_mask:0xf
    v_add_f32_dpp v22, v22, v22 row_ror:1 row_mask:0xf bank_mask:0xf
    v_add_f32_dpp v23, v23, v23 row_ror:1 row_mask:0xf bank_mask:0xf
    v_lshlrev_b32 v82, 16, v201
    s_add_u32 s52, s3, 6
    s_xor_b32 s52, s52, s45
    s_add_u32 s52, s52, 16
    s_lshr_b32 s53, s52, 1
    s_mul_i32 s53, s53, 98304
    s_and_b32 s50, s52, 1
    s_lshl_b32 s50, s50, 10
    s_add_u32 s50, s50, s53
    s_lshl_b32 s52, s52, 12
    s_add_u32 m0, s52, 3072
    s_add_u32 s50, s50, s51
    buffer_load_dwordx4 v6, s[24:27], s50 offen lds
    v_and_b32 v83, 0xffff0000, v201
    v_mul_f32 v16, 0x3b000000, v16
    v_mul_f32 v20, 0x3b000000, v20
    v_mul_f32 v17, 0x3b000000, v17
    v_mul_f32 v21, 0x3b000000, v21
    v_mul_f32 v18, 0x3b000000, v18
    v_mul_f32 v22, 0x3b000000, v22
    v_mul_f32 v19, 0x3b000000, v19
    v_mul_f32 v23, 0x3b000000, v23
    s_add_u32 m0, s62, 65536
    s_add_u32 s50, s58, 787456
    buffer_load_dwordx4 v9, s[24:27], s50 offen lds
    v_fma_f32 v20, -v16, v16, v20
    v_fma_f32 v21, -v17, v17, v21
    v_fma_f32 v22, -v18, v18, v22
    v_fma_f32 v23, -v19, v19, v23
    v_max_f32 v20, 0, v20
    v_max_f32 v21, 0, v21
    v_max_f32 v22, 0, v22
    v_max_f32 v23, 0, v23
    v_add_f32 v20, 0x3727c5ac, v20
    v_add_f32 v21, 0x3727c5ac, v21
    s_add_u32 m0, s62, 69632
    s_add_u32 s50, s58, 788480
    buffer_load_dwordx4 v9, s[24:27], s50 offen lds
    v_add_f32 v22, 0x3727c5ac, v22
    v_add_f32 v23, 0x3727c5ac, v23
    v_rsq_f32 v20, v20
    v_rsq_f32 v21, v21
    v_rsq_f32 v22, v22
    v_rsq_f32 v23, v23
    v_lshlrev_b32 v84, 16, v202
    v_and_b32 v85, 0xffff0000, v202
    v_mul_f32 v16, v16, v20
    s_add_u32 m0, s62, 73728
    s_add_u32 s50, s58, 885760
    buffer_load_dwordx4 v9, s[24:27], s50 offen lds
    v_mul_f32 v17, v17, v21
    v_mul_f32 v18, v18, v22
    v_mul_f32 v19, v19, v23
    v_sub_f32 v16, 0, v16
    v_sub_f32 v17, 0, v17
    v_sub_f32 v18, 0, v18
    v_sub_f32 v19, 0, v19
    v_lshlrev_b32 v86, 16, v203
    v_and_b32 v87, 0xffff0000, v203
    v_lshlrev_b32 v88, 16, v204
    s_add_u32 m0, s62, 77824
    s_add_u32 s50, s58, 886784
    buffer_load_dwordx4 v9, s[24:27], s50 offen lds
    v_and_b32 v89, 0xffff0000, v204
    v_lshlrev_b32 v90, 16, v205
    v_and_b32 v91, 0xffff0000, v205
    v_lshlrev_b32 v92, 16, v206
    v_and_b32 v93, 0xffff0000, v206
    v_lshlrev_b32 v94, 16, v207
    v_and_b32 v95, 0xffff0000, v207
    v_lshlrev_b32 v96, 16, v208
    v_and_b32 v97, 0xffff0000, v208
    s_add_u32 s52, s3, 9
    s_xor_b32 s52, s52, s45
    s_add_u32 s52, s52, 16
    s_lshr_b32 s53, s52, 1
    s_mul_i32 s53, s53, 98304
    s_and_b32 s50, s52, 1
    s_lshl_b32 s50, s50, 10
    s_add_u32 s50, s50, s53
    s_lshl_b32 s52, s52, 12
    s_add_u32 m0, s52, 3072
    s_add_u32 s50, s50, s51
    buffer_load_dwordx4 v6, s[24:27], s50 offen lds
    v_lshlrev_b32 v98, 16, v209
    v_and_b32 v99, 0xffff0000, v209
    v_lshlrev_b32 v100, 16, v210
    v_and_b32 v101, 0xffff0000, v210
    v_lshlrev_b32 v102, 16, v211
    v_and_b32 v103, 0xffff0000, v211
    v_lshlrev_b32 v104, 16, v212
    v_and_b32 v105, 0xffff0000, v212
    v_lshlrev_b32 v106, 16, v213
    v_and_b32 v107, 0xffff0000, v213
    s_add_u32 m0, s63, 65536
    s_add_u32 s50, s59, 787456
    buffer_load_dwordx4 v9, s[24:27], s50 offen lds
    v_lshlrev_b32 v108, 16, v214
    v_and_b32 v109, 0xffff0000, v214
    v_lshlrev_b32 v110, 16, v215
    v_and_b32 v111, 0xffff0000, v215
    v_lshlrev_b32 v112, 16, v216
    v_and_b32 v113, 0xffff0000, v216
    v_lshlrev_b32 v114, 16, v217
    v_and_b32 v115, 0xffff0000, v217
    v_lshlrev_b32 v116, 16, v218
    s_add_u32 m0, s63, 69632
    s_add_u32 s50, s59, 788480
    buffer_load_dwordx4 v9, s[24:27], s50 offen lds
    v_and_b32 v117, 0xffff0000, v218
    v_lshlrev_b32 v118, 16, v219
    v_and_b32 v119, 0xffff0000, v219
    v_lshlrev_b32 v120, 16, v220
    v_and_b32 v121, 0xffff0000, v220
    v_lshlrev_b32 v122, 16, v221
    v_and_b32 v123, 0xffff0000, v221
    v_lshlrev_b32 v124, 16, v222
    v_and_b32 v125, 0xffff0000, v222
    s_add_u32 m0, s63, 73728
    s_add_u32 s50, s59, 885760
    buffer_load_dwordx4 v9, s[24:27], s50 offen lds
    v_lshlrev_b32 v126, 16, v223
    v_and_b32 v127, 0xffff0000, v223
    v_lshlrev_b32 v128, 16, v224
    v_and_b32 v129, 0xffff0000, v224
    v_lshlrev_b32 v130, 16, v225
    v_and_b32 v131, 0xffff0000, v225
    v_lshlrev_b32 v132, 16, v226
    v_and_b32 v133, 0xffff0000, v226
    v_lshlrev_b32 v134, 16, v227
    v_and_b32 v135, 0xffff0000, v227
    s_add_u32 m0, s63, 77824
    s_add_u32 s50, s59, 886784
    buffer_load_dwordx4 v9, s[24:27], s50 offen lds
    v_lshlrev_b32 v136, 16, v228
    v_and_b32 v137, 0xffff0000, v228
    v_lshlrev_b32 v138, 16, v229
    v_and_b32 v139, 0xffff0000, v229
    v_lshlrev_b32 v140, 16, v230
    v_and_b32 v141, 0xffff0000, v230
    v_lshlrev_b32 v142, 16, v231
    v_and_b32 v143, 0xffff0000, v231
    v_lshlrev_b32 v144, 16, v232
    s_add_u32 s52, s3, 12
    s_xor_b32 s52, s52, s45
    s_add_u32 s52, s52, 16
    s_lshr_b32 s53, s52, 1
    s_mul_i32 s53, s53, 98304
    s_and_b32 s50, s52, 1
    s_lshl_b32 s50, s50, 10
    s_add_u32 s50, s50, s53
    s_lshl_b32 s52, s52, 12
    s_add_u32 m0, s52, 3072
    s_add_u32 s50, s50, s51
    buffer_load_dwordx4 v6, s[24:27], s50 offen lds
    v_and_b32 v145, 0xffff0000, v232
    v_lshlrev_b32 v146, 16, v233
    v_and_b32 v147, 0xffff0000, v233
    v_lshlrev_b32 v148, 16, v234
    v_and_b32 v149, 0xffff0000, v234
    v_lshlrev_b32 v150, 16, v235
    v_and_b32 v151, 0xffff0000, v235
    v_lshlrev_b32 v152, 16, v236
    v_and_b32 v153, 0xffff0000, v236
    v_lshlrev_b32 v154, 16, v237
    s_add_u32 s52, s3, 15
    s_min_u32 s52, s52, 15
    s_xor_b32 s52, s52, s45
    s_add_u32 s52, s52, 16
    s_lshr_b32 s53, s52, 1
    s_mul_i32 s53, s53, 98304
    s_and_b32 s50, s52, 1
    s_lshl_b32 s50, s50, 10
    s_add_u32 s50, s50, s53
    s_lshl_b32 s52, s52, 12
    s_add_u32 m0, s52, 3072
    s_add_u32 s50, s50, s51
    buffer_load_dwordx4 v6, s[24:27], s50 offen lds
    v_and_b32 v155, 0xffff0000, v237
    v_lshlrev_b32 v156, 16, v238
    v_and_b32 v157, 0xffff0000, v238
    v_lshlrev_b32 v158, 16, v239
    v_and_b32 v159, 0xffff0000, v239
    v_lshlrev_b32 v160, 16, v240
    v_and_b32 v161, 0xffff0000, v240
    v_lshlrev_b32 v162, 16, v241
    v_and_b32 v163, 0xffff0000, v241
    s_add_u32 s55, s68, 0
    buffer_load_dwordx4 a[0:3], v60, s[32:35], s55 offen nt
    v_lshlrev_b32 v164, 16, v242
    v_and_b32 v165, 0xffff0000, v242
    v_lshlrev_b32 v166, 16, v243
    v_and_b32 v167, 0xffff0000, v243
    v_lshlrev_b32 v168, 16, v244
    v_and_b32 v169, 0xffff0000, v244
    v_lshlrev_b32 v170, 16, v245
    v_and_b32 v171, 0xffff0000, v245
    v_lshlrev_b32 v172, 16, v246
    v_and_b32 v173, 0xffff0000, v246
    s_add_u32 s55, s68, 196608
    buffer_load_dwordx4 a[12:15], v60, s[32:35], s55 offen nt
    v_lshlrev_b32 v174, 16, v247
    v_and_b32 v175, 0xffff0000, v247
    v_lshlrev_b32 v176, 16, v248
    v_and_b32 v177, 0xffff0000, v248
    v_lshlrev_b32 v178, 16, v249
    v_and_b32 v179, 0xffff0000, v249
    v_lshlrev_b32 v180, 16, v250
    v_and_b32 v181, 0xffff0000, v250
    v_lshlrev_b32 v182, 16, v251
    s_add_u32 s55, s68, 393216
    buffer_load_dwordx4 a[24:27], v60, s[32:35], s55 offen nt
PG32:
    s_cbranch_execz PW_S1
    v_and_b32 v183, 0xffff0000, v251
    v_lshlrev_b32 v184, 16, v252
    v_and_b32 v185, 0xffff0000, v252
    v_lshlrev_b32 v186, 16, v253
    v_and_b32 v187, 0xffff0000, v253
    v_lshlrev_b32 v188, 16, v254
    v_and_b32 v189, 0xffff0000, v254
    v_lshlrev_b32 v190, 16, v255
    v_and_b32 v191, 0xffff0000, v255
    s_add_u32 s55, s68, 589824
    buffer_load_dwordx4 a[36:39], v60, s[32:35], s55 offen nt
    s_branch F_J
F_W3C:
    s_cmp_ge_u32 s2, 64
    s_cbranch_scc1 F_W3D
    v_lshlrev_b32 v12, 2, v1
    v_add_u32 v13, 147456, v12
    ds_read_b32 v48, v13 offset:0
    ds_read_b32 v49, v13 offset:256
    ds_read_b32 v50, v13 offset:512
    ds_read_b32 v51, v13 offset:768
    s_waitcnt lgkmcnt(0)
    v_add_f32 v48, v48, v49
    v_add_f32 v50, v50, v51
    v_add_f32 v48, v48, v50
    s_waitcnt vmcnt(0)
    buffer_store_dword v48, v12, s[40:43], s69 offen sc1
    s_branch F_W3E
F_W3D:
    s_waitcnt vmcnt(0) lgkmcnt(0)
F_W3E:
    s_mov_b32 s46, 0x3f803f80
    v_dot2_f32_bf16 v16, v192, s46, 0
    v_dot2_f32_bf16 v20, v192, v192, 0
    v_dot2_f32_bf16 v17, v196, s46, 0
    v_dot2_f32_bf16 v21, v196, v196, 0
    v_dot2_f32_bf16 v16, v193, s46, v16
    v_dot2_f32_bf16 v20, v193, v193, v20
    v_dot2_f32_bf16 v17, v197, s46, v17
    v_dot2_f32_bf16 v21, v197, v197, v21
    v_dot2_f32_bf16 v16, v194, s46, v16
    v_dot2_f32_bf16 v20, v194, v194, v20
    v_dot2_f32_bf16 v17, v198, s46, v17
    v_dot2_f32_bf16 v21, v198, v198, v21
    v_dot2_f32_bf16 v16, v195, s46, v16
    v_dot2_f32_bf16 v20, v195, v195, v20
    v_dot2_f32_bf16 v17, v199, s46, v17
    v_dot2_f32_bf16 v21, v199, v199, v21
    v_dot2_f32_bf16 v18, v200, s46, 0
    v_dot2_f32_bf16 v22, v200, v200, 0
    v_dot2_f32_bf16 v19, v204, s46, 0
    v_dot2_f32_bf16 v23, v204, v204, 0
    v_dot2_f32_bf16 v18, v201, s46, v18
    v_dot2_f32_bf16 v22, v201, v201, v22
    v_dot2_f32_bf16 v19, v205, s46, v19
    v_dot2_f32_bf16 v23, v205, v205, v23
    v_dot2_f32_bf16 v18, v202, s46, v18
    v_dot2_f32_bf16 v22, v202, v202, v22
    v_dot2_f32_bf16 v19, v206, s46, v19
    v_dot2_f32_bf16 v23, v206, v206, v23
    v_dot2_f32_bf16 v18, v203, s46, v18
    v_dot2_f32_bf16 v22, v203, v203, v22
    v_dot2_f32_bf16 v19, v207, s46, v19
    v_dot2_f32_bf16 v23, v207, v207, v23
    v_dot2_f32_bf16 v24, v208, s46, 0
    v_dot2_f32_bf16 v28, v208, v208, 0
    v_dot2_f32_bf16 v25, v212, s46, 0
    v_dot2_f32_bf16 v29, v212, v212, 0
    v_dot2_f32_bf16 v24, v209, s46, v24
    v_dot2_f32_bf16 v28, v209, v209, v28
    v_dot2_f32_bf16 v25, v213, s46, v25
    v_dot2_f32_bf16 v29, v213, v213, v29
    v_dot2_f32_bf16 v24, v210, s46, v24
    v_dot2_f32_bf16 v28, v210, v210, v28
    v_dot2_f32_bf16 v25, v214, s46, v25
    v_dot2_f32_bf16 v29, v214, v214, v29
    v_dot2_f32_bf16 v24, v211, s46, v24
    v_dot2_f32_bf16 v28, v211, v211, v28
    v_dot2_f32_bf16 v25, v215, s46, v25
    v_dot2_f32_bf16 v29, v215, v215, v29
    v_dot2_f32_bf16 v26, v216, s46, 0
    v_dot2_f32_bf16 v30, v216, v216, 0
    v_dot2_f32_bf16 v27, v220, s46, 0
    v_dot2_f32_bf16 v31, v220, v220, 0
    v_dot2_f32_bf16 v26, v217, s46, v26
    v_dot2_f32_bf16 v30, v217, v217, v30
    v_dot2_f32_bf16 v27, v221, s46, v27
    v_dot2_f32_bf16 v31, v221, v221, v31
    v_dot2_f32_bf16 v26, v218, s46, v26
    v_dot2_f32_bf16 v30, v218, v218, v30
    v_dot2_f32_bf16 v27, v222, s46, v27
    v_dot2_f32_bf16 v31, v222, v222, v31
    v_dot2_f32_bf16 v26, v219, s46, v26
    v_dot2_f32_bf16 v30, v219, v219, v30
    v_dot2_f32_bf16 v27, v223, s46, v27
    v_dot2_f32_bf16 v31, v223, v223, v31
    v_dot2_f32_bf16 v32, v224, s46, 0
    v_dot2_f32_bf16 v36, v224, v224, 0
    v_dot2_f32_bf16 v33, v228, s46, 0
    v_dot2_f32_bf16 v37, v228, v228, 0
    v_dot2_f32_bf16 v32, v225, s46, v32
    v_dot2_f32_bf16 v36, v225, v225, v36
    v_dot2_f32_bf16 v33, v229, s46, v33
    v_dot2_f32_bf16 v37, v229, v229, v37
    v_dot2_f32_bf16 v32, v226, s46, v32
    v_dot2_f32_bf16 v36, v226, v226, v36
    v_dot2_f32_bf16 v33, v230, s46, v33
    v_dot2_f32_bf16 v37, v230, v230, v37
    v_dot2_f32_bf16 v32, v227, s46, v32
    v_dot2_f32_bf16 v36, v227, v227, v36
    v_dot2_f32_bf16 v33, v231, s46, v33
    v_dot2_f32_bf16 v37, v231, v231, v37
    v_dot2_f32_bf16 v34, v232, s46, 0
    v_dot2_f32_bf16 v38, v232, v232, 0
    v_dot2_f32_bf16 v35, v236, s46, 0
    v_dot2_f32_bf16 v39, v236, v236, 0
    v_dot2_f32_bf16 v34, v233, s46, v34
    v_dot2_f32_bf16 v38, v233, v233, v38
    v_dot2_f32_bf16 v35, v237, s46, v35
    v_dot2_f32_bf16 v39, v237, v237, v39
    v_dot2_f32_bf16 v34, v234, s46, v34
    v_dot2_f32_bf16 v38, v234, v234, v38
    v_dot2_f32_bf16 v35, v238, s46, v35
    v_dot2_f32_bf16 v39, v238, v238, v39
    v_dot2_f32_bf16 v34, v235, s46, v34
    v_dot2_f32_bf16 v38, v235, v235, v38
    v_dot2_f32_bf16 v35, v239, s46, v35
    v_dot2_f32_bf16 v39, v239, v239, v39
    v_dot2_f32_bf16 v40, v240, s46, 0
    v_dot2_f32_bf16 v44, v240, v240, 0
    v_dot2_f32_bf16 v41, v244, s46, 0
    v_dot2_f32_bf16 v45, v244, v244, 0
    v_dot2_f32_bf16 v40, v241, s46, v40
    v_dot2_f32_bf16 v44, v241, v241, v44
    v_dot2_f32_bf16 v41, v245, s46, v41
    v_dot2_f32_bf16 v45, v245, v245, v45
    v_dot2_f32_bf16 v40, v242, s46, v40
    v_dot2_f32_bf16 v44, v242, v242, v44
    v_dot2_f32_bf16 v41, v246, s46, v41
    v_dot2_f32_bf16 v45, v246, v246, v45
    v_dot2_f32_bf16 v40, v243, s46, v40
    v_dot2_f32_bf16 v44, v243, v243, v44
    v_dot2_f32_bf16 v41, v247, s46, v41
    v_dot2_f32_bf16 v45, v247, v247, v45
    v_dot2_f32_bf16 v42, v248, s46, 0
    v_dot2_f32_bf16 v46, v248, v248, 0
    v_dot2_f32_bf16 v43, v252, s46, 0
    v_dot2_f32_bf16 v47, v252, v252, 0
    v_dot2_f32_bf16 v42, v249, s46, v42
    v_dot2_f32_bf16 v46, v249, v249, v46
    v_dot2_f32_bf16 v43, v253, s46, v43
    v_dot2_f32_bf16 v47, v253, v253, v47
    v_dot2_f32_bf16 v42, v250, s46, v42
    v_dot2_f32_bf16 v46, v250, v250, v46
    v_dot2_f32_bf16 v43, v254, s46, v43
    v_dot2_f32_bf16 v47, v254, v254, v47
    v_dot2_f32_bf16 v42, v251, s46, v42
    v_dot2_f32_bf16 v46, v251, v251, v46
    v_dot2_f32_bf16 v43, v255, s46, v43
    v_dot2_f32_bf16 v47, v255, v255, v47
    s_cmp_ge_u32 s2, 64
    s_cbranch_scc1 F_W3F
    v_mov_b32 v48, 1
    v_mov_b32 v49, 0
    s_lshl_b32 s56, s2, 2
    s_waitcnt vmcnt(0)
    s_mov_b64 exec, 1
    buffer_store_dword v48, v49, s[36:39], s56 offen sc1
    s_mov_b64 exec, -1
F_W3F:
    v_lshlrev_b32 v12, 7, v1
    s_mov_b32 s67, 0x00020000
    s_mov_b64 exec, 0xffff
    v_lshrrev_b32 v13, 3, v1
    v_mul_u32_u24 v13, 2048, v13
    v_add_u32 v13, v13, v12
    s_mul_i32 s56, s2, 6144
    buffer_load_dword v50, v13, s[24:27], s56 offen
    s_mov_b32 s64, s8
    s_and_b32 s65, s9, 0xffff
    s_mov_b32 s66, 512*2752
    s_mul_i32 s56, s2, 5504
    s_mov_b32 exec_lo, -1
    s_mov_b32 exec_hi, 2047
    buffer_load_dword v51, v12, s[64:67], s56 offen
    s_mov_b64 exec, -1
    v_lshlrev_b32 v64, 16, v192
    v_and_b32 v65, 0xffff0000, v192
    v_lshlrev_b32 v66, 16, v193
    v_and_b32 v67, 0xffff0000, v193
    v_permlane32_swap_b32 v16, v32
    v_permlane32_swap_b32 v17, v33
    v_permlane32_swap_b32 v18, v34
    v_permlane32_swap_b32 v19, v35
    v_permlane32_swap_b32 v20, v36
    v_permlane32_swap_b32 v21, v37
    v_permlane32_swap_b32 v22, v38
    v_permlane32_swap_b32 v23, v39
    v_permlane32_swap_b32 v24, v40
    v_permlane32_swap_b32 v25, v41
    v_permlane32_swap_b32 v26, v42
    v_permlane32_swap_b32 v27, v43
    v_permlane32_swap_b32 v28, v44
    v_permlane32_swap_b32 v29, v45
    v_permlane32_swap_b32 v30, v46
    v_permlane32_swap_b32 v31, v47
    v_lshlrev_b32 v68, 16, v194
    v_and_b32 v69, 0xffff0000, v194
    v_add_f32 v16, v16, v32
    v_add_f32 v17, v17, v33
    v_add_f32 v18, v18, v34
    v_add_f32 v19, v19, v35
    v_add_f32 v20, v20, v36
    v_add_f32 v21, v21, v37
    v_add_f32 v22, v22, v38
    v_add_f32 v23, v23, v39
    v_add_f32 v24, v24, v40
    v_add_f32 v25, v25, v41
    v_add_f32 v26, v26, v42
    v_add_f32 v27, v27, v43
    v_add_f32 v28, v28, v44
    v_add_f32 v29, v29, v45
    v_add_f32 v30, v30, v46
    v_add_f32 v31, v31, v47
    v_lshlrev_b32 v70, 16, v195
    v_and_b32 v71, 0xffff0000, v195
    v_permlane16_swap_b32 v16, v24
    v_permlane16_swap_b32 v17, v25
    v_permlane16_swap_b32 v18, v26
    v_permlane16_swap_b32 v19, v27
    v_permlane16_swap_b32 v20, v28
    v_permlane16_swap_b32 v21, v29
    v_permlane16_swap_b32 v22, v30
    v_permlane16_swap_b32 v23, v31
    v_lshlrev_b32 v72, 16, v196
    v_and_b32 v73, 0xffff0000, v196
    v_add_f32 v16, v16, v24
    v_add_f32 v17, v17, v25
    v_add_f32 v18, v18, v26
    v_add_f32 v19, v19, v27
    v_add_f32 v20, v20, v28
    v_add_f32 v21, v21, v29
    v_add_f32 v22, v22, v30
    v_add_f32 v23, v23, v31
    v_lshlrev_b32 v74, 16, v197
    v_and_b32 v75, 0xffff0000, v197
    v_add_f32_dpp v16, v16, v16 row_ror:8 row_mask:0xf bank_mask:0xf
    v_add_f32_dpp v17, v17, v17 row_ror:8 row_mask:0xf bank_mask:0xf
    v_add_f32_dpp v18, v18, v18 row_ror:8 row_mask:0xf bank_mask:0xf
    v_add_f32_dpp v19, v19, v19 row_ror:8 row_mask:0xf bank_mask:0xf
    v_add_f32_dpp v20, v20, v20 row_ror:8 row_mask:0xf bank_mask:0xf
    v_add_f32_dpp v21, v21, v21 row_ror:8 row_mask:0xf bank_mask:0xf
    v_add_f32_dpp v22, v22, v22 row_ror:8 row_mask:0xf bank_mask:0xf
    v_add_f32_dpp v23, v23, v23 row_ror:8 row_mask:0xf bank_mask:0xf
    v_lshlrev_b32 v76, 16, v198
    v_and_b32 v77, 0xffff0000, v198
    v_add_f32_dpp v16, v16, v16 row_ror:4 row_mask:0xf bank_mask:0xf
    v_add_f32_dpp v17, v17, v17 row_ror:4 row_mask:0xf bank_mask:0xf
    v_add_f32_dpp v18, v18, v18 row_ror:4 row_mask:0xf bank_mask:0xf
    v_add_f32_dpp v19, v19, v19 row_ror:4 row_mask:0xf bank_mask:0xf
    v_add_f32_dpp v20, v20, v20 row_ror:4 row_mask:0xf bank_mask:0xf
    v_add_f32_dpp v21, v21, v21 row_ror:4 row_mask:0xf bank_mask:0xf
    v_add_f32_dpp v22, v22, v22 row_ror:4 row_mask:0xf bank_mask:0xf
    v_add_f32_dpp v23, v23, v23 row_ror:4 row_mask:0xf bank_mask:0xf
    v_lshlrev_b32 v78, 16, v199
    v_and_b32 v79, 0xffff0000, v199
    v_add_f32_dpp v16, v16, v16 row_ror:2 row_mask:0xf bank_mask:0xf
    v_add_f32_dpp v17, v17, v17 row_ror:2 row_mask:0xf bank_mask:0xf
    v_add_f32_dpp v18, v18, v18 row_ror:2 row_mask:0xf bank_mask:0xf
    v_add_f32_dpp v19, v19, v19 row_ror:2 row_mask:0xf bank_mask:0xf
    v_add_f32_dpp v20, v20, v20 row_ror:2 row_mask:0xf bank_mask:0xf
    v_add_f32_dpp v21, v21, v21 row_ror:2 row_mask:0xf bank_mask:0xf
    v_add_f32_dpp v22, v22, v22 row_ror:2 row_mask:0xf bank_mask:0xf
    v_add_f32_dpp v23, v23, v23 row_ror:2 row_mask:0xf bank_mask:0xf
    v_lshlrev_b32 v80, 16, v200
    v_and_b32 v81, 0xffff0000, v200
    v_add_f32_dpp v16, v16, v16 row_ror:1 row_mask:0xf bank_mask:0xf
    v_add_f32_dpp v17, v17, v17 row_ror:1 row_mask:0xf bank_mask:0xf
    v_add_f32_dpp v18, v18, v18 row_ror:1 row_mask:0xf bank_mask:0xf
    v_add_f32_dpp v19, v19, v19 row_ror:1 row_mask:0xf bank_mask:0xf
    v_add_f32_dpp v20, v20, v20 row_ror:1 row_mask:0xf bank_mask:0xf
    v_add_f32_dpp v21, v21, v21 row_ror:1 row_mask:0xf bank_mask:0xf
    v_add_f32_dpp v22, v22, v22 row_ror:1 row_mask:0xf bank_mask:0xf
    v_add_f32_dpp v23, v23, v23 row_ror:1 row_mask:0xf bank_mask:0xf
    v_lshlrev_b32 v82, 16, v201
    v_and_b32 v83, 0xffff0000, v201
    v_mul_f32 v16, 0x3b000000, v16
    v_mul_f32 v20, 0x3b000000, v20
    v_mul_f32 v17, 0x3b000000, v17
    v_mul_f32 v21, 0x3b000000, v21
    v_mul_f32 v18, 0x3b000000, v18
    v_mul_f32 v22, 0x3b000000, v22
    v_mul_f32 v19, 0x3b000000, v19
    v_mul_f32 v23, 0x3b000000, v23
    v_fma_f32 v20, -v16, v16, v20
    v_fma_f32 v21, -v17, v17, v21
    v_fma_f32 v22, -v18, v18, v22
    v_fma_f32 v23, -v19, v19, v23
    v_max_f32 v20, 0, v20
    v_max_f32 v21, 0, v21
    v_max_f32 v22, 0, v22
    v_max_f32 v23, 0, v23
    v_add_f32 v20, 0x3727c5ac, v20
    v_add_f32 v21, 0x3727c5ac, v21
    v_add_f32 v22, 0x3727c5ac, v22
    v_add_f32 v23, 0x3727c5ac, v23
    v_rsq_f32 v20, v20
    v_rsq_f32 v21, v21
    v_rsq_f32 v22, v22
    v_rsq_f32 v23, v23
    v_lshlrev_b32 v84, 16, v202
    v_and_b32 v85, 0xffff0000, v202
    v_mul_f32 v16, v16, v20
    v_mul_f32 v17, v17, v21
    v_mul_f32 v18, v18, v22
    v_mul_f32 v19, v19, v23
    v_sub_f32 v16, 0, v16
    v_sub_f32 v17, 0, v17
    v_sub_f32 v18, 0, v18
    v_sub_f32 v19, 0, v19
    v_lshlrev_b32 v86, 16, v203
    v_and_b32 v87, 0xffff0000, v203
    v_lshlrev_b32 v88, 16, v204
    v_and_b32 v89, 0xffff0000, v204
    v_lshlrev_b32 v90, 16, v205
    v_and_b32 v91, 0xffff0000, v205
    v_lshlrev_b32 v92, 16, v206
    v_and_b32 v93, 0xffff0000, v206
    v_lshlrev_b32 v94, 16, v207
    v_and_b32 v95, 0xffff0000, v207
    v_lshlrev_b32 v96, 16, v208
    v_and_b32 v97, 0xffff0000, v208
    v_lshlrev_b32 v98, 16, v209
    v_and_b32 v99, 0xffff0000, v209
    v_lshlrev_b32 v100, 16, v210
    v_and_b32 v101, 0xffff0000, v210
    v_lshlrev_b32 v102, 16, v211
    v_and_b32 v103, 0xffff0000, v211
    v_lshlrev_b32 v104, 16, v212
    v_and_b32 v105, 0xffff0000, v212
    v_lshlrev_b32 v106, 16, v213
    v_and_b32 v107, 0xffff0000, v213
    v_lshlrev_b32 v108, 16, v214
    v_and_b32 v109, 0xffff0000, v214
    v_lshlrev_b32 v110, 16, v215
    v_and_b32 v111, 0xffff0000, v215
    v_lshlrev_b32 v112, 16, v216
    v_and_b32 v113, 0xffff0000, v216
    v_lshlrev_b32 v114, 16, v217
    v_and_b32 v115, 0xffff0000, v217
    v_lshlrev_b32 v116, 16, v218
    v_and_b32 v117, 0xffff0000, v218
    v_lshlrev_b32 v118, 16, v219
    v_and_b32 v119, 0xffff0000, v219
    v_lshlrev_b32 v120, 16, v220
    v_and_b32 v121, 0xffff0000, v220
    v_lshlrev_b32 v122, 16, v221
    v_and_b32 v123, 0xffff0000, v221
    v_lshlrev_b32 v124, 16, v222
    v_and_b32 v125, 0xffff0000, v222
    v_lshlrev_b32 v126, 16, v223
    v_and_b32 v127, 0xffff0000, v223
    v_lshlrev_b32 v128, 16, v224
    v_and_b32 v129, 0xffff0000, v224
    v_lshlrev_b32 v130, 16, v225
    v_and_b32 v131, 0xffff0000, v225
    v_lshlrev_b32 v132, 16, v226
    v_and_b32 v133, 0xffff0000, v226
    v_lshlrev_b32 v134, 16, v227
    v_and_b32 v135, 0xffff0000, v227
    v_lshlrev_b32 v136, 16, v228
    v_and_b32 v137, 0xffff0000, v228
    v_lshlrev_b32 v138, 16, v229
    v_and_b32 v139, 0xffff0000, v229
    v_lshlrev_b32 v140, 16, v230
    v_and_b32 v141, 0xffff0000, v230
    v_lshlrev_b32 v142, 16, v231
    v_and_b32 v143, 0xffff0000, v231
    v_lshlrev_b32 v144, 16, v232
    v_and_b32 v145, 0xffff0000, v232
    v_lshlrev_b32 v146, 16, v233
    v_and_b32 v147, 0xffff0000, v233
    v_lshlrev_b32 v148, 16, v234
    v_and_b32 v149, 0xffff0000, v234
    v_lshlrev_b32 v150, 16, v235
    v_and_b32 v151, 0xffff0000, v235
    v_lshlrev_b32 v152, 16, v236
    v_and_b32 v153, 0xffff0000, v236
    v_lshlrev_b32 v154, 16, v237
    v_and_b32 v155, 0xffff0000, v237
    v_lshlrev_b32 v156, 16, v238
    v_and_b32 v157, 0xffff0000, v238
    v_lshlrev_b32 v158, 16, v239
    v_and_b32 v159, 0xffff0000, v239
    v_lshlrev_b32 v160, 16, v240
    v_and_b32 v161, 0xffff0000, v240
    v_lshlrev_b32 v162, 16, v241
    v_and_b32 v163, 0xffff0000, v241
    v_lshlrev_b32 v164, 16, v242
    v_and_b32 v165, 0xffff0000, v242
    v_lshlrev_b32 v166, 16, v243
    v_and_b32 v167, 0xffff0000, v243
    v_lshlrev_b32 v168, 16, v244
    v_and_b32 v169, 0xffff0000, v244
    v_lshlrev_b32 v170, 16, v245
    v_and_b32 v171, 0xffff0000, v245
    v_lshlrev_b32 v172, 16, v246
    v_and_b32 v173, 0xffff0000, v246
    v_lshlrev_b32 v174, 16, v247
    v_and_b32 v175, 0xffff0000, v247
    v_lshlrev_b32 v176, 16, v248
    v_and_b32 v177, 0xffff0000, v248
    v_lshlrev_b32 v178, 16, v249
    v_and_b32 v179, 0xffff0000, v249
    v_lshlrev_b32 v180, 16, v250
    v_and_b32 v181, 0xffff0000, v250
    v_lshlrev_b32 v182, 16, v251
    v_and_b32 v183, 0xffff0000, v251
    v_lshlrev_b32 v184, 16, v252
    v_and_b32 v185, 0xffff0000, v252
    v_lshlrev_b32 v186, 16, v253
    v_and_b32 v187, 0xffff0000, v253
    v_lshlrev_b32 v188, 16, v254
    v_and_b32 v189, 0xffff0000, v254
    v_lshlrev_b32 v190, 16, v255
    v_and_b32 v191, 0xffff0000, v255
    v_lshlrev_b32 v12, 7, v1
    s_mov_b32 s67, 0x00020000
    s_mov_b64 exec, 0xffff
    s_mov_b32 s64, s12
    s_and_b32 s65, s13, 0xffff
    s_mov_b32 s66, 512*1024
    s_lshl_b32 s56, s2, 11
    buffer_load_dword v50, v12, s[64:67], s56 offen
    s_mov_b32 s64, s10
    s_and_b32 s65, s11, 0xffff
    s_mov_b32 s66, 512*2752
    s_mul_i32 s56, s2, 5504
    s_mov_b32 exec_lo, -1
    s_mov_b32 exec_hi, 2047
    buffer_load_dword v51, v12, s[64:67], s56 offen
    s_mov_b64 exec, -1
    s_add_u32 s55, s68, 0
    buffer_load_dwordx4 a[0:3], v60, s[32:35], s55 offen nt
    s_add_u32 s55, s68, 196608
    buffer_load_dwordx4 a[12:15], v60, s[32:35], s55 offen nt
    s_add_u32 s55, s68, 393216
    buffer_load_dwordx4 a[24:27], v60, s[32:35], s55 offen nt
    s_add_u32 s55, s68, 589824
    buffer_load_dwordx4 a[36:39], v60, s[32:35], s55 offen nt
    s_mov_b64 exec, 0
    s_branch PG80
PW_S2:
    s_mov_b64 exec, -1
F_J:
    v_lshlrev_b32 v12, 7, v2
    v_lshl_add_u32 v12, v5, 1, v12
    s_lshl_b32 s44, s7, 2
    s_add_u32 s44, s44, s3
    s_lshl_b32 s44, s44, 9
    buffer_load_ushort v56, v12, s[28:31], s44 offen offset:0
    buffer_load_ushort v57, v12, s[28:31], s44 offen offset:32
    buffer_load_ushort v58, v12, s[28:31], s44 offen offset:64
    buffer_load_ushort v59, v12, s[28:31], s44 offen offset:96
    s_mov_b32 s44, s48
    v_lshlrev_b32 v11, 10, v2
    v_lshl_add_u32 v11, v3, 7, v11
    v_lshl_add_u32 v11, v4, 3, v11
    v_and_b32 v12, 1, v2
    v_xor_b32 v12, v12, v3
    v_xor_b32 v12, s3, v12
    v_lshl_add_u32 v7, v12, 5, v11
    v_add_u32 v12, 65536, v7
    s_waitcnt vmcnt(26)
    s_barrier
    ds_read_b64_tr_b16 a[4:5], v7 offset:0
    v_readlane_b32 s8, v20, 0
    v_readlane_b32 s9, v16, 0
    ds_read_b64_tr_b16 a[6:7], v7 offset:512
    v_mov_b32 v24, s9
    v_pk_fma_f32 v[64:65], v[64:65], s[8:9], v[24:25] op_sel_hi:[1,0,0]
    ds_read_b64_tr_b16 a[8:9], v7 offset:4096
    v_pk_fma_f32 v[66:67], v[66:67], s[8:9], v[24:25] op_sel_hi:[1,0,0]
    v_pk_fma_f32 v[68:69], v[68:69], s[8:9], v[24:25] op_sel_hi:[1,0,0]
    ds_read_b64_tr_b16 a[10:11], v7 offset:4608
    v_pk_fma_f32 v[70:71], v[70:71], s[8:9], v[24:25] op_sel_hi:[1,0,0]
    ds_read_b64_tr_b16 a[16:17], v7 offset:8192
    v_readlane_b32 s10, v21, 0
    v_readlane_b32 s11, v17, 0
    ds_read_b64_tr_b16 a[18:19], v7 offset:8704
    v_mov_b32 v26, s11
    v_pk_fma_f32 v[72:73], v[72:73], s[10:11], v[26:27] op_sel_hi:[1,0,0]
    ds_read_b64_tr_b16 a[20:21], v7 offset:12288
    v_pk_fma_f32 v[74:75], v[74:75], s[10:11], v[26:27] op_sel_hi:[1,0,0]
    v_pk_fma_f32 v[76:77], v[76:77], s[10:11], v[26:27] op_sel_hi:[1,0,0]
    ds_read_b64_tr_b16 a[22:23], v7 offset:12800
    v_pk_fma_f32 v[78:79], v[78:79], s[10:11], v[26:27] op_sel_hi:[1,0,0]
    ds_read_b64_tr_b16 a[28:29], v7 offset:16384
    v_readlane_b32 s12, v22, 0
    v_readlane_b32 s13, v18, 0
    ds_read_b64_tr_b16 a[30:31], v7 offset:16896
    v_mov_b32 v24, s13
    v_pk_fma_f32 v[80:81], v[80:81], s[12:13], v[24:25] op_sel_hi:[1,0,0]
    ds_read_b64_tr_b16 a[32:33], v7 offset:20480
    v_pk_fma_f32 v[82:83], v[82:83], s[12:13], v[24:25] op_sel_hi:[1,0,0]
    v_pk_fma_f32 v[84:85], v[84:85], s[12:13], v[24:25] op_sel_hi:[1,0,0]
    ds_read_b64_tr_b16 a[34:35], v7 offset:20992
    v_pk_fma_f32 v[86:87], v[86:87], s[12:13], v[24:25] op_sel_hi:[1,0,0]
    ds_read_b64_tr_b16 a[40:41], v7 offset:24576
    v_readlane_b32 s14, v23, 0
    v_readlane_b32 s15, v19, 0
    ds_read_b64_tr_b16 a[42:43], v7 offset:25088
    v_mov_b32 v26, s15
    v_pk_fma_f32 v[88:89], v[88:89], s[14:15], v[26:27] op_sel_hi:[1,0,0]
    ds_read_b64_tr_b16 a[44:45], v7 offset:28672
    v_pk_fma_f32 v[90:91], v[90:91], s[14:15], v[26:27] op_sel_hi:[1,0,0]
    v_pk_fma_f32 v[92:93], v[92:93], s[14:15], v[26:27] op_sel_hi:[1,0,0]
    ds_read_b64_tr_b16 a[46:47], v7 offset:29184
    v_pk_fma_f32 v[94:95], v[94:95], s[14:15], v[26:27] op_sel_hi:[1,0,0]
    ds_read_b64_tr_b16 a[52:53], v7 offset:32768
    v_readlane_b32 s8, v20, 16
    v_readlane_b32 s9, v16, 16
    ds_read_b64_tr_b16 a[54:55], v7 offset:33280
    v_mov_b32 v24, s9
    v_pk_fma_f32 v[96:97], v[96:97], s[8:9], v[24:25] op_sel_hi:[1,0,0]
    ds_read_b64_tr_b16 a[56:57], v7 offset:36864
    v_pk_fma_f32 v[98:99], v[98:99], s[8:9], v[24:25] op_sel_hi:[1,0,0]
    v_pk_fma_f32 v[100:101], v[100:101], s[8:9], v[24:25] op_sel_hi:[1,0,0]
    ds_read_b64_tr_b16 a[58:59], v7 offset:37376
    v_pk_fma_f32 v[102:103], v[102:103], s[8:9], v[24:25] op_sel_hi:[1,0,0]
    ds_read_b64_tr_b16 a[64:65], v7 offset:40960
    v_readlane_b32 s10, v21, 16
    v_readlane_b32 s11, v17, 16
    ds_read_b64_tr_b16 a[66:67], v7 offset:41472
    v_mov_b32 v26, s11
    v_pk_fma_f32 v[104:105], v[104:105], s[10:11], v[26:27] op_sel_hi:[1,0,0]
    ds_read_b64_tr_b16 a[68:69], v7 offset:45056
    v_pk_fma_f32 v[106:107], v[106:107], s[10:11], v[26:27] op_sel_hi:[1,0,0]
    v_pk_fma_f32 v[108:109], v[108:109], s[10:11], v[26:27] op_sel_hi:[1,0,0]
    ds_read_b64_tr_b16 a[70:71], v7 offset:45568
    v_pk_fma_f32 v[110:111], v[110:111], s[10:11], v[26:27] op_sel_hi:[1,0,0]
    ds_read_b64_tr_b16 a[76:77], v7 offset:49152
    v_readlane_b32 s12, v22, 16
    v_readlane_b32 s13, v18, 16
    ds_read_b64_tr_b16 a[78:79], v7 offset:49664
    v_mov_b32 v24, s13
    v_pk_fma_f32 v[112:113], v[112:113], s[12:13], v[24:25] op_sel_hi:[1,0,0]
    ds_read_b64_tr_b16 a[80:81], v7 offset:53248
    v_pk_fma_f32 v[114:115], v[114:115], s[12:13], v[24:25] op_sel_hi:[1,0,0]
    v_pk_fma_f32 v[116:117], v[116:117], s[12:13], v[24:25] op_sel_hi:[1,0,0]
    ds_read_b64_tr_b16 a[82:83], v7 offset:53760
    v_pk_fma_f32 v[118:119], v[118:119], s[12:13], v[24:25] op_sel_hi:[1,0,0]
    ds_read_b64_tr_b16 a[88:89], v7 offset:57344
    v_readlane_b32 s14, v23, 16
    v_readlane_b32 s15, v19, 16
    ds_read_b64_tr_b16 a[90:91], v7 offset:57856
    v_mov_b32 v26, s15
    v_pk_fma_f32 v[120:121], v[120:121], s[14:15], v[26:27] op_sel_hi:[1,0,0]
    ds_read_b64_tr_b16 a[92:93], v7 offset:61440
    v_pk_fma_f32 v[122:123], v[122:123], s[14:15], v[26:27] op_sel_hi:[1,0,0]
    v_pk_fma_f32 v[124:125], v[124:125], s[14:15], v[26:27] op_sel_hi:[1,0,0]
    ds_read_b64_tr_b16 a[94:95], v7 offset:61952
    v_pk_fma_f32 v[126:127], v[126:127], s[14:15], v[26:27] op_sel_hi:[1,0,0]
    s_cmp_eq_u32 s3, 3
    s_cbranch_scc1 F_H1
    s_waitcnt vmcnt(8)
F_H1:
    s_barrier
    ds_read_b64_tr_b16 a[100:101], v12 offset:0
    v_readlane_b32 s8, v20, 32
    v_readlane_b32 s9, v16, 32
    ds_read_b64_tr_b16 a[102:103], v12 offset:512
    v_mov_b32 v24, s9
    v_pk_fma_f32 v[128:129], v[128:129], s[8:9], v[24:25] op_sel_hi:[1,0,0]
    ds_read_b64_tr_b16 a[104:105], v12 offset:4096
    v_pk_fma_f32 v[130:131], v[130:131], s[8:9], v[24:25] op_sel_hi:[1,0,0]
    v_pk_fma_f32 v[132:133], v[132:133], s[8:9], v[24:25] op_sel_hi:[1,0,0]
    ds_read_b64_tr_b16 a[106:107], v12 offset:4608
    v_pk_fma_f32 v[134:135], v[134:135], s[8:9], v[24:25] op_sel_hi:[1,0,0]
    ds_read_b64_tr_b16 a[112:113], v12 offset:8192
    v_readlane_b32 s10, v21, 32
    v_readlane_b32 s11, v17, 32
    ds_read_b64_tr_b16 a[114:115], v12 offset:8704
    v_mov_b32 v26, s11
    v_pk_fma_f32 v[136:137], v[136:137], s[10:11], v[26:27] op_sel_hi:[1,0,0]
    ds_read_b64_tr_b16 a[116:117], v12 offset:12288
    v_pk_fma_f32 v[138:139], v[138:139], s[10:11], v[26:27] op_sel_hi:[1,0,0]
    v_pk_fma_f32 v[140:141], v[140:141], s[10:11], v[26:27] op_sel_hi:[1,0,0]
    ds_read_b64_tr_b16 a[118:119], v12 offset:12800
    v_pk_fma_f32 v[142:143], v[142:143], s[10:11], v[26:27] op_sel_hi:[1,0,0]
    ds_read_b64_tr_b16 a[124:125], v12 offset:16384
    v_readlane_b32 s12, v22, 32
    v_readlane_b32 s13, v18, 32
    ds_read_b64_tr_b16 a[126:127], v12 offset:16896
    v_mov_b32 v24, s13
    v_pk_fma_f32 v[144:145], v[144:145], s[12:13], v[24:25] op_sel_hi:[1,0,0]
    ds_read_b64_tr_b16 a[128:129], v12 offset:20480
    v_pk_fma_f32 v[146:147], v[146:147], s[12:13], v[24:25] op_sel_hi:[1,0,0]
    v_pk_fma_f32 v[148:149], v[148:149], s[12:13], v[24:25] op_sel_hi:[1,0,0]
    ds_read_b64_tr_b16 a[130:131], v12 offset:20992
    v_pk_fma_f32 v[150:151], v[150:151], s[12:13], v[24:25] op_sel_hi:[1,0,0]
    ds_read_b64_tr_b16 a[136:137], v12 offset:24576
    v_readlane_b32 s14, v23, 32
    v_readlane_b32 s15, v19, 32
    ds_read_b64_tr_b16 a[138:139], v12 offset:25088
    v_mov_b32 v26, s15
    v_pk_fma_f32 v[152:153], v[152:153], s[14:15], v[26:27] op_sel_hi:[1,0,0]
    ds_read_b64_tr_b16 a[140:141], v12 offset:28672
    v_pk_fma_f32 v[154:155], v[154:155], s[14:15], v[26:27] op_sel_hi:[1,0,0]
    v_pk_fma_f32 v[156:157], v[156:157], s[14:15], v[26:27] op_sel_hi:[1,0,0]
    ds_read_b64_tr_b16 a[142:143], v12 offset:29184
    v_pk_fma_f32 v[158:159], v[158:159], s[14:15], v[26:27] op_sel_hi:[1,0,0]
    ds_read_b64_tr_b16 a[148:149], v12 offset:32768
    v_readlane_b32 s8, v20, 48
    v_readlane_b32 s9, v16, 48
    ds_read_b64_tr_b16 a[150:151], v12 offset:33280
PG48:
    s_cbranch_execz PW_S1
    v_mov_b32 v24, s9
    v_pk_fma_f32 v[160:161], v[160:161], s[8:9], v[24:25] op_sel_hi:[1,0,0]
    ds_read_b64_tr_b16 a[152:153], v12 offset:36864
    v_pk_fma_f32 v[162:163], v[162:163], s[8:9], v[24:25] op_sel_hi:[1,0,0]
    v_pk_fma_f32 v[164:165], v[164:165], s[8:9], v[24:25] op_sel_hi:[1,0,0]
    ds_read_b64_tr_b16 a[154:155], v12 offset:37376
    v_pk_fma_f32 v[166:167], v[166:167], s[8:9], v[24:25] op_sel_hi:[1,0,0]
    ds_read_b64_tr_b16 a[160:161], v12 offset:40960
    v_readlane_b32 s10, v21, 48
    v_readlane_b32 s11, v17, 48
    ds_read_b64_tr_b16 a[162:163], v12 offset:41472
    v_mov_b32 v26, s11
    v_pk_fma_f32 v[168:169], v[168:169], s[10:11], v[26:27] op_sel_hi:[1,0,0]
    ds_read_b64_tr_b16 a[164:165], v12 offset:45056
    v_pk_fma_f32 v[170:171], v[170:171], s[10:11], v[26:27] op_sel_hi:[1,0,0]
    v_pk_fma_f32 v[172:173], v[172:173], s[10:11], v[26:27] op_sel_hi:[1,0,0]
    ds_read_b64_tr_b16 a[166:167], v12 offset:45568
    v_pk_fma_f32 v[174:175], v[174:175], s[10:11], v[26:27] op_sel_hi:[1,0,0]
    ds_read_b64_tr_b16 a[172:173], v12 offset:49152
    v_readlane_b32 s12, v22, 48
    v_readlane_b32 s13, v18, 48
    ds_read_b64_tr_b16 a[174:175], v12 offset:49664
    v_mov_b32 v24, s13
    v_pk_fma_f32 v[176:177], v[176:177], s[12:13], v[24:25] op_sel_hi:[1,0,0]
    ds_read_b64_tr_b16 a[176:177], v12 offset:53248
    v_pk_fma_f32 v[178:179], v[178:179], s[12:13], v[24:25] op_sel_hi:[1,0,0]
    v_pk_fma_f32 v[180:181], v[180:181], s[12:13], v[24:25] op_sel_hi:[1,0,0]
    ds_read_b64_tr_b16 a[178:179], v12 offset:53760
    v_pk_fma_f32 v[182:183], v[182:183], s[12:13], v[24:25] op_sel_hi:[1,0,0]
    ds_read_b64_tr_b16 a[184:185], v12 offset:57344
    v_readlane_b32 s14, v23, 48
    v_readlane_b32 s15, v19, 48
    ds_read_b64_tr_b16 a[186:187], v12 offset:57856
    v_mov_b32 v26, s15
    v_pk_fma_f32 v[184:185], v[184:185], s[14:15], v[26:27] op_sel_hi:[1,0,0]
    ds_read_b64_tr_b16 a[188:189], v12 offset:61440
    v_pk_fma_f32 v[186:187], v[186:187], s[14:15], v[26:27] op_sel_hi:[1,0,0]
    v_pk_fma_f32 v[188:189], v[188:189], s[14:15], v[26:27] op_sel_hi:[1,0,0]
    ds_read_b64_tr_b16 a[190:191], v12 offset:61952
    v_pk_fma_f32 v[190:191], v[190:191], s[14:15], v[26:27] op_sel_hi:[1,0,0]
    s_load_dwordx2 s[8:9], s[0:1], 24
    s_load_dwordx4 s[16:19], s[0:1], 40
    s_load_dwordx2 s[10:11], s[0:1], 56
    s_cmp_lg_u32 s3, 0
    s_cbranch_scc1 F_PW
    v_lshlrev_b32 v12, 2, v1
    s_mov_b32 s48, 0
F_PP:
    buffer_load_dword v13, v12, s[36:39], 0 offen sc1
    s_add_u32 s48, s48, 1
    s_cmp_gt_u32 s48, 400000
    s_cbranch_scc1 F_PW
    s_waitcnt vmcnt(0)
    v_cmp_ne_u32 vcc, 1, v13
    s_cbranch_vccz F_PW
    s_sleep 4
    s_branch F_PP
F_PW:
    v_lshrrev_b32 v12, 5, v1
    v_and_b32 v13, 31, v1
    v_lshlrev_b32 v12, 11, v12
    v_lshl_add_u32 v12, v13, 4, v12
    s_waitcnt lgkmcnt(0)
    s_barrier
    s_lshl_b32 s48, s3, 9
    buffer_load_dwordx4 v[192:195], v12, s[40:43], s48 offen
    s_add_u32 s48, s48, 12288
    buffer_load_dwordx4 v[196:199], v12, s[40:43], s48 offen
    s_add_u32 s48, s48, 12288
    buffer_load_dwordx4 v[200:203], v12, s[40:43], s48 offen
    s_add_u32 s48, s48, 12288
    buffer_load_dwordx4 v[204:207], v12, s[40:43], s48 offen
    s_mov_b32 s64, s10
    s_and_b32 s65, s11, 0xffff
    s_mov_b32 s66, 512*2752
    s_mov_b32 s67, 0x00020000
    s_mul_i32 s52, s2, 5504
    s_mul_i32 s53, s3, 1408
    s_add_u32 s52, s52, s53
    s_mov_b64 exec, 0x7ff
    v_lshlrev_b32 v13, 7, v1
    buffer_load_dword v63, v13, s[64:67], s52 offen
    s_mov_b64 exec, -1
    s_lshl_b32 s49, s3, 10
    v_and_b32 v13, 7, v1
    s_lshl_b32 s48, s3, 14
    s_add_u32 s48, s48, 65536
    v_lshlrev_b32 v10, 8, v1
    v_lshl_add_u32 v10, v13, 4, v10
    v_add_u32 v10, s48, v10
    s_lshl_b32 s48, s7, 5
    v_xor_b32 v10, s48, v10
    v_xor_b32 v11, v5, v2
    v_lshlrev_b32 v11, 4, v11
    v_lshl_add_u32 v11, v2, 8, v11
    v_add_u32 v11, 65536, v11
    v_xor_b32 v13, 64, v11
    s_and_b32 s48, s2, 7
    s_lshr_b32 s50, s2, 3
    s_lshl_b32 s33, s48, 1
    s_cmp_ge_u32 s50, 15
    s_cselect_b32 s32, 1, 0
    s_add_u32 s33, s33, s32
    s_mul_i32 s32, s32, 15
    s_sub_u32 s32, s50, s32
    s_sub_u32 s48, s2, 240
    s_min_u32 s48, s48, 14
    s_cmp_ge_u32 s2, 240
    s_cselect_b32 s32, s48, s32
    s_and_b32 s48, s3, 1
    s_mul_i32 s34, s48, 16*2752
    s_mul_i32 s50, s32, 192
    s_add_u32 s34, s34, s50
    s_mul_i32 s35, s3, 3072
    v_add_u32 v12, 0, v1
    v_mul_u32_u24 v16, 43691, v12
    v_lshrrev_b32 v16, 19, v16
    v_mul_u32_u24 v17, 12, v16
    v_sub_u32 v12, v12, v17
    v_bfe_u32 v17, v16, 2, 1
    v_lshlrev_b32 v17, 1, v17
    v_xor_b32 v12, v12, v17
    v_mul_u32_u24 v60, 2752, v16
    v_lshl_add_u32 v60, v12, 4, v60
    v_add_u32 v12, 64, v1
    v_mul_u32_u24 v16, 43691, v12
    v_lshrrev_b32 v16, 19, v16
    v_mul_u32_u24 v17, 12, v16
    v_sub_u32 v12, v12, v17
    v_bfe_u32 v17, v16, 2, 1
    v_lshlrev_b32 v17, 1, v17
    v_xor_b32 v12, v12, v17
    v_mul_u32_u24 v61, 2752, v16
    v_lshl_add_u32 v61, v12, 4, v61
    v_add_u32 v12, 128, v1
    v_mul_u32_u24 v16, 43691, v12
    v_lshrrev_b32 v16, 19, v16
    v_mul_u32_u24 v17, 12, v16
    v_sub_u32 v12, v12, v17
    v_bfe_u32 v17, v16, 2, 1
    v_lshlrev_b32 v17, 1, v17
    v_xor_b32 v12, v12, v17
    v_mul_u32_u24 v62, 2752, v16
    v_lshl_add_u32 v62, v12, 4, v62
    s_waitcnt lgkmcnt(0)
    s_cmp_ge_u32 s3, 2
    s_cselect_b32 s28, s18, s16
    s_cselect_b32 s29, s19, s17
    s_and_b32 s29, s29, 0xffff
    s_mov_b32 s30, 512*2752
    s_mov_b32 s31, 0x00020000
    v_lshrrev_b32 v16, 5, v1
    v_and_b32 v17, 1, v1
    v_bfe_u32 v18, v1, 1, 4
    v_lshlrev_b32 v12, 11, v16
    v_lshl_add_u32 v12, v17, 10, v12
    v_lshl_add_u32 v12, v18, 4, v12
    s_lshl_b32 s48, s3, 8
    s_add_u32 s48, s48, 131072
    v_add_u32 v12, s48, v12
    v_cvt_f32_u32 v16, v16
    v_add_u32 v17, 131072, v8
    s_waitcnt vmcnt(1)
    v_lshl_or_b32 v14, v57, 16, v56
    v_lshl_or_b32 v15, v59, 16, v58
    v_pk_add_f32 v[192:193], v[192:193], v[196:197]
    v_pk_add_f32 v[200:201], v[200:201], v[204:205]
    v_pk_add_f32 v[194:195], v[194:195], v[198:199]
    v_pk_add_f32 v[202:203], v[202:203], v[206:207]
    v_pk_add_f32 v[192:193], v[192:193], v[200:201]
    v_pk_add_f32 v[194:195], v[194:195], v[202:203]
    v_cvt_pk_bf16_f32 v192, v192, v193
    v_cvt_pk_bf16_f32 v194, v194, v195
    v_and_b32 v193, 0xffff0000, v192
    v_lshlrev_b32 v192, 16, v192
    v_and_b32 v195, 0xffff0000, v194
    v_lshlrev_b32 v194, 16, v194
    v_add_f32 v192, v192, v16
    v_add_f32 v193, v193, v16
    v_add_f32 v194, v194, v16
    v_add_f32 v195, v195, v16
    v_cvt_pk_bf16_f32 v192, v192, v193
    v_cvt_pk_bf16_f32 v194, v194, v195
    v_and_b32 v193, 0xffff0000, v192
    v_lshlrev_b32 v192, 16, v192
    v_and_b32 v195, 0xffff0000, v194
    v_lshlrev_b32 v194, 16, v194
    ds_write_b128 v12, v[192:195]
    s_waitcnt lgkmcnt(0)
    s_barrier
    ds_read_b128 v[24:27], v17
    ds_read_b128 v[28:31], v17 offset:1024
    ds_read_b128 v[20:23], v17 offset:3072
    ds_read_b128 v[16:19], v17 offset:2048
    s_waitcnt lgkmcnt(0)
    v_pk_fma_f32 v[32:33], v[64:65], v[16:17], v[24:25]
    v_pk_fma_f32 v[34:35], v[66:67], v[18:19], v[26:27]
    v_pk_fma_f32 v[36:37], v[68:69], v[20:21], v[28:29]
    v_pk_fma_f32 v[38:39], v[70:71], v[22:23], v[30:31]
    v_xor_b32 v48, 0, v10
    v_cvt_pk_bf16_f32 v32, v32, v33
    v_cvt_pk_bf16_f32 v33, v34, v35
    v_cvt_pk_bf16_f32 v34, v36, v37
    v_cvt_pk_bf16_f32 v35, v38, v39
    ds_write_b128 v48, v[32:35]
    s_add_u32 m0, s49, 0
    s_add_u32 s50, s44, 0
    buffer_load_dwordx4 v9, s[24:27], s50 offen lds
    v_pk_fma_f32 v[40:41], v[72:73], v[16:17], v[24:25]
    v_pk_fma_f32 v[42:43], v[74:75], v[18:19], v[26:27]
    v_pk_fma_f32 v[44:45], v[76:77], v[20:21], v[28:29]
    v_pk_fma_f32 v[46:47], v[78:79], v[22:23], v[30:31]
    v_xor_b32 v49, 16, v10
    v_cvt_pk_bf16_f32 v40, v40, v41
    v_cvt_pk_bf16_f32 v41, v42, v43
    v_cvt_pk_bf16_f32 v42, v44, v45
    v_cvt_pk_bf16_f32 v43, v46, v47
    ds_write_b128 v49, v[40:43]
    s_add_u32 m0, s49, 4096
    s_add_u32 s50, s44, 98304
    buffer_load_dwordx4 v9, s[24:27], s50 offen lds
    v_pk_fma_f32 v[32:33], v[80:81], v[16:17], v[24:25]
    v_pk_fma_f32 v[34:35], v[82:83], v[18:19], v[26:27]
    v_pk_fma_f32 v[36:37], v[84:85], v[20:21], v[28:29]
    v_pk_fma_f32 v[38:39], v[86:87], v[22:23], v[30:31]
    v_xor_b32 v48, 32, v10
    v_cvt_pk_bf16_f32 v32, v32, v33
    v_cvt_pk_bf16_f32 v33, v34, v35
    v_cvt_pk_bf16_f32 v34, v36, v37
    v_cvt_pk_bf16_f32 v35, v38, v39
    ds_write_b128 v48, v[32:35]
    s_add_u32 m0, s49, 8192
    s_add_u32 s50, s44, 196608
    buffer_load_dwordx4 v9, s[24:27], s50 offen lds
    v_pk_fma_f32 v[40:41], v[88:89], v[16:17], v[24:25]
    v_pk_fma_f32 v[42:43], v[90:91], v[18:19], v[26:27]
    v_pk_fma_f32 v[44:45], v[92:93], v[20:21], v[28:29]
    v_pk_fma_f32 v[46:47], v[94:95], v[22:23], v[30:31]
    v_xor_b32 v49, 48, v10
    v_cvt_pk_bf16_f32 v40, v40, v41
    v_cvt_pk_bf16_f32 v41, v42, v43
    v_cvt_pk_bf16_f32 v42, v44, v45
    v_cvt_pk_bf16_f32 v43, v46, v47
    ds_write_b128 v49, v[40:43]
    s_add_u32 m0, s49, 12288
    s_add_u32 s50, s44, 294912
    buffer_load_dwordx4 v9, s[24:27], s50 offen lds
    v_pk_fma_f32 v[32:33], v[96:97], v[16:17], v[24:25]
    v_pk_fma_f32 v[34:35], v[98:99], v[18:19], v[26:27]
    v_pk_fma_f32 v[36:37], v[100:101], v[20:21], v[28:29]
    v_pk_fma_f32 v[38:39], v[102:103], v[22:23], v[30:31]
    v_xor_b32 v48, 64, v10
    v_cvt_pk_bf16_f32 v32, v32, v33
    v_cvt_pk_bf16_f32 v33, v34, v35
    v_cvt_pk_bf16_f32 v34, v36, v37
    v_cvt_pk_bf16_f32 v35, v38, v39
    ds_write_b128 v48, v[32:35]
    s_add_u32 m0, s49, 16384
    s_add_u32 s50, s44, 393216
    buffer_load_dwordx4 v9, s[24:27], s50 offen lds
    v_pk_fma_f32 v[40:41], v[104:105], v[16:17], v[24:25]
    v_pk_fma_f32 v[42:43], v[106:107], v[18:19], v[26:27]
    v_pk_fma_f32 v[44:45], v[108:109], v[20:21], v[28:29]
    v_pk_fma_f32 v[46:47], v[110:111], v[22:23], v[30:31]
    v_xor_b32 v49, 80, v10
    v_cvt_pk_bf16_f32 v40, v40, v41
    v_cvt_pk_bf16_f32 v41, v42, v43
    v_cvt_pk_bf16_f32 v42, v44, v45
    v_cvt_pk_bf16_f32 v43, v46, v47
    ds_write_b128 v49, v[40:43]
    s_add_u32 m0, s49, 20480
    s_add_u32 s50, s44, 491520
    buffer_load_dwordx4 v9, s[24:27], s50 offen lds
    v_pk_fma_f32 v[32:33], v[112:113], v[16:17], v[24:25]
    v_pk_fma_f32 v[34:35], v[114:115], v[18:19], v[26:27]
    v_pk_fma_f32 v[36:37], v[116:117], v[20:21], v[28:29]
    v_pk_fma_f32 v[38:39], v[118:119], v[22:23], v[30:31]
    v_xor_b32 v48, 96, v10
    v_cvt_pk_bf16_f32 v32, v32, v33
    v_cvt_pk_bf16_f32 v33, v34, v35
    v_cvt_pk_bf16_f32 v34, v36, v37
    v_cvt_pk_bf16_f32 v35, v38, v39
    ds_write_b128 v48, v[32:35]
    s_add_u32 m0, s49, 24576
    s_add_u32 s50, s44, 589824
    buffer_load_dwordx4 v9, s[24:27], s50 offen lds
    v_pk_fma_f32 v[40:41], v[120:121], v[16:17], v[24:25]
    v_pk_fma_f32 v[42:43], v[122:123], v[18:19], v[26:27]
    v_pk_fma_f32 v[44:45], v[124:125], v[20:21], v[28:29]
    v_pk_fma_f32 v[46:47], v[126:127], v[22:23], v[30:31]
    v_xor_b32 v49, 112, v10
    v_cvt_pk_bf16_f32 v40, v40, v41
    v_cvt_pk_bf16_f32 v41, v42, v43
    v_cvt_pk_bf16_f32 v42, v44, v45
    v_cvt_pk_bf16_f32 v43, v46, v47
    ds_write_b128 v49, v[40:43]
    s_add_u32 m0, s49, 28672
    s_add_u32 s50, s44, 688128
    buffer_load_dwordx4 v9, s[24:27], s50 offen lds
    v_pk_fma_f32 v[32:33], v[128:129], v[16:17], v[24:25]
    v_pk_fma_f32 v[34:35], v[130:131], v[18:19], v[26:27]
    v_pk_fma_f32 v[36:37], v[132:133], v[20:21], v[28:29]
    v_pk_fma_f32 v[38:39], v[134:135], v[22:23], v[30:31]
    v_xor_b32 v48, 128, v10
    v_cvt_pk_bf16_f32 v32, v32, v33
    v_cvt_pk_bf16_f32 v33, v34, v35
    v_cvt_pk_bf16_f32 v34, v36, v37
    v_cvt_pk_bf16_f32 v35, v38, v39
    ds_write_b128 v48, v[32:35]
    s_add_u32 m0, s49, 32768
    s_add_u32 s50, s44, 786432
    buffer_load_dwordx4 v9, s[24:27], s50 offen lds
    v_pk_fma_f32 v[40:41], v[136:137], v[16:17], v[24:25]
    v_pk_fma_f32 v[42:43], v[138:139], v[18:19], v[26:27]
    v_pk_fma_f32 v[44:45], v[140:141], v[20:21], v[28:29]
    v_pk_fma_f32 v[46:47], v[142:143], v[22:23], v[30:31]
    v_xor_b32 v49, 144, v10
    v_cvt_pk_bf16_f32 v40, v40, v41
    v_cvt_pk_bf16_f32 v41, v42, v43
    v_cvt_pk_bf16_f32 v42, v44, v45
    v_cvt_pk_bf16_f32 v43, v46, v47
    ds_write_b128 v49, v[40:43]
    s_add_u32 m0, s49, 36864
    s_add_u32 s50, s44, 884736
    buffer_load_dwordx4 v9, s[24:27], s50 offen lds
    v_pk_fma_f32 v[32:33], v[144:145], v[16:17], v[24:25]
    v_pk_fma_f32 v[34:35], v[146:147], v[18:19], v[26:27]
    v_pk_fma_f32 v[36:37], v[148:149], v[20:21], v[28:29]
    v_pk_fma_f32 v[38:39], v[150:151], v[22:23], v[30:31]
    v_xor_b32 v48, 160, v10
    v_cvt_pk_bf16_f32 v32, v32, v33
    v_cvt_pk_bf16_f32 v33, v34, v35
    v_cvt_pk_bf16_f32 v34, v36, v37
    v_cvt_pk_bf16_f32 v35, v38, v39
    ds_write_b128 v48, v[32:35]
    s_add_u32 m0, s49, 40960
    s_add_u32 s50, s44, 983040
    buffer_load_dwordx4 v9, s[24:27], s50 offen lds
    v_pk_fma_f32 v[40:41], v[152:153], v[16:17], v[24:25]
    v_pk_fma_f32 v[42:43], v[154:155], v[18:19], v[26:27]
    v_pk_fma_f32 v[44:45], v[156:157], v[20:21], v[28:29]
    v_pk_fma_f32 v[46:47], v[158:159], v[22:23], v[30:31]
    v_xor_b32 v49, 176, v10
    v_cvt_pk_bf16_f32 v40, v40, v41
    v_cvt_pk_bf16_f32 v41, v42, v43
    v_cvt_pk_bf16_f32 v42, v44, v45
    v_cvt_pk_bf16_f32 v43, v46, v47
    ds_write_b128 v49, v[40:43]
    s_add_u32 m0, s49, 45056
    s_add_u32 s50, s44, 1081344
    buffer_load_dwordx4 v9, s[24:27], s50 offen lds
    v_pk_fma_f32 v[32:33], v[160:161], v[16:17], v[24:25]
    v_pk_fma_f32 v[34:35], v[162:163], v[18:19], v[26:27]
    v_pk_fma_f32 v[36:37], v[164:165], v[20:21], v[28:29]
    v_pk_fma_f32 v[38:39], v[166:167], v[22:23], v[30:31]
    v_xor_b32 v48, 192, v10
    v_cvt_pk_bf16_f32 v32, v32, v33
    v_cvt_pk_bf16_f32 v33, v34, v35
    v_cvt_pk_bf16_f32 v34, v36, v37
    v_cvt_pk_bf16_f32 v35, v38, v39
    ds_write_b128 v48, v[32:35]
    s_add_u32 m0, s49, 49152
    s_add_u32 s50, s44, 1179648
    buffer_load_dwordx4 v9, s[24:27], s50 offen lds
    v_pk_fma_f32 v[40:41], v[168:169], v[16:17], v[24:25]
    v_pk_fma_f32 v[42:43], v[170:171], v[18:19], v[26:27]
    v_pk_fma_f32 v[44:45], v[172:173], v[20:21], v[28:29]
    v_pk_fma_f32 v[46:47], v[174:175], v[22:23], v[30:31]
    v_xor_b32 v49, 208, v10
    v_cvt_pk_bf16_f32 v40, v40, v41
    v_cvt_pk_bf16_f32 v41, v42, v43
    v_cvt_pk_bf16_f32 v42, v44, v45
    v_cvt_pk_bf16_f32 v43, v46, v47
    ds_write_b128 v49, v[40:43]
    s_add_u32 m0, s49, 53248
    s_add_u32 s50, s44, 1277952
    buffer_load_dwordx4 v9, s[24:27], s50 offen lds
    v_pk_fma_f32 v[32:33], v[176:177], v[16:17], v[24:25]
    v_pk_fma_f32 v[34:35], v[178:179], v[18:19], v[26:27]
    v_pk_fma_f32 v[36:37], v[180:181], v[20:21], v[28:29]
    v_pk_fma_f32 v[38:39], v[182:183], v[22:23], v[30:31]
    v_xor_b32 v48, 224, v10
    v_cvt_pk_bf16_f32 v32, v32, v33
    v_cvt_pk_bf16_f32 v33, v34, v35
    v_cvt_pk_bf16_f32 v34, v36, v37
    v_cvt_pk_bf16_f32 v35, v38, v39
    ds_write_b128 v48, v[32:35]
    s_add_u32 m0, s49, 57344
    s_add_u32 s50, s44, 1376256
    buffer_load_dwordx4 v9, s[24:27], s50 offen lds
    v_pk_fma_f32 v[40:41], v[184:185], v[16:17], v[24:25]
    v_pk_fma_f32 v[42:43], v[186:187], v[18:19], v[26:27]
    v_pk_fma_f32 v[44:45], v[188:189], v[20:21], v[28:29]
    v_pk_fma_f32 v[46:47], v[190:191], v[22:23], v[30:31]
    v_xor_b32 v49, 240, v10
    v_cvt_pk_bf16_f32 v40, v40, v41
    v_cvt_pk_bf16_f32 v41, v42, v43
    v_cvt_pk_bf16_f32 v42, v44, v45
    v_cvt_pk_bf16_f32 v43, v46, v47
    ds_write_b128 v49, v[40:43]
    s_add_u32 m0, s49, 61440
    s_add_u32 s50, s44, 1474560
    buffer_load_dwordx4 v9, s[24:27], s50 offen lds
    s_waitcnt lgkmcnt(0)
    s_barrier
    ds_read_b128 a[192:195], v11 offset:0
    ds_read_b128 a[196:199], v11 offset:16384
    ds_read_b128 a[200:203], v11 offset:32768
    ds_read_b128 a[204:207], v11 offset:49152
    ds_read_b128 a[208:211], v13 offset:1024
    ds_read_b128 a[212:215], v13 offset:17408
    ds_read_b128 a[216:219], v13 offset:33792
    ds_read_b128 a[220:223], v13 offset:50176
    ds_read_b128 a[224:227], v11 offset:2048
    ds_read_b128 a[228:231], v11 offset:18432
    ds_read_b128 a[232:235], v11 offset:34816
    ds_read_b128 a[236:239], v11 offset:51200
    s_waitcnt lgkmcnt(8)
    v_mfma_f32_16x16x32_bf16 v[208:211], a[4:7], a[192:195], 0
    ds_read_b128 a[240:243], v13 offset:3072
    ds_read_b128 a[244:247], v13 offset:19456
    ds_read_b128 a[248:251], v13 offset:35840
    ds_read_b128 a[252:255], v13 offset:52224
    v_mfma_f32_16x16x32_bf16 v[224:227], a[192:195], a[8:11], 0
    v_lshlrev_b32 v101, 12, v4
    s_lshl_b32 s39, s6, 7
    s_add_u32 s39, s39, 425984
    v_mfma_f32_16x16x32_bf16 v[212:215], a[4:7], a[196:199], 0
    s_mov_b64 exec, 7
    buffer_load_dword v63, v101, s[40:43], s39 offen sc1
    s_mov_b64 exec, -1
    v_lshlrev_b32 v101, 7, v5
    v_lshl_add_u32 v101, v2, 14, v101
    v_mfma_f32_16x16x32_bf16 v[228:231], a[196:199], a[8:11], 0
    s_lshl_b32 s39, s6, 16
    s_lshl_b32 s52, s7, 11
    s_add_u32 s39, s39, s52
    v_mfma_f32_16x16x32_bf16 v[216:219], a[4:7], a[200:203], 0
    s_add_u32 s52, s39, 7340032
    s_add_u32 s39, s39, 3145728
    s_cmp_eq_u32 s3, 1
    v_mfma_f32_16x16x32_bf16 v[232:235], a[200:203], a[8:11], 0
    s_cselect_b32 s39, s52, s39
    s_lshl_b32 s52, s6, 3
    s_add_u32 s52, s52, s7
    v_mfma_f32_16x16x32_bf16 v[220:223], a[4:7], a[204:207], 0
    s_lshl_b32 s52, s52, 9
    s_add_u32 s52, s52, 196608
    s_cmp_lt_u32 s3, 2
    v_mfma_f32_16x16x32_bf16 v[236:239], a[204:207], a[8:11], 0
    s_cselect_b32 s39, s39, s52
    s_cselect_b32 s38, -1, 15
    s_mov_b32 exec_lo, s38
    s_cselect_b32 exec_hi, -1, 0
    buffer_load_dword v63, v101, s[40:43], s39 offen
    s_mov_b64 exec, -1
    s_waitcnt lgkmcnt(8)
    v_mfma_f32_16x16x32_bf16 v[208:211], a[16:19], a[208:211], v[208:211]
    ds_read_b128 a[192:195], v11 offset:4096
    ds_read_b128 a[196:199], v11 offset:20480
    ds_read_b128 a[200:203], v11 offset:36864
    ds_read_b128 a[204:207], v11 offset:53248
    v_mfma_f32_16x16x32_bf16 v[224:227], a[208:211], a[20:23], v[224:227]
    v_accvgpr_read_b32 v240, a0
    v_accvgpr_read_b32 v241, a1
    v_accvgpr_read_b32 v242, a2
    v_mfma_f32_16x16x32_bf16 v[212:215], a[16:19], a[212:215], v[212:215]
    v_accvgpr_read_b32 v243, a3
    v_accvgpr_read_b32 v244, a12
    v_accvgpr_read_b32 v245, a13
    v_accvgpr_read_b32 v246, a14
    v_mfma_f32_16x16x32_bf16 v[228:231], a[212:215], a[20:23], v[228:231]
    v_accvgpr_read_b32 v247, a15
    v_accvgpr_read_b32 v248, a24
    v_accvgpr_read_b32 v249, a25
    v_mfma_f32_16x16x32_bf16 v[216:219], a[16:19], a[216:219], v[216:219]
    v_accvgpr_read_b32 v250, a26
    v_lshlrev_b32 v100, 7, v1
    s_lshr_b32 s36, s2, 3
    v_mfma_f32_16x16x32_bf16 v[232:235], a[216:219], a[20:23], v[232:235]
    s_mul_i32 s37, s36, 16384
    s_and_b32 s38, s3, 1
    s_mul_i32 s38, s38, 8192
    s_add_u32 s37, s37, s38
    v_mfma_f32_16x16x32_bf16 v[220:223], a[16:19], a[220:223], v[220:223]
    s_lshl_b32 s36, s36, 14
    s_lshl_b32 s38, s3, 12
    s_add_u32 s36, s36, s38
    v_mfma_f32_16x16x32_bf16 v[236:239], a[220:223], a[20:23], v[236:239]
    s_mov_b32 s64, s8
    s_and_b32 s65, s9, 0xffff
    s_mov_b32 s66, 512*1024
    s_waitcnt lgkmcnt(8)
    v_mfma_f32_16x16x32_bf16 v[208:211], a[28:31], a[224:227], v[208:211]
    ds_read_b128 a[208:211], v13 offset:5120
    ds_read_b128 a[212:215], v13 offset:21504
    v_mfma_f32_16x16x32_bf16 v[224:227], a[224:227], a[32:35], v[224:227]
    ds_read_b128 a[216:219], v13 offset:37888
    ds_read_b128 a[220:223], v13 offset:54272
    v_mfma_f32_16x16x32_bf16 v[212:215], a[28:31], a[228:231], v[212:215]
    v_accvgpr_read_b32 v251, a27
    v_accvgpr_read_b32 v252, a36
    v_mfma_f32_16x16x32_bf16 v[228:231], a[228:231], a[32:35], v[228:231]
    v_accvgpr_read_b32 v253, a37
    v_accvgpr_read_b32 v254, a38
    v_mfma_f32_16x16x32_bf16 v[216:219], a[28:31], a[232:235], v[216:219]
    v_accvgpr_read_b32 v255, a39
    v_lshlrev_b32 v64, 16, v52
    v_mfma_f32_16x16x32_bf16 v[232:235], a[232:235], a[32:35], v[232:235]
    v_lshlrev_b32 v65, 16, v53
    v_lshlrev_b32 v66, 16, v54
    v_mfma_f32_16x16x32_bf16 v[220:223], a[28:31], a[236:239], v[220:223]
    v_lshlrev_b32 v67, 16, v55
    v_mul_f32 v68, 0xbfb8aa3b, v64
    v_mfma_f32_16x16x32_bf16 v[236:239], a[236:239], a[32:35], v[236:239]
    v_mul_f32 v69, 0xbfb8aa3b, v65
    s_mov_b32 exec_hi, 0
    buffer_load_dword v63, v100, s[64:67], s36 offen
    s_mov_b32 exec_hi, -1
    s_waitcnt lgkmcnt(8)
    v_mfma_f32_16x16x32_bf16 v[208:211], a[40:43], a[240:243], v[208:211]
    ds_read_b128 a[224:227], v11 offset:6144
    ds_read_b128 a[228:231], v11 offset:22528
    v_mfma_f32_16x16x32_bf16 v[224:227], a[240:243], a[44:47], v[224:227]
    ds_read_b128 a[232:235], v11 offset:38912
    ds_read_b128 a[236:239], v11 offset:55296
    v_mfma_f32_16x16x32_bf16 v[212:215], a[40:43], a[244:247], v[212:215]
    v_mul_f32 v70, 0xbfb8aa3b, v66
    v_mul_f32 v71, 0xbfb8aa3b, v67
    v_mfma_f32_16x16x32_bf16 v[228:231], a[244:247], a[44:47], v[228:231]
    v_exp_f32 v68, v68
    v_exp_f32 v69, v69
    v_mfma_f32_16x16x32_bf16 v[216:219], a[40:43], a[248:251], v[216:219]
    v_exp_f32 v70, v70
    v_exp_f32 v71, v71
    v_mfma_f32_16x16x32_bf16 v[232:235], a[248:251], a[44:47], v[232:235]
    s_nop 0
    v_add_f32 v68, 1.0, v68
    v_mfma_f32_16x16x32_bf16 v[220:223], a[40:43], a[252:255], v[220:223]
    v_add_f32 v69, 1.0, v69
    v_add_f32 v70, 1.0, v70
    v_mfma_f32_16x16x32_bf16 v[236:239], a[252:255], a[44:47], v[236:239]
    v_add_f32 v71, 1.0, v71
    s_waitcnt lgkmcnt(8)
    v_mfma_f32_16x16x32_bf16 v[208:211], a[52:55], a[192:195], v[208:211]
    ds_read_b128 a[240:243], v13 offset:7168
    ds_read_b128 a[244:247], v13 offset:23552
    v_mfma_f32_16x16x32_bf16 v[224:227], a[192:195], a[56:59], v[224:227]
    ds_read_b128 a[248:251], v13 offset:39936
    ds_read_b128 a[252:255], v13 offset:56320
    v_mfma_f32_16x16x32_bf16 v[212:215], a[52:55], a[196:199], v[212:215]
    v_rcp_f32 v68, v68
    v_rcp_f32 v69, v69
    v_mfma_f32_16x16x32_bf16 v[228:231], a[196:199], a[56:59], v[228:231]
    v_rcp_f32 v70, v70
    v_rcp_f32 v71, v71
    v_mfma_f32_16x16x32_bf16 v[216:219], a[52:55], a[200:203], v[216:219]
    s_nop 0
    v_mul_f32 v64, v64, v68
    v_mfma_f32_16x16x32_bf16 v[232:235], a[200:203], a[56:59], v[232:235]
    v_mul_f32 v65, v65, v69
    v_mul_f32 v66, v66, v70
    v_mfma_f32_16x16x32_bf16 v[220:223], a[52:55], a[204:207], v[220:223]
    v_mul_f32 v67, v67, v71
    v_cvt_pk_bf16_f32 v64, v64, v64
    v_mfma_f32_16x16x32_bf16 v[236:239], a[204:207], a[56:59], v[236:239]
    v_cvt_pk_bf16_f32 v65, v65, v65
    s_waitcnt lgkmcnt(8)
    v_mfma_f32_16x16x32_bf16 v[208:211], a[64:67], a[208:211], v[208:211]
    ds_read_b128 a[192:195], v11 offset:8192
    ds_read_b128 a[196:199], v11 offset:24576
    v_mfma_f32_16x16x32_bf16 v[224:227], a[208:211], a[68:71], v[224:227]
    ds_read_b128 a[200:203], v11 offset:40960
    ds_read_b128 a[204:207], v11 offset:57344
    v_mfma_f32_16x16x32_bf16 v[212:215], a[64:67], a[212:215], v[212:215]
    v_cvt_pk_bf16_f32 v66, v66, v66
    v_cvt_pk_bf16_f32 v67, v67, v67
    v_mfma_f32_16x16x32_bf16 v[228:231], a[212:215], a[68:71], v[228:231]
    v_lshlrev_b32 v64, 16, v64
    v_lshlrev_b32 v65, 16, v65
    v_mfma_f32_16x16x32_bf16 v[216:219], a[64:67], a[216:219], v[216:219]
    v_lshlrev_b32 v66, 16, v66
    v_lshlrev_b32 v67, 16, v67
    v_mfma_f32_16x16x32_bf16 v[232:235], a[216:219], a[68:71], v[232:235]
    v_lshlrev_b32 v80, 16, v240
    v_and_b32 v81, 0xffff0000, v240
    v_mfma_f32_16x16x32_bf16 v[220:223], a[64:67], a[220:223], v[220:223]
    v_mul_f32 v72, v64, v80
    v_mul_f32 v73, v64, v81
    v_mfma_f32_16x16x32_bf16 v[236:239], a[220:223], a[68:71], v[236:239]
    v_lshlrev_b32 v82, 16, v241
    s_waitcnt lgkmcnt(8)
    v_mfma_f32_16x16x32_bf16 v[208:211], a[76:79], a[224:227], v[208:211]
    ds_read_b128 a[208:211], v13 offset:9216
PG64:
    s_cbranch_execz PW_S1
    ds_read_b128 a[212:215], v13 offset:25600
    v_mfma_f32_16x16x32_bf16 v[224:227], a[224:227], a[80:83], v[224:227]
    ds_read_b128 a[216:219], v13 offset:41984
    ds_read_b128 a[220:223], v13 offset:58368
    v_mfma_f32_16x16x32_bf16 v[212:215], a[76:79], a[228:231], v[212:215]
    v_and_b32 v83, 0xffff0000, v241
    v_mul_f32 v74, v64, v82
    v_mfma_f32_16x16x32_bf16 v[228:231], a[228:231], a[80:83], v[228:231]
    v_mul_f32 v75, v64, v83
    v_lshlrev_b32 v80, 16, v242
    v_mfma_f32_16x16x32_bf16 v[216:219], a[76:79], a[232:235], v[216:219]
    v_and_b32 v81, 0xffff0000, v242
    v_mul_f32 v76, v64, v80
    v_mfma_f32_16x16x32_bf16 v[232:235], a[232:235], a[80:83], v[232:235]
    v_mul_f32 v77, v64, v81
    v_lshlrev_b32 v82, 16, v243
    v_mfma_f32_16x16x32_bf16 v[220:223], a[76:79], a[236:239], v[220:223]
    v_and_b32 v83, 0xffff0000, v243
    v_mul_f32 v78, v64, v82
    v_mfma_f32_16x16x32_bf16 v[236:239], a[236:239], a[80:83], v[236:239]
    v_mul_f32 v79, v64, v83
    s_waitcnt lgkmcnt(8)
    v_mfma_f32_16x16x32_bf16 v[208:211], a[88:91], a[240:243], v[208:211]
    ds_read_b128 a[224:227], v11 offset:10240
    ds_read_b128 a[228:231], v11 offset:26624
    v_mfma_f32_16x16x32_bf16 v[224:227], a[240:243], a[92:95], v[224:227]
    ds_read_b128 a[232:235], v11 offset:43008
    ds_read_b128 a[236:239], v11 offset:59392
    v_mfma_f32_16x16x32_bf16 v[212:215], a[88:91], a[244:247], v[212:215]
    v_lshlrev_b32 v80, 16, v244
    v_and_b32 v81, 0xffff0000, v244
    v_mfma_f32_16x16x32_bf16 v[228:231], a[244:247], a[92:95], v[228:231]
    v_fmac_f32 v72, v65, v80
    v_fmac_f32 v73, v65, v81
    v_mfma_f32_16x16x32_bf16 v[216:219], a[88:91], a[248:251], v[216:219]
    v_lshlrev_b32 v82, 16, v245
    v_and_b32 v83, 0xffff0000, v245
    v_mfma_f32_16x16x32_bf16 v[232:235], a[248:251], a[92:95], v[232:235]
    v_fmac_f32 v74, v65, v82
    v_fmac_f32 v75, v65, v83
    v_mfma_f32_16x16x32_bf16 v[220:223], a[88:91], a[252:255], v[220:223]
    v_lshlrev_b32 v80, 16, v246
    v_and_b32 v81, 0xffff0000, v246
    v_mfma_f32_16x16x32_bf16 v[236:239], a[252:255], a[92:95], v[236:239]
    v_fmac_f32 v76, v65, v80
    v_fmac_f32 v77, v65, v81
    s_waitcnt lgkmcnt(8)
    v_mfma_f32_16x16x32_bf16 v[208:211], a[100:103], a[192:195], v[208:211]
    ds_read_b128 a[240:243], v13 offset:11264
    ds_read_b128 a[244:247], v13 offset:27648
    v_mfma_f32_16x16x32_bf16 v[224:227], a[192:195], a[104:107], v[224:227]
    ds_read_b128 a[248:251], v13 offset:44032
    ds_read_b128 a[252:255], v13 offset:60416
    v_mfma_f32_16x16x32_bf16 v[212:215], a[100:103], a[196:199], v[212:215]
    v_lshlrev_b32 v82, 16, v247
    v_and_b32 v83, 0xffff0000, v247
    v_mfma_f32_16x16x32_bf16 v[228:231], a[196:199], a[104:107], v[228:231]
    v_fmac_f32 v78, v65, v82
    v_fmac_f32 v79, v65, v83
    v_mfma_f32_16x16x32_bf16 v[216:219], a[100:103], a[200:203], v[216:219]
    v_lshlrev_b32 v80, 16, v248
    v_and_b32 v81, 0xffff0000, v248
    v_mfma_f32_16x16x32_bf16 v[232:235], a[200:203], a[104:107], v[232:235]
    v_fmac_f32 v72, v66, v80
    v_fmac_f32 v73, v66, v81
    v_mfma_f32_16x16x32_bf16 v[220:223], a[100:103], a[204:207], v[220:223]
    v_lshlrev_b32 v82, 16, v249
    v_and_b32 v83, 0xffff0000, v249
    v_mfma_f32_16x16x32_bf16 v[236:239], a[204:207], a[104:107], v[236:239]
    v_fmac_f32 v74, v66, v82
    s_waitcnt lgkmcnt(8)
    v_mfma_f32_16x16x32_bf16 v[208:211], a[112:115], a[208:211], v[208:211]
    ds_read_b128 a[192:195], v11 offset:12288
    ds_read_b128 a[196:199], v11 offset:28672
    ds_read_b128 a[200:203], v11 offset:45056
    v_mfma_f32_16x16x32_bf16 v[224:227], a[208:211], a[116:119], v[224:227]
    ds_read_b128 a[204:207], v11 offset:61440
    v_fmac_f32 v75, v66, v83
    v_mfma_f32_16x16x32_bf16 v[212:215], a[112:115], a[212:215], v[212:215]
    v_lshlrev_b32 v80, 16, v250
    v_and_b32 v81, 0xffff0000, v250
    v_mfma_f32_16x16x32_bf16 v[228:231], a[212:215], a[116:119], v[228:231]
    v_fmac_f32 v76, v66, v80
    v_fmac_f32 v77, v66, v81
    v_mfma_f32_16x16x32_bf16 v[216:219], a[112:115], a[216:219], v[216:219]
    v_lshlrev_b32 v82, 16, v251
    v_and_b32 v83, 0xffff0000, v251
    v_mfma_f32_16x16x32_bf16 v[232:235], a[216:219], a[116:119], v[232:235]
    v_fmac_f32 v78, v66, v82
    v_fmac_f32 v79, v66, v83
    v_mfma_f32_16x16x32_bf16 v[220:223], a[112:115], a[220:223], v[220:223]
    v_lshlrev_b32 v80, 16, v252
    v_and_b32 v81, 0xffff0000, v252
    v_mfma_f32_16x16x32_bf16 v[236:239], a[220:223], a[116:119], v[236:239]
    s_add_u32 s38, s37, 0
    buffer_load_dword v63, v100, s[28:31], s38 offen
    s_waitcnt lgkmcnt(8)
    v_mfma_f32_16x16x32_bf16 v[208:211], a[124:127], a[224:227], v[208:211]
    ds_read_b128 a[208:211], v13 offset:13312
    ds_read_b128 a[212:215], v13 offset:29696
    v_mfma_f32_16x16x32_bf16 v[224:227], a[224:227], a[128:131], v[224:227]
    ds_read_b128 a[216:219], v13 offset:46080
    ds_read_b128 a[220:223], v13 offset:62464
    v_mfma_f32_16x16x32_bf16 v[212:215], a[124:127], a[228:231], v[212:215]
    v_fmac_f32 v72, v67, v80
    v_fmac_f32 v73, v67, v81
    v_mfma_f32_16x16x32_bf16 v[228:231], a[228:231], a[128:131], v[228:231]
    v_lshlrev_b32 v82, 16, v253
    v_and_b32 v83, 0xffff0000, v253
    v_mfma_f32_16x16x32_bf16 v[216:219], a[124:127], a[232:235], v[216:219]
    v_fmac_f32 v74, v67, v82
    v_fmac_f32 v75, v67, v83
    v_mfma_f32_16x16x32_bf16 v[232:235], a[232:235], a[128:131], v[232:235]
    v_lshlrev_b32 v80, 16, v254
    v_and_b32 v81, 0xffff0000, v254
    v_mfma_f32_16x16x32_bf16 v[220:223], a[124:127], a[236:239], v[220:223]
    v_fmac_f32 v76, v67, v80
    v_fmac_f32 v77, v67, v81
    v_mfma_f32_16x16x32_bf16 v[236:239], a[236:239], a[128:131], v[236:239]
    v_lshlrev_b32 v82, 16, v255
    s_waitcnt lgkmcnt(8)
    v_mfma_f32_16x16x32_bf16 v[208:211], a[136:139], a[240:243], v[208:211]
    ds_read_b128 a[224:227], v11 offset:14336
    ds_read_b128 a[228:231], v11 offset:30720
    v_mfma_f32_16x16x32_bf16 v[224:227], a[240:243], a[140:143], v[224:227]
    ds_read_b128 a[232:235], v11 offset:47104
    ds_read_b128 a[236:239], v11 offset:63488
    v_mfma_f32_16x16x32_bf16 v[212:215], a[136:139], a[244:247], v[212:215]
    v_and_b32 v83, 0xffff0000, v255
    v_fmac_f32 v78, v67, v82
    v_mfma_f32_16x16x32_bf16 v[228:231], a[244:247], a[140:143], v[228:231]
    v_fmac_f32 v79, v67, v83
    v_and_b32 v80, 7, v1
    v_mfma_f32_16x16x32_bf16 v[216:219], a[136:139], a[248:251], v[216:219]
    v_bfe_u32 v81, v1, 3, 1
    v_lshlrev_b32 v80, 5, v80
    v_mfma_f32_16x16x32_bf16 v[232:235], a[248:251], a[140:143], v[232:235]
    v_lshl_add_u32 v80, v81, 4, v80
    v_lshl_add_u32 v80, v2, 2, v80
    v_mfma_f32_16x16x32_bf16 v[220:223], a[136:139], a[252:255], v[220:223]
    s_lshl_b32 s53, s3, 8
    s_add_u32 s53, s53, 147456
    v_mfma_f32_16x16x32_bf16 v[236:239], a[252:255], a[140:143], v[236:239]
    v_add_u32 v80, s53, v80
    s_waitcnt lgkmcnt(8)
    v_mfma_f32_16x16x32_bf16 v[208:211], a[148:151], a[192:195], v[208:211]
    ds_read_b128 a[240:243], v13 offset:15360
    ds_read_b128 a[244:247], v13 offset:31744
    v_mfma_f32_16x16x32_bf16 v[224:227], a[192:195], a[152:155], v[224:227]
    ds_read_b128 a[248:251], v13 offset:48128
    ds_read_b128 a[252:255], v13 offset:64512
    v_mfma_f32_16x16x32_bf16 v[212:215], a[148:151], a[196:199], v[212:215]
    v_cmp_eq_u32 vcc, 1, v81
    s_nop 0
    v_mfma_f32_16x16x32_bf16 v[228:231], a[196:199], a[152:155], v[228:231]
    v_permlane16_swap_b32 v72, v73
    v_permlane16_swap_b32 v74, v75
    v_mfma_f32_16x16x32_bf16 v[216:219], a[148:151], a[200:203], v[216:219]
    v_permlane16_swap_b32 v76, v77
    v_permlane16_swap_b32 v78, v79
    v_mfma_f32_16x16x32_bf16 v[232:235], a[200:203], a[152:155], v[232:235]
    s_nop 0
    v_add_f32 v72, v72, v73
    v_mfma_f32_16x16x32_bf16 v[220:223], a[148:151], a[204:207], v[220:223]
    v_add_f32 v74, v74, v75
    v_add_f32 v76, v76, v77
    v_mfma_f32_16x16x32_bf16 v[236:239], a[204:207], a[152:155], v[236:239]
    v_add_f32 v78, v78, v79
    s_waitcnt lgkmcnt(8)
    v_mfma_f32_16x16x32_bf16 v[208:211], a[160:163], a[208:211], v[208:211]
    s_nop 0
    v_permlane32_swap_b32 v72, v74
    v_mfma_f32_16x16x32_bf16 v[224:227], a[208:211], a[164:167], v[224:227]
    v_permlane32_swap_b32 v76, v78
    v_mfma_f32_16x16x32_bf16 v[212:215], a[160:163], a[212:215], v[212:215]
    s_nop 0
    v_add_f32 v72, v72, v74
    v_mfma_f32_16x16x32_bf16 v[228:231], a[212:215], a[164:167], v[228:231]
    v_add_f32 v76, v76, v78
    v_mfma_f32_16x16x32_bf16 v[216:219], a[160:163], a[216:219], v[216:219]
    s_nop 1
    v_add_f32_dpp v72, v72, v72 row_ror:8 row_mask:0xf bank_mask:0xf
    v_mfma_f32_16x16x32_bf16 v[232:235], a[216:219], a[164:167], v[232:235]
    v_add_f32_dpp v76, v76, v76 row_ror:8 row_mask:0xf bank_mask:0xf
    v_mfma_f32_16x16x32_bf16 v[220:223], a[160:163], a[220:223], v[220:223]
    s_nop 0
    v_cndmask_b32 v72, v72, v76, vcc
    v_mfma_f32_16x16x32_bf16 v[236:239], a[220:223], a[164:167], v[236:239]
    ds_write_b32 v80, v72
    s_waitcnt lgkmcnt(5)
    v_mfma_f32_16x16x32_bf16 v[208:211], a[172:175], a[224:227], v[208:211]
    v_mfma_f32_16x16x32_bf16 v[224:227], a[224:227], a[176:179], v[224:227]
    v_mfma_f32_16x16x32_bf16 v[212:215], a[172:175], a[228:231], v[212:215]
    v_mfma_f32_16x16x32_bf16 v[228:231], a[228:231], a[176:179], v[228:231]
    v_mfma_f32_16x16x32_bf16 v[216:219], a[172:175], a[232:235], v[216:219]
    v_mfma_f32_16x16x32_bf16 v[232:235], a[232:235], a[176:179], v[232:235]
    v_mfma_f32_16x16x32_bf16 v[220:223], a[172:175], a[236:239], v[220:223]
    v_mfma_f32_16x16x32_bf16 v[236:239], a[236:239], a[176:179], v[236:239]
    s_waitcnt lgkmcnt(1)
    v_mfma_f32_16x16x32_bf16 v[208:211], a[184:187], a[240:243], v[208:211]
    v_mfma_f32_16x16x32_bf16 v[224:227], a[240:243], a[188:191], v[224:227]
    v_mfma_f32_16x16x32_bf16 v[212:215], a[184:187], a[244:247], v[212:215]
    v_mfma_f32_16x16x32_bf16 v[228:231], a[244:247], a[188:191], v[228:231]
    v_mfma_f32_16x16x32_bf16 v[216:219], a[184:187], a[248:251], v[216:219]
    v_mfma_f32_16x16x32_bf16 v[232:235], a[248:251], a[188:191], v[232:235]
    v_mfma_f32_16x16x32_bf16 v[220:223], a[184:187], a[252:255], v[220:223]
    v_mfma_f32_16x16x32_bf16 v[236:239], a[252:255], a[188:191], v[236:239]
    s_lshl_b32 s57, s3, 12
    s_add_u32 s57, s57, 131072
    v_lshlrev_b32 v12, 6, v5
    v_lshl_add_u32 v12, v2, 3, v12
    v_add_u32 v12, s57, v12
    s_nop 3
    v_cvt_pk_bf16_f32 v32, v208, v209
    v_cvt_pk_bf16_f32 v33, v210, v211
    v_cvt_pk_bf16_f32 v34, v212, v213
    v_cvt_pk_bf16_f32 v35, v214, v215
    v_cvt_pk_bf16_f32 v36, v216, v217
    v_cvt_pk_bf16_f32 v37, v218, v219
    v_cvt_pk_bf16_f32 v38, v220, v221
    v_cvt_pk_bf16_f32 v39, v222, v223
    s_nop 0
    v_mfma_f32_16x16x16_bf16 v[144:147], v[14:15], v[32:33], 0
    v_mfma_f32_16x16x16_bf16 v[148:151], v[14:15], v[34:35], 0
    v_mfma_f32_16x16x16_bf16 v[152:155], v[14:15], v[36:37], 0
    v_mfma_f32_16x16x16_bf16 v[156:159], v[14:15], v[38:39], 0
    v_cvt_pk_bf16_f32 v48, v224, v225
    v_cvt_pk_bf16_f32 v49, v226, v227
    v_cvt_pk_bf16_f32 v50, v228, v229
    v_cvt_pk_bf16_f32 v51, v230, v231
    v_cvt_pk_bf16_f32 v52, v232, v233
    v_cvt_pk_bf16_f32 v53, v234, v235
    v_cvt_pk_bf16_f32 v54, v236, v237
    v_cvt_pk_bf16_f32 v55, v238, v239
    s_nop 5
    v_cvt_pk_bf16_f32 v144, v144, v145
    v_cvt_pk_bf16_f32 v146, v146, v147
    v_cvt_pk_bf16_f32 v148, v148, v149
    v_cvt_pk_bf16_f32 v150, v150, v151
    v_cvt_pk_bf16_f32 v152, v152, v153
    v_cvt_pk_bf16_f32 v154, v154, v155
    v_cvt_pk_bf16_f32 v156, v156, v157
    v_cvt_pk_bf16_f32 v158, v158, v159
    v_and_b32 v145, 0xffff0000, v144
    v_lshlrev_b32 v144, 16, v144
    v_and_b32 v147, 0xffff0000, v146
    v_lshlrev_b32 v146, 16, v146
    v_and_b32 v149, 0xffff0000, v148
    v_lshlrev_b32 v148, 16, v148
    v_and_b32 v151, 0xffff0000, v150
    v_lshlrev_b32 v150, 16, v150
    v_and_b32 v153, 0xffff0000, v152
    v_lshlrev_b32 v152, 16, v152
    v_and_b32 v155, 0xffff0000, v154
    v_lshlrev_b32 v154, 16, v154
    v_and_b32 v157, 0xffff0000, v156
    v_lshlrev_b32 v156, 16, v156
    v_and_b32 v159, 0xffff0000, v158
    v_lshlrev_b32 v158, 16, v158
    v_max3_f32 v80, v144, v145, v146
    v_min3_f32 v88, v144, v145, v146
    v_max3_f32 v82, v148, v149, v150
    v_min3_f32 v90, v148, v149, v150
    v_max3_f32 v84, v152, v153, v154
    v_min3_f32 v92, v152, v153, v154
    v_max3_f32 v86, v156, v157, v158
    v_min3_f32 v94, v156, v157, v158
    v_max_f32 v80, v80, v147
    v_min_f32 v88, v88, v147
    v_max_f32 v82, v82, v151
    v_min_f32 v90, v90, v151
    v_max_f32 v84, v84, v155
    v_min_f32 v92, v92, v155
    v_max_f32 v86, v86, v159
    v_min_f32 v94, v94, v159
    s_nop 0
    v_permlane16_swap_b32 v80, v82
    v_permlane16_swap_b32 v84, v86
    v_permlane16_swap_b32 v88, v90
    v_permlane16_swap_b32 v92, v94
    s_nop 0
    v_max_f32 v80, v80, v82
    v_max_f32 v84, v84, v86
    v_min_f32 v88, v88, v90
    v_min_f32 v92, v92, v94
    s_nop 0
    v_permlane32_swap_b32 v80, v84
    v_permlane32_swap_b32 v88, v92
    s_nop 0
    v_max_f32 v80, v80, v84
    v_min_f32 v88, v88, v92
    s_mov_b32 s60, 0x3fb8aa3b
    s_mov_b32 s61, 0x3fb8aa3b
    v_mul_f32 v80, s60, v80
    v_mul_f32 v88, s60, v88
    v_mov_b32 v84, v80
    v_mov_b32 v92, v88
    s_nop 1
    v_permlane32_swap_b32 v80, v84
    v_permlane32_swap_b32 v88, v92
    s_nop 0
    v_mov_b32 v82, v80
    v_mov_b32 v86, v84
    v_mov_b32 v90, v88
    v_mov_b32 v94, v92
    s_nop 0
    v_permlane16_swap_b32 v80, v82
    v_permlane16_swap_b32 v84, v86
    v_permlane16_swap_b32 v88, v90
    v_permlane16_swap_b32 v92, v94
    s_nop 0
    v_pk_fma_f32 v[96:97], v[144:145], s[60:61], v[80:81] op_sel_hi:[1,1,0] neg_lo:[0,0,1] neg_hi:[0,0,1]
    v_pk_fma_f32 v[100:101], v[144:145], s[60:61], v[88:89] op_sel_hi:[1,1,0] neg_lo:[1,0,0] neg_hi:[1,0,0]
    v_pk_fma_f32 v[98:99], v[146:147], s[60:61], v[80:81] op_sel_hi:[1,1,0] neg_lo:[0,0,1] neg_hi:[0,0,1]
    v_pk_fma_f32 v[102:103], v[146:147], s[60:61], v[88:89] op_sel_hi:[1,1,0] neg_lo:[1,0,0] neg_hi:[1,0,0]
    v_pk_fma_f32 v[104:105], v[148:149], s[60:61], v[82:83] op_sel_hi:[1,1,0] neg_lo:[0,0,1] neg_hi:[0,0,1]
    v_pk_fma_f32 v[108:109], v[148:149], s[60:61], v[90:91] op_sel_hi:[1,1,0] neg_lo:[1,0,0] neg_hi:[1,0,0]
    v_pk_fma_f32 v[106:107], v[150:151], s[60:61], v[82:83] op_sel_hi:[1,1,0] neg_lo:[0,0,1] neg_hi:[0,0,1]
    v_pk_fma_f32 v[110:111], v[150:151], s[60:61], v[90:91] op_sel_hi:[1,1,0] neg_lo:[1,0,0] neg_hi:[1,0,0]
    v_pk_fma_f32 v[112:113], v[152:153], s[60:61], v[84:85] op_sel_hi:[1,1,0] neg_lo:[0,0,1] neg_hi:[0,0,1]
    v_pk_fma_f32 v[116:117], v[152:153], s[60:61], v[92:93] op_sel_hi:[1,1,0] neg_lo:[1,0,0] neg_hi:[1,0,0]
    v_pk_fma_f32 v[114:115], v[154:155], s[60:61], v[84:85] op_sel_hi:[1,1,0] neg_lo:[0,0,1] neg_hi:[0,0,1]
    v_pk_fma_f32 v[118:119], v[154:155], s[60:61], v[92:93] op_sel_hi:[1,1,0] neg_lo:[1,0,0] neg_hi:[1,0,0]
    v_pk_fma_f32 v[120:121], v[156:157], s[60:61], v[86:87] op_sel_hi:[1,1,0] neg_lo:[0,0,1] neg_hi:[0,0,1]
    v_pk_fma_f32 v[124:125], v[156:157], s[60:61], v[94:95] op_sel_hi:[1,1,0] neg_lo:[1,0,0] neg_hi:[1,0,0]
    v_pk_fma_f32 v[122:123], v[158:159], s[60:61], v[86:87] op_sel_hi:[1,1,0] neg_lo:[0,0,1] neg_hi:[0,0,1]
    v_pk_fma_f32 v[126:127], v[158:159], s[60:61], v[94:95] op_sel_hi:[1,1,0] neg_lo:[1,0,0] neg_hi:[1,0,0]
    v_exp_f32 v96, v96
    v_exp_f32 v97, v97
    v_exp_f32 v98, v98
    v_exp_f32 v99, v99
    v_exp_f32 v100, v100
    v_exp_f32 v101, v101
    v_exp_f32 v102, v102
    v_exp_f32 v103, v103
    v_exp_f32 v104, v104
    v_exp_f32 v105, v105
    v_exp_f32 v106, v106
    v_exp_f32 v107, v107
    v_exp_f32 v108, v108
    v_exp_f32 v109, v109
    v_exp_f32 v110, v110
    v_exp_f32 v111, v111
    v_pk_add_f32 v[128:129], v[96:97], v[98:99]
    v_pk_add_f32 v[130:131], v[100:101], v[102:103]
    v_exp_f32 v112, v112
    v_exp_f32 v113, v113
    v_exp_f32 v114, v114
    v_exp_f32 v115, v115
    v_exp_f32 v116, v116
    v_exp_f32 v117, v117
    v_exp_f32 v118, v118
    v_exp_f32 v119, v119
    v_pk_add_f32 v[132:133], v[104:105], v[106:107]
    v_pk_add_f32 v[134:135], v[108:109], v[110:111]
    v_exp_f32 v120, v120
    v_exp_f32 v121, v121
    v_exp_f32 v122, v122
    v_exp_f32 v123, v123
    v_exp_f32 v124, v124
    v_exp_f32 v125, v125
    v_exp_f32 v126, v126
    v_exp_f32 v127, v127
    v_pk_add_f32 v[136:137], v[112:113], v[114:115]
    v_pk_add_f32 v[138:139], v[116:117], v[118:119]
    s_nop 0
    v_pk_add_f32 v[140:141], v[120:121], v[122:123]
    v_pk_add_f32 v[142:143], v[124:125], v[126:127]
    v_add_f32 v80, v128, v129
    v_add_f32 v88, v130, v131
    v_add_f32 v82, v132, v133
    v_add_f32 v90, v134, v135
    v_add_f32 v84, v136, v137
    v_add_f32 v92, v138, v139
    v_add_f32 v86, v140, v141
    v_add_f32 v94, v142, v143
    s_nop 0
    v_permlane16_swap_b32 v80, v82
    v_permlane16_swap_b32 v84, v86
    v_permlane16_swap_b32 v88, v90
    v_permlane16_swap_b32 v92, v94
    s_nop 0
    v_add_f32 v80, v80, v82
    v_add_f32 v84, v84, v86
    v_add_f32 v88, v88, v90
    v_add_f32 v92, v92, v94
    s_nop 0
    v_permlane32_swap_b32 v80, v84
    v_permlane32_swap_b32 v88, v92
    s_nop 0
    v_add_f32 v80, v80, v84
    v_add_f32 v88, v88, v92
    v_rcp_f32 v80, v80
    v_rcp_f32 v88, v88
    s_nop 0
    v_mov_b32 v84, v80
    v_mov_b32 v92, v88
    s_nop 1
    v_permlane32_swap_b32 v80, v84
    v_permlane32_swap_b32 v88, v92
    s_nop 0
    v_mov_b32 v82, v80
    v_mov_b32 v86, v84
    v_mov_b32 v90, v88
    v_mov_b32 v94, v92
    s_nop 0
    v_permlane16_swap_b32 v80, v82
    v_permlane16_swap_b32 v84, v86
    v_permlane16_swap_b32 v88, v90
    v_permlane16_swap_b32 v92, v94
    s_nop 0
    v_pk_mul_f32 v[96:97], v[96:97], v[80:81] op_sel_hi:[1,0]
    v_pk_mul_f32 v[100:101], v[100:101], v[88:89] op_sel_hi:[1,0]
    v_pk_mul_f32 v[98:99], v[98:99], v[80:81] op_sel_hi:[1,0]
    v_pk_mul_f32 v[102:103], v[102:103], v[88:89] op_sel_hi:[1,0]
    v_pk_mul_f32 v[104:105], v[104:105], v[82:83] op_sel_hi:[1,0]
    v_pk_mul_f32 v[108:109], v[108:109], v[90:91] op_sel_hi:[1,0]
    v_pk_mul_f32 v[106:107], v[106:107], v[82:83] op_sel_hi:[1,0]
    v_pk_mul_f32 v[110:111], v[110:111], v[90:91] op_sel_hi:[1,0]
    v_pk_mul_f32 v[112:113], v[112:113], v[84:85] op_sel_hi:[1,0]
    v_pk_mul_f32 v[116:117], v[116:117], v[92:93] op_sel_hi:[1,0]
    v_pk_mul_f32 v[114:115], v[114:115], v[84:85] op_sel_hi:[1,0]
    v_pk_mul_f32 v[118:119], v[118:119], v[92:93] op_sel_hi:[1,0]
    v_pk_mul_f32 v[120:121], v[120:121], v[86:87] op_sel_hi:[1,0]
    v_pk_mul_f32 v[124:125], v[124:125], v[94:95] op_sel_hi:[1,0]
    v_pk_mul_f32 v[122:123], v[122:123], v[86:87] op_sel_hi:[1,0]
    v_pk_mul_f32 v[126:127], v[126:127], v[94:95] op_sel_hi:[1,0]
    v_cvt_pk_bf16_f32 v160, v96, v97
    v_cvt_pk_bf16_f32 v161, v98, v99
    v_cvt_pk_bf16_f32 v162, v100, v101
    v_cvt_pk_bf16_f32 v163, v102, v103
    ds_write_b64 v12, v[160:161] offset:0
    ds_write_b64 v12, v[162:163] offset:32
    v_cvt_pk_bf16_f32 v164, v104, v105
    v_cvt_pk_bf16_f32 v165, v106, v107
    v_cvt_pk_bf16_f32 v166, v108, v109
    v_cvt_pk_bf16_f32 v167, v110, v111
    ds_write_b64 v12, v[164:165] offset:1024
    ds_write_b64 v12, v[166:167] offset:1056
    v_cvt_pk_bf16_f32 v168, v112, v113
    v_cvt_pk_bf16_f32 v169, v114, v115
    v_cvt_pk_bf16_f32 v170, v116, v117
    v_cvt_pk_bf16_f32 v171, v118, v119
    ds_write_b64 v12, v[168:169] offset:2048
    ds_write_b64 v12, v[170:171] offset:2080
    v_cvt_pk_bf16_f32 v172, v120, v121
    v_cvt_pk_bf16_f32 v173, v122, v123
    v_cvt_pk_bf16_f32 v174, v124, v125
    v_cvt_pk_bf16_f32 v175, v126, v127
    ds_write_b64 v12, v[172:173] offset:3072
    ds_write_b64 v12, v[174:175] offset:3104
    v_lshlrev_b32 v12, 8, v2
    v_lshl_add_u32 v12, v3, 6, v12
    v_lshl_add_u32 v12, v4, 3, v12
    v_add_u32 v12, s57, v12
    v_mov_b32 v176, 0x3f803f80
    v_mov_b32 v177, 0x3f803f80
    v_mov_b32 v178, 0x3f803f80
    v_mov_b32 v179, 0x3f803f80
    s_waitcnt lgkmcnt(0)
    ds_read_b64_tr_b16 v[128:129], v12 offset:0
    ds_read_b64_tr_b16 v[130:131], v12 offset:1024
    ds_read_b64_tr_b16 v[132:133], v12 offset:32
    ds_read_b64_tr_b16 v[134:135], v12 offset:1056
    ds_read_b64_tr_b16 v[136:137], v12 offset:2048
    ds_read_b64_tr_b16 v[138:139], v12 offset:3072
    ds_read_b64_tr_b16 v[140:141], v12 offset:2080
    ds_read_b64_tr_b16 v[142:143], v12 offset:3104
    v_lshlrev_b32 v12, 2, v1
    s_lshl_b32 s58, s7, 2
    s_add_u32 s58, s58, s3
    s_lshl_b32 s39, s58, 10
    s_add_u32 s39, s39, 129024
    s_mul_i32 s58, s58, 2048
    s_add_u32 s58, s58, 65536
    v_cmp_eq_u32 vcc, 1, v2
    s_waitcnt lgkmcnt(0)
    v_mfma_f32_16x16x32_bf16 v[208:211], v[48:51], v[128:131], 0
    v_mfma_f32_16x16x32_bf16 v[212:215], v[48:51], v[132:135], 0
    v_mfma_f32_16x16x32_bf16 v[216:219], v[176:179], v[128:131], 0
    v_mfma_f32_16x16x32_bf16 v[220:223], v[176:179], v[132:135], 0
    v_mfma_f32_16x16x32_bf16 v[208:211], v[52:55], v[136:139], v[208:211]
    v_mfma_f32_16x16x32_bf16 v[212:215], v[52:55], v[140:143], v[212:215]
    v_mfma_f32_16x16x32_bf16 v[216:219], v[176:179], v[136:139], v[216:219]
    v_mfma_f32_16x16x32_bf16 v[220:223], v[176:179], v[140:143], v[220:223]
    s_waitcnt vmcnt(4)
    s_nop 6
    buffer_atomic_add_f32 v208, v12, s[40:43], s58 offen offset:0 sc0 sc1
    buffer_atomic_add_f32 v209, v12, s[40:43], s58 offen offset:256 sc0 sc1
    buffer_atomic_add_f32 v210, v12, s[40:43], s58 offen offset:512 sc0 sc1
    buffer_atomic_add_f32 v211, v12, s[40:43], s58 offen offset:768 sc0 sc1
    buffer_atomic_add_f32 v212, v12, s[40:43], s58 offen offset:1024 sc0 sc1
    buffer_atomic_add_f32 v213, v12, s[40:43], s58 offen offset:1280 sc0 sc1
    buffer_atomic_add_f32 v214, v12, s[40:43], s58 offen offset:1536 sc0 sc1
    buffer_atomic_add_f32 v215, v12, s[40:43], s58 offen offset:1792 sc0 sc1
    v_cndmask_b32 v216, v216, v220, vcc
    s_mov_b64 exec, 0xffffffff
    buffer_atomic_add_f32 v216, v12, s[40:43], s39 offen offset:2048 sc0 sc1
    s_mov_b64 exec, -1
    s_barrier
    ds_read_b64_tr_b16 a[0:1], v7 offset:0
    ds_read_b64_tr_b16 a[2:3], v7 offset:512
    ds_read_b64_tr_b16 a[12:13], v7 offset:4096
    ds_read_b64_tr_b16 a[14:15], v7 offset:4608
    ds_read_b64_tr_b16 a[24:25], v7 offset:8192
    ds_read_b64_tr_b16 a[26:27], v7 offset:8704
    ds_read_b64_tr_b16 a[36:37], v7 offset:12288
    ds_read_b64_tr_b16 a[38:39], v7 offset:12800
    ds_read_b64_tr_b16 a[48:49], v7 offset:16384
    ds_read_b64_tr_b16 a[50:51], v7 offset:16896
    ds_read_b64_tr_b16 a[60:61], v7 offset:20480
    ds_read_b64_tr_b16 a[62:63], v7 offset:20992
    ds_read_b64_tr_b16 a[72:73], v7 offset:24576
    ds_read_b64_tr_b16 a[74:75], v7 offset:25088
    ds_read_b64_tr_b16 a[84:85], v7 offset:28672
    ds_read_b64_tr_b16 a[86:87], v7 offset:29184
    ds_read_b64_tr_b16 a[96:97], v7 offset:32768
    ds_read_b64_tr_b16 a[98:99], v7 offset:33280
    ds_read_b64_tr_b16 a[108:109], v7 offset:36864
    ds_read_b64_tr_b16 a[110:111], v7 offset:37376
    ds_read_b64_tr_b16 a[120:121], v7 offset:40960
    ds_read_b64_tr_b16 a[122:123], v7 offset:41472
    ds_read_b64_tr_b16 a[132:133], v7 offset:45056
    ds_read_b64_tr_b16 a[134:135], v7 offset:45568
    ds_read_b64_tr_b16 a[144:145], v7 offset:49152
    ds_read_b64_tr_b16 a[146:147], v7 offset:49664
    ds_read_b64_tr_b16 a[156:157], v7 offset:53248
    ds_read_b64_tr_b16 a[158:159], v7 offset:53760
    ds_read_b64_tr_b16 a[168:169], v7 offset:57344
    ds_read_b64_tr_b16 a[170:171], v7 offset:57856
    ds_read_b64_tr_b16 a[180:181], v7 offset:61440
    ds_read_b64_tr_b16 a[182:183], v7 offset:61952
    v_lshrrev_b32 v12, 3, v1
    v_and_b32 v9, 7, v1
    v_and_b32 v6, 3, v12
    s_and_b32 s48, s3, 1
    v_xor_b32 v6, s48, v6
    v_lshlrev_b32 v6, 1, v6
    v_xor_b32 v9, v9, v6
    v_lshlrev_b32 v12, 10, v12
    v_lshl_add_u32 v9, v9, 4, v12
    s_lshl_b32 s48, s3, 13
    s_lshl_b32 s49, s7, 7
    s_add_u32 s44, s48, s49
    s_lshl_b32 s45, s3, 10
    s_mov_b32 s24, s8
    s_mov_b32 s25, s9
    s_and_b32 s25, s25, 0xffff
    s_mov_b32 s26, 0x80000
    s_mov_b32 s27, 0x00020000
    s_waitcnt lgkmcnt(0)
    ds_read_b128 a[192:195], v11 offset:0
    ds_read_b128 a[196:199], v11 offset:16384
    ds_read_b128 a[200:203], v11 offset:32768
    ds_read_b128 a[204:207], v11 offset:49152
    ds_read_b128 a[208:211], v13 offset:1024
    ds_read_b128 a[212:215], v13 offset:17408
    ds_read_b128 a[216:219], v13 offset:33792
    ds_read_b128 a[220:223], v13 offset:50176
    ds_read_b128 a[224:227], v11 offset:2048
    ds_read_b128 a[228:231], v11 offset:18432
    ds_read_b128 a[232:235], v11 offset:34816
    ds_read_b128 a[236:239], v11 offset:51200
    s_waitcnt lgkmcnt(8)
    v_mfma_f32_16x16x32_bf16 v[192:195], a[0:3], a[192:195], 0
    ds_read_b128 a[240:243], v13 offset:3072
    ds_read_b128 a[244:247], v13 offset:19456
    ds_read_b128 a[248:251], v13 offset:35840
    v_mfma_f32_16x16x32_bf16 v[196:199], a[0:3], a[196:199], 0
    ds_read_b128 a[252:255], v13 offset:52224
    v_lshlrev_b32 v16, 2, v1
    v_mfma_f32_16x16x32_bf16 v[200:203], a[0:3], a[200:203], 0
    v_add_u32 v17, 147456, v16
    ds_read_b32 v18, v17 offset:0
    ds_read_b32 v19, v17 offset:256
    v_mfma_f32_16x16x32_bf16 v[204:207], a[0:3], a[204:207], 0
    ds_read_b32 v20, v17 offset:512
    ds_read_b32 v21, v17 offset:768
    s_waitcnt lgkmcnt(12)
    v_mfma_f32_16x16x32_bf16 v[192:195], a[12:15], a[208:211], v[192:195]
    ds_read_b128 a[192:195], v11 offset:4096
    v_mfma_f32_16x16x32_bf16 v[196:199], a[12:15], a[212:215], v[196:199]
    ds_read_b128 a[196:199], v11 offset:20480
    v_mfma_f32_16x16x32_bf16 v[200:203], a[12:15], a[216:219], v[200:203]
    ds_read_b128 a[200:203], v11 offset:36864
    v_mfma_f32_16x16x32_bf16 v[204:207], a[12:15], a[220:223], v[204:207]
    ds_read_b128 a[204:207], v11 offset:53248
    s_waitcnt lgkmcnt(12)
    v_mfma_f32_16x16x32_bf16 v[192:195], a[24:27], a[224:227], v[192:195]
    ds_read_b128 a[208:211], v13 offset:5120
    v_mfma_f32_16x16x32_bf16 v[196:199], a[24:27], a[228:231], v[196:199]
    ds_read_b128 a[212:215], v13 offset:21504
    v_mfma_f32_16x16x32_bf16 v[200:203], a[24:27], a[232:235], v[200:203]
    ds_read_b128 a[216:219], v13 offset:37888
    v_mfma_f32_16x16x32_bf16 v[204:207], a[24:27], a[236:239], v[204:207]
    ds_read_b128 a[220:223], v13 offset:54272
    s_waitcnt lgkmcnt(12)
    v_mfma_f32_16x16x32_bf16 v[192:195], a[36:39], a[240:243], v[192:195]
    ds_read_b128 a[224:227], v11 offset:6144
    ds_read_b128 a[228:231], v11 offset:22528
    ds_read_b128 a[232:235], v11 offset:38912
    v_mfma_f32_16x16x32_bf16 v[196:199], a[36:39], a[244:247], v[196:199]
    ds_read_b128 a[236:239], v11 offset:55296
    s_waitcnt lgkmcnt(12)
    v_mfma_f32_16x16x32_bf16 v[200:203], a[36:39], a[248:251], v[200:203]
    v_add_f32 v18, v18, v19
    v_add_f32 v20, v20, v21
    v_mfma_f32_16x16x32_bf16 v[204:207], a[36:39], a[252:255], v[204:207]
    v_add_f32 v18, v18, v20
    s_mov_b32 exec_lo, s70
    s_mov_b32 exec_hi, s70
    buffer_atomic_swap v18, v16, s[40:43], s69 offen sc0 sc1
    s_mov_b64 exec, -1
    s_waitcnt lgkmcnt(8)
    v_mfma_f32_16x16x32_bf16 v[192:195], a[48:51], a[192:195], v[192:195]
    ds_read_b128 a[240:243], v13 offset:7168
    v_mfma_f32_16x16x32_bf16 v[196:199], a[48:51], a[196:199], v[196:199]
    ds_read_b128 a[244:247], v13 offset:23552
    v_mfma_f32_16x16x32_bf16 v[200:203], a[48:51], a[200:203], v[200:203]
    ds_read_b128 a[248:251], v13 offset:39936
    v_mfma_f32_16x16x32_bf16 v[204:207], a[48:51], a[204:207], v[204:207]
    ds_read_b128 a[252:255], v13 offset:56320
    s_waitcnt lgkmcnt(8)
    v_mfma_f32_16x16x32_bf16 v[192:195], a[60:63], a[208:211], v[192:195]
    ds_read_b128 a[192:195], v11 offset:8192
    v_mfma_f32_16x16x32_bf16 v[196:199], a[60:63], a[212:215], v[196:199]
    ds_read_b128 a[196:199], v11 offset:24576
    v_mfma_f32_16x16x32_bf16 v[200:203], a[60:63], a[216:219], v[200:203]
    ds_read_b128 a[200:203], v11 offset:40960
    v_mfma_f32_16x16x32_bf16 v[204:207], a[60:63], a[220:223], v[204:207]
    ds_read_b128 a[204:207], v11 offset:57344
    s_waitcnt lgkmcnt(8)
    v_mfma_f32_16x16x32_bf16 v[192:195], a[72:75], a[224:227], v[192:195]
    ds_read_b128 a[208:211], v13 offset:9216
    v_mfma_f32_16x16x32_bf16 v[196:199], a[72:75], a[228:231], v[196:199]
    ds_read_b128 a[212:215], v13 offset:25600
    v_mfma_f32_16x16x32_bf16 v[200:203], a[72:75], a[232:235], v[200:203]
    ds_read_b128 a[216:219], v13 offset:41984
PG80:
    s_cbranch_execz PG96
    v_mfma_f32_16x16x32_bf16 v[204:207], a[72:75], a[236:239], v[204:207]
    ds_read_b128 a[220:223], v13 offset:58368
    s_waitcnt lgkmcnt(8)
    v_mfma_f32_16x16x32_bf16 v[192:195], a[84:87], a[240:243], v[192:195]
    ds_read_b128 a[224:227], v11 offset:10240
    v_mfma_f32_16x16x32_bf16 v[196:199], a[84:87], a[244:247], v[196:199]
    ds_read_b128 a[228:231], v11 offset:26624
    v_mfma_f32_16x16x32_bf16 v[200:203], a[84:87], a[248:251], v[200:203]
    ds_read_b128 a[232:235], v11 offset:43008
    v_mfma_f32_16x16x32_bf16 v[204:207], a[84:87], a[252:255], v[204:207]
    ds_read_b128 a[236:239], v11 offset:59392
    s_waitcnt lgkmcnt(8)
    v_mfma_f32_16x16x32_bf16 v[192:195], a[96:99], a[192:195], v[192:195]
    ds_read_b128 a[240:243], v13 offset:11264
    v_mfma_f32_16x16x32_bf16 v[196:199], a[96:99], a[196:199], v[196:199]
    ds_read_b128 a[244:247], v13 offset:27648
    v_mfma_f32_16x16x32_bf16 v[200:203], a[96:99], a[200:203], v[200:203]
    ds_read_b128 a[248:251], v13 offset:44032
    v_mfma_f32_16x16x32_bf16 v[204:207], a[96:99], a[204:207], v[204:207]
    ds_read_b128 a[252:255], v13 offset:60416
    s_waitcnt lgkmcnt(8)
    v_mfma_f32_16x16x32_bf16 v[192:195], a[108:111], a[208:211], v[192:195]
    ds_read_b128 a[192:195], v11 offset:12288
    v_mfma_f32_16x16x32_bf16 v[196:199], a[108:111], a[212:215], v[196:199]
    ds_read_b128 a[196:199], v11 offset:28672
    v_mfma_f32_16x16x32_bf16 v[200:203], a[108:111], a[216:219], v[200:203]
    ds_read_b128 a[200:203], v11 offset:45056
    v_mfma_f32_16x16x32_bf16 v[204:207], a[108:111], a[220:223], v[204:207]
    ds_read_b128 a[204:207], v11 offset:61440
    s_waitcnt lgkmcnt(8)
    v_mfma_f32_16x16x32_bf16 v[192:195], a[120:123], a[224:227], v[192:195]
    ds_read_b128 a[208:211], v13 offset:13312
    v_mfma_f32_16x16x32_bf16 v[196:199], a[120:123], a[228:231], v[196:199]
    ds_read_b128 a[212:215], v13 offset:29696
    v_mfma_f32_16x16x32_bf16 v[200:203], a[120:123], a[232:235], v[200:203]
    ds_read_b128 a[216:219], v13 offset:46080
    v_mfma_f32_16x16x32_bf16 v[204:207], a[120:123], a[236:239], v[204:207]
    ds_read_b128 a[220:223], v13 offset:62464
    s_waitcnt lgkmcnt(8)
    v_mfma_f32_16x16x32_bf16 v[192:195], a[132:135], a[240:243], v[192:195]
    ds_read_b128 a[224:227], v11 offset:14336
    v_mfma_f32_16x16x32_bf16 v[196:199], a[132:135], a[244:247], v[196:199]
    ds_read_b128 a[228:231], v11 offset:30720
    v_mfma_f32_16x16x32_bf16 v[200:203], a[132:135], a[248:251], v[200:203]
    ds_read_b128 a[232:235], v11 offset:47104
    v_mfma_f32_16x16x32_bf16 v[204:207], a[132:135], a[252:255], v[204:207]
    ds_read_b128 a[236:239], v11 offset:63488
    s_waitcnt lgkmcnt(8)
    v_mfma_f32_16x16x32_bf16 v[192:195], a[144:147], a[192:195], v[192:195]
    ds_read_b128 a[240:243], v13 offset:15360
    v_mfma_f32_16x16x32_bf16 v[196:199], a[144:147], a[196:199], v[196:199]
    ds_read_b128 a[244:247], v13 offset:31744
    v_mfma_f32_16x16x32_bf16 v[200:203], a[144:147], a[200:203], v[200:203]
    ds_read_b128 a[248:251], v13 offset:48128
    v_mfma_f32_16x16x32_bf16 v[204:207], a[144:147], a[204:207], v[204:207]
    ds_read_b128 a[252:255], v13 offset:64512
    s_waitcnt lgkmcnt(8)
    v_mfma_f32_16x16x32_bf16 v[192:195], a[156:159], a[208:211], v[192:195]
    v_mfma_f32_16x16x32_bf16 v[196:199], a[156:159], a[212:215], v[196:199]
    v_mfma_f32_16x16x32_bf16 v[200:203], a[156:159], a[216:219], v[200:203]
    v_mfma_f32_16x16x32_bf16 v[204:207], a[156:159], a[220:223], v[204:207]
    s_waitcnt lgkmcnt(4)
    v_mfma_f32_16x16x32_bf16 v[192:195], a[168:171], a[224:227], v[192:195]
    v_mfma_f32_16x16x32_bf16 v[196:199], a[168:171], a[228:231], v[196:199]
    v_mfma_f32_16x16x32_bf16 v[200:203], a[168:171], a[232:235], v[200:203]
    v_mfma_f32_16x16x32_bf16 v[204:207], a[168:171], a[236:239], v[204:207]
    s_waitcnt lgkmcnt(0)
    v_mfma_f32_16x16x32_bf16 v[192:195], a[180:183], a[240:243], v[192:195]
    v_mfma_f32_16x16x32_bf16 v[196:199], a[180:183], a[244:247], v[196:199]
    v_mfma_f32_16x16x32_bf16 v[200:203], a[180:183], a[248:251], v[200:203]
    v_mfma_f32_16x16x32_bf16 v[204:207], a[180:183], a[252:255], v[204:207]
    s_barrier
    v_cvt_pk_bf16_f32 v32, v192, v193
    v_cvt_pk_bf16_f32 v33, v194, v195
    v_cvt_pk_bf16_f32 v34, v196, v197
    v_cvt_pk_bf16_f32 v35, v198, v199
    v_cvt_pk_bf16_f32 v36, v200, v201
    v_cvt_pk_bf16_f32 v37, v202, v203
    s_add_u32 m0, s45, 0
    s_add_u32 s50, s44, 0
    buffer_load_dwordx4 v9, s[24:27], s50 offen lds
    v_cvt_pk_bf16_f32 v38, v204, v205
    v_cvt_pk_bf16_f32 v39, v206, v207
    s_nop 0
    v_mfma_f32_16x16x16_bf16 v[144:147], v[14:15], v[32:33], 0
    v_mfma_f32_16x16x16_bf16 v[148:151], v[14:15], v[34:35], 0
    v_mfma_f32_16x16x16_bf16 v[152:155], v[14:15], v[36:37], 0
    s_add_u32 m0, s45, 4096
    s_add_u32 s50, s44, 32768
    buffer_load_dwordx4 v9, s[24:27], s50 offen lds
    v_mfma_f32_16x16x16_bf16 v[156:159], v[14:15], v[38:39], 0
    s_nop 5
    v_cvt_pk_bf16_f32 v144, v144, v145
    v_cvt_pk_bf16_f32 v146, v146, v147
    v_cvt_pk_bf16_f32 v148, v148, v149
    v_cvt_pk_bf16_f32 v150, v150, v151
    s_add_u32 m0, s45, 8192
    s_add_u32 s50, s44, 65536
    buffer_load_dwordx4 v9, s[24:27], s50 offen lds
    v_cvt_pk_bf16_f32 v152, v152, v153
    v_cvt_pk_bf16_f32 v154, v154, v155
    v_cvt_pk_bf16_f32 v156, v156, v157
    v_cvt_pk_bf16_f32 v158, v158, v159
    v_and_b32 v145, 0xffff0000, v144
    v_lshlrev_b32 v144, 16, v144
    s_add_u32 m0, s45, 12288
    s_add_u32 s50, s44, 98304
    buffer_load_dwordx4 v9, s[24:27], s50 offen lds
    v_and_b32 v147, 0xffff0000, v146
    v_lshlrev_b32 v146, 16, v146
    v_and_b32 v149, 0xffff0000, v148
    v_lshlrev_b32 v148, 16, v148
    v_and_b32 v151, 0xffff0000, v150
    v_lshlrev_b32 v150, 16, v150
    s_add_u32 m0, s45, 16384
    s_add_u32 s50, s44, 131072
    buffer_load_dwordx4 v9, s[24:27], s50 offen lds
    v_and_b32 v153, 0xffff0000, v152
    v_lshlrev_b32 v152, 16, v152
    v_and_b32 v155, 0xffff0000, v154
    v_lshlrev_b32 v154, 16, v154
    v_and_b32 v157, 0xffff0000, v156
    v_lshlrev_b32 v156, 16, v156
    s_add_u32 m0, s45, 20480
    s_add_u32 s50, s44, 163840
    buffer_load_dwordx4 v9, s[24:27], s50 offen lds
    v_and_b32 v159, 0xffff0000, v158
    v_lshlrev_b32 v158, 16, v158
    v_max3_f32 v80, v144, v145, v146
    v_min3_f32 v88, v144, v145, v146
    v_max3_f32 v82, v148, v149, v150
    v_min3_f32 v90, v148, v149, v150
    s_add_u32 m0, s45, 24576
    s_add_u32 s50, s44, 196608
    buffer_load_dwordx4 v9, s[24:27], s50 offen lds
    v_max3_f32 v84, v152, v153, v154
    v_min3_f32 v92, v152, v153, v154
    v_max3_f32 v86, v156, v157, v158
    v_min3_f32 v94, v156, v157, v158
    v_max_f32 v80, v80, v147
    v_min_f32 v88, v88, v147
    s_add_u32 m0, s45, 28672
    s_add_u32 s50, s44, 229376
    buffer_load_dwordx4 v9, s[24:27], s50 offen lds
    v_max_f32 v82, v82, v151
    v_min_f32 v90, v90, v151
    v_max_f32 v84, v84, v155
    v_min_f32 v92, v92, v155
    v_max_f32 v86, v86, v159
    v_min_f32 v94, v94, v159
    s_add_u32 m0, s45, 32768
    s_add_u32 s50, s44, 262144
    buffer_load_dwordx4 v9, s[24:27], s50 offen lds
    s_nop 0
    v_permlane16_swap_b32 v80, v82
    v_permlane16_swap_b32 v84, v86
    v_permlane16_swap_b32 v88, v90
    v_permlane16_swap_b32 v92, v94
    s_nop 0
    s_add_u32 m0, s45, 36864
    s_add_u32 s50, s44, 294912
    buffer_load_dwordx4 v9, s[24:27], s50 offen lds
    s_waitcnt vmcnt(10)
    s_barrier
    s_cmp_lg_u32 s3, 0
    s_cbranch_scc1 B1_A
    v_lshlrev_b32 v12, 12, v1
    v_mov_b32 v16, s71
    s_lshl_b32 s48, s2, 4
    s_add_u32 s48, s48, 393216
    s_mov_b64 exec, 255
    buffer_store_dword v16, v12, s[40:43], s48 offen sc1
    s_mov_b64 exec, -1
    B1_A:
    v_max_f32 v80, v80, v82
    v_max_f32 v84, v84, v86
    v_min_f32 v88, v88, v90
    v_min_f32 v92, v92, v94
    s_nop 0
    v_permlane32_swap_b32 v80, v84
    s_add_u32 m0, s45, 40960
    s_add_u32 s50, s44, 327680
    buffer_load_dwordx4 v9, s[24:27], s50 offen lds
    v_permlane32_swap_b32 v88, v92
    s_nop 0
    v_max_f32 v80, v80, v84
    v_min_f32 v88, v88, v92
    s_mov_b32 s60, 0x3fb8aa3b
    s_mov_b32 s61, 0x3fb8aa3b
    s_add_u32 m0, s45, 45056
    s_add_u32 s50, s44, 360448
    buffer_load_dwordx4 v9, s[24:27], s50 offen lds
    v_mul_f32 v80, s60, v80
    v_mul_f32 v88, s60, v88
    v_mov_b32 v84, v80
    v_mov_b32 v92, v88
    s_nop 1
    v_permlane32_swap_b32 v80, v84
    s_add_u32 m0, s45, 49152
    s_add_u32 s50, s44, 393216
    buffer_load_dwordx4 v9, s[24:27], s50 offen lds
    v_permlane32_swap_b32 v88, v92
    s_nop 0
    v_mov_b32 v82, v80
    v_mov_b32 v86, v84
    v_mov_b32 v90, v88
    v_mov_b32 v94, v92
    s_add_u32 m0, s45, 53248
    s_add_u32 s50, s44, 425984
    buffer_load_dwordx4 v9, s[24:27], s50 offen lds
    s_nop 0
    v_permlane16_swap_b32 v80, v82
    v_permlane16_swap_b32 v84, v86
    v_permlane16_swap_b32 v88, v90
    v_permlane16_swap_b32 v92, v94
    s_nop 0
    s_add_u32 m0, s45, 57344
    s_add_u32 s50, s44, 458752
    buffer_load_dwordx4 v9, s[24:27], s50 offen lds
    v_pk_fma_f32 v[96:97], v[144:145], s[60:61], v[80:81] op_sel_hi:[1,1,0] neg_lo:[0,0,1] neg_hi:[0,0,1]
    v_pk_fma_f32 v[100:101], v[144:145], s[60:61], v[88:89] op_sel_hi:[1,1,0] neg_lo:[1,0,0] neg_hi:[1,0,0]
    v_pk_fma_f32 v[98:99], v[146:147], s[60:61], v[80:81] op_sel_hi:[1,1,0] neg_lo:[0,0,1] neg_hi:[0,0,1]
    v_pk_fma_f32 v[102:103], v[146:147], s[60:61], v[88:89] op_sel_hi:[1,1,0] neg_lo:[1,0,0] neg_hi:[1,0,0]
    v_pk_fma_f32 v[104:105], v[148:149], s[60:61], v[82:83] op_sel_hi:[1,1,0] neg_lo:[0,0,1] neg_hi:[0,0,1]
    v_pk_fma_f32 v[108:109], v[148:149], s[60:61], v[90:91] op_sel_hi:[1,1,0] neg_lo:[1,0,0] neg_hi:[1,0,0]
    s_add_u32 m0, s45, 61440
    s_add_u32 s50, s44, 491520
    buffer_load_dwordx4 v9, s[24:27], s50 offen lds
    v_pk_fma_f32 v[106:107], v[150:151], s[60:61], v[82:83] op_sel_hi:[1,1,0] neg_lo:[0,0,1] neg_hi:[0,0,1]
    v_pk_fma_f32 v[110:111], v[150:151], s[60:61], v[90:91] op_sel_hi:[1,1,0] neg_lo:[1,0,0] neg_hi:[1,0,0]
    v_pk_fma_f32 v[112:113], v[152:153], s[60:61], v[84:85] op_sel_hi:[1,1,0] neg_lo:[0,0,1] neg_hi:[0,0,1]
    v_pk_fma_f32 v[116:117], v[152:153], s[60:61], v[92:93] op_sel_hi:[1,1,0] neg_lo:[1,0,0] neg_hi:[1,0,0]
    v_pk_fma_f32 v[114:115], v[154:155], s[60:61], v[84:85] op_sel_hi:[1,1,0] neg_lo:[0,0,1] neg_hi:[0,0,1]
    v_pk_fma_f32 v[118:119], v[154:155], s[60:61], v[92:93] op_sel_hi:[1,1,0] neg_lo:[1,0,0] neg_hi:[1,0,0]
    s_add_u32 m0, s35, 73728
    s_add_u32 s50, s34, 0
    buffer_load_dwordx4 v60, s[28:31], s50 offen lds
    v_pk_fma_f32 v[120:121], v[156:157], s[60:61], v[86:87] op_sel_hi:[1,1,0] neg_lo:[0,0,1] neg_hi:[0,0,1]
    v_pk_fma_f32 v[124:125], v[156:157], s[60:61], v[94:95] op_sel_hi:[1,1,0] neg_lo:[1,0,0] neg_hi:[1,0,0]
    v_pk_fma_f32 v[122:123], v[158:159], s[60:61], v[86:87] op_sel_hi:[1,1,0] neg_lo:[0,0,1] neg_hi:[0,0,1]
    v_pk_fma_f32 v[126:127], v[158:159], s[60:61], v[94:95] op_sel_hi:[1,1,0] neg_lo:[1,0,0] neg_hi:[1,0,0]
    v_exp_f32 v96, v96
    v_exp_f32 v97, v97
    s_add_u32 m0, s35, 74752
    s_add_u32 s50, s34, 0
    buffer_load_dwordx4 v61, s[28:31], s50 offen lds
    v_exp_f32 v98, v98
    v_exp_f32 v99, v99
    v_exp_f32 v100, v100
    v_exp_f32 v101, v101
    v_exp_f32 v102, v102
    v_exp_f32 v103, v103
    s_add_u32 m0, s35, 75776
    s_add_u32 s50, s34, 0
    buffer_load_dwordx4 v62, s[28:31], s50 offen lds
    v_exp_f32 v104, v104
    v_exp_f32 v105, v105
    v_exp_f32 v106, v106
    v_exp_f32 v107, v107
    v_exp_f32 v108, v108
    v_exp_f32 v109, v109
    s_add_u32 m0, s35, 86016
    s_add_u32 s50, s34, 88064
    buffer_load_dwordx4 v60, s[28:31], s50 offen lds
    v_exp_f32 v110, v110
    v_exp_f32 v111, v111
    v_pk_add_f32 v[128:129], v[96:97], v[98:99]
    v_pk_add_f32 v[130:131], v[100:101], v[102:103]
    v_exp_f32 v112, v112
    v_exp_f32 v113, v113
    s_add_u32 m0, s35, 87040
    s_add_u32 s50, s34, 88064
    buffer_load_dwordx4 v61, s[28:31], s50 offen lds
    v_exp_f32 v114, v114
    v_exp_f32 v115, v115
    v_exp_f32 v116, v116
    v_exp_f32 v117, v117
    v_exp_f32 v118, v118
    v_exp_f32 v119, v119
    s_add_u32 m0, s35, 88064
    s_add_u32 s50, s34, 88064
    buffer_load_dwordx4 v62, s[28:31], s50 offen lds
    v_pk_add_f32 v[132:133], v[104:105], v[106:107]
    v_pk_add_f32 v[134:135], v[108:109], v[110:111]
    v_exp_f32 v120, v120
    v_exp_f32 v121, v121
    v_exp_f32 v122, v122
    v_exp_f32 v123, v123
    s_add_u32 m0, s35, 98304
    s_add_u32 s50, s34, 176128
    buffer_load_dwordx4 v60, s[28:31], s50 offen lds
    v_exp_f32 v124, v124
    v_exp_f32 v125, v125
    v_exp_f32 v126, v126
    v_exp_f32 v127, v127
    v_pk_add_f32 v[136:137], v[112:113], v[114:115]
    v_pk_add_f32 v[138:139], v[116:117], v[118:119]
    s_add_u32 m0, s35, 99328
    s_add_u32 s50, s34, 176128
    buffer_load_dwordx4 v61, s[28:31], s50 offen lds
    s_nop 0
    v_pk_add_f32 v[140:141], v[120:121], v[122:123]
    v_pk_add_f32 v[142:143], v[124:125], v[126:127]
    v_add_f32 v80, v128, v129
    v_add_f32 v88, v130, v131
    v_add_f32 v82, v132, v133
    s_add_u32 m0, s35, 100352
    s_add_u32 s50, s34, 176128
    buffer_load_dwordx4 v62, s[28:31], s50 offen lds
    v_add_f32 v90, v134, v135
    v_add_f32 v84, v136, v137
    v_add_f32 v92, v138, v139
    v_add_f32 v86, v140, v141
    v_add_f32 v94, v142, v143
    s_nop 0
    s_add_u32 m0, s35, 110592
    s_add_u32 s50, s34, 264192
    buffer_load_dwordx4 v60, s[28:31], s50 offen lds
    v_permlane16_swap_b32 v80, v82
    v_permlane16_swap_b32 v84, v86
    v_permlane16_swap_b32 v88, v90
    v_permlane16_swap_b32 v92, v94
    s_nop 0
    v_add_f32 v80, v80, v82
    s_add_u32 m0, s35, 111616
    s_add_u32 s50, s34, 264192
    buffer_load_dwordx4 v61, s[28:31], s50 offen lds
    v_add_f32 v84, v84, v86
    v_add_f32 v88, v88, v90
    v_add_f32 v92, v92, v94
    s_nop 0
    v_permlane32_swap_b32 v80, v84
    v_permlane32_swap_b32 v88, v92
    s_add_u32 m0, s35, 112640
    s_add_u32 s50, s34, 264192
    buffer_load_dwordx4 v62, s[28:31], s50 offen lds
    s_nop 0
    v_add_f32 v80, v80, v84
    v_add_f32 v88, v88, v92
    v_rcp_f32 v80, v80
    v_rcp_f32 v88, v88
    s_nop 0
    s_add_u32 m0, s35, 122880
    s_add_u32 s50, s34, 352256
    buffer_load_dwordx4 v60, s[28:31], s50 offen lds
    v_mov_b32 v84, v80
    v_mov_b32 v92, v88
    s_nop 1
    v_permlane32_swap_b32 v80, v84
    v_permlane32_swap_b32 v88, v92
    s_nop 0
    s_add_u32 m0, s35, 123904
    s_add_u32 s50, s34, 352256
    buffer_load_dwordx4 v61, s[28:31], s50 offen lds
    v_mov_b32 v82, v80
    v_mov_b32 v86, v84
    v_mov_b32 v90, v88
    v_mov_b32 v94, v92
    s_nop 0
    v_permlane16_swap_b32 v80, v82
    s_add_u32 m0, s35, 124928
    s_add_u32 s50, s34, 352256
    buffer_load_dwordx4 v62, s[28:31], s50 offen lds
    v_permlane16_swap_b32 v84, v86
    v_permlane16_swap_b32 v88, v90
    v_permlane16_swap_b32 v92, v94
    s_nop 0
    v_pk_mul_f32 v[96:97], v[96:97], v[80:81] op_sel_hi:[1,0]
    v_pk_mul_f32 v[100:101], v[100:101], v[88:89] op_sel_hi:[1,0]
    s_add_u32 m0, s35, 135168
    s_add_u32 s50, s34, 440320
    buffer_load_dwordx4 v60, s[28:31], s50 offen lds
    v_pk_mul_f32 v[98:99], v[98:99], v[80:81] op_sel_hi:[1,0]
    v_pk_mul_f32 v[102:103], v[102:103], v[88:89] op_sel_hi:[1,0]
    v_pk_mul_f32 v[104:105], v[104:105], v[82:83] op_sel_hi:[1,0]
    v_pk_mul_f32 v[108:109], v[108:109], v[90:91] op_sel_hi:[1,0]
    v_pk_mul_f32 v[106:107], v[106:107], v[82:83] op_sel_hi:[1,0]
    v_pk_mul_f32 v[110:111], v[110:111], v[90:91] op_sel_hi:[1,0]
    s_add_u32 m0, s35, 136192
    s_add_u32 s50, s34, 440320
    buffer_load_dwordx4 v61, s[28:31], s50 offen lds
    v_pk_mul_f32 v[112:113], v[112:113], v[84:85] op_sel_hi:[1,0]
    v_pk_mul_f32 v[116:117], v[116:117], v[92:93] op_sel_hi:[1,0]
    v_pk_mul_f32 v[114:115], v[114:115], v[84:85] op_sel_hi:[1,0]
    v_pk_mul_f32 v[118:119], v[118:119], v[92:93] op_sel_hi:[1,0]
    v_pk_mul_f32 v[120:121], v[120:121], v[86:87] op_sel_hi:[1,0]
    v_pk_mul_f32 v[124:125], v[124:125], v[94:95] op_sel_hi:[1,0]
    s_add_u32 m0, s35, 137216
    s_add_u32 s50, s34, 440320
    buffer_load_dwordx4 v62, s[28:31], s50 offen lds
    v_pk_mul_f32 v[122:123], v[122:123], v[86:87] op_sel_hi:[1,0]
    v_pk_mul_f32 v[126:127], v[126:127], v[94:95] op_sel_hi:[1,0]
    v_cvt_pk_bf16_f32 v64, v96, v97
    v_cvt_pk_bf16_f32 v65, v98, v99
    v_cvt_pk_bf16_f32 v66, v100, v101
    v_cvt_pk_bf16_f32 v67, v102, v103
    s_add_u32 m0, s35, 147456
    s_add_u32 s50, s34, 528384
    buffer_load_dwordx4 v60, s[28:31], s50 offen lds
    v_cvt_pk_bf16_f32 v68, v104, v105
    v_cvt_pk_bf16_f32 v69, v106, v107
    v_cvt_pk_bf16_f32 v70, v108, v109
    v_cvt_pk_bf16_f32 v71, v110, v111
    v_cvt_pk_bf16_f32 v72, v112, v113
    v_cvt_pk_bf16_f32 v73, v114, v115
    s_add_u32 m0, s35, 148480
    s_add_u32 s50, s34, 528384
    buffer_load_dwordx4 v61, s[28:31], s50 offen lds
    v_cvt_pk_bf16_f32 v74, v116, v117
    v_cvt_pk_bf16_f32 v75, v118, v119
    v_cvt_pk_bf16_f32 v76, v120, v121
    v_cvt_pk_bf16_f32 v77, v122, v123
    v_cvt_pk_bf16_f32 v78, v124, v125
    v_cvt_pk_bf16_f32 v79, v126, v127
    s_add_u32 m0, s35, 149504
    s_add_u32 s50, s34, 528384
    buffer_load_dwordx4 v62, s[28:31], s50 offen lds
    v_lshlrev_b32 v12, 10, v5
    v_lshl_add_u32 v12, v2, 3, v12
    s_lshl_b32 s54, s6, 6
    s_lshl_b32 s55, s3, 4
    s_add_u32 s54, s54, s55
    s_lshl_b32 s56, s54, 10
    s_lshl_b32 s57, s7, 7
    s_add_u32 s56, s56, s57
    buffer_load_dwordx2 v[224:225], v12, s[20:23], s56 offen offset:0
    buffer_load_dwordx2 v[226:227], v12, s[20:23], s56 offen offset:32
    buffer_load_dwordx2 v[228:229], v12, s[20:23], s56 offen offset:64
    buffer_load_dwordx2 v[230:231], v12, s[20:23], s56 offen offset:96
    v_lshlrev_b32 v12, 10, v2
    v_lshl_add_u32 v12, v3, 7, v12
    v_lshl_add_u32 v12, v4, 3, v12
    v_and_b32 v13, 1, v2
    v_xor_b32 v13, v13, v3
    v_lshl_add_u32 v6, v13, 5, v12
    v_xor_b32 v7, 32, v6
    v_xor_b32 v10, 64, v6
    v_xor_b32 v11, 96, v6
    v_lshlrev_b32 v41, 8, v4
    v_lshl_add_u32 v41, v3, 6, v41
    v_lshl_add_u32 v41, v2, 4, v41
    v_mov_b32 v44, 160768
    s_cmp_lg_u32 s3, 0
    s_cbranch_scc1 B1_W
    v_lshlrev_b32 v12, 6, v1
    s_and_b32 s48, s2, 7
    s_lshl_b32 s48, s48, 12
    s_add_u32 s48, s48, 393216
    s_mov_b32 s49, 0
    s_sleep 6
B1_P:
    buffer_load_dword v16, v12, s[40:43], s48 offen offset:0 sc1
    buffer_load_dword v17, v12, s[40:43], s48 offen offset:16 sc1
    buffer_load_dword v18, v12, s[40:43], s48 offen offset:32 sc1
    buffer_load_dword v19, v12, s[40:43], s48 offen offset:48 sc1
    s_add_u32 s49, s49, 1
    s_mov_b32 s71, 0
    s_cmp_gt_u32 s49, 400000
    s_cbranch_scc1 B1_T
    s_waitcnt vmcnt(0)
    v_min_u32 v20, v16, v17
    v_min_u32 v21, v18, v19
    v_min_u32 v20, v20, v21
    v_cmp_eq_u32 vcc, 0, v20
    s_cbranch_vccz B1_OK
    s_sleep 6
    s_branch B1_P
B1_OK:
    v_lshl_or_b32 v20, v17, 8, v16
    v_lshl_or_b32 v21, v19, 8, v18
    v_and_b32 v23, 1, v1
    v_lshl_or_b32 v20, v21, 16, v20
    v_cmp_eq_u32 vcc, 1, v23
    s_nop 0
    v_readlane_b32 s48, v20, 0
    v_readlane_b32 s49, v20, 1
    s_nop 1
    v_mov_b32 v21, s48
    v_mov_b32 v22, s49
    v_cndmask_b32 v21, v21, v22, vcc
    v_cmp_ne_u32 vcc, v20, v21
    s_cmp_eq_u64 vcc, 0
    s_cselect_b32 s71, 1, 0
B1_T:
    v_mov_b32 v20, s71
    ds_write_b32 v44, v20
    s_branch B1_W2
B1_W:
    s_mov_b64 exec, 0
    s_cmp_eq_u32 s3, 1
    s_cbranch_scc1 PG128
    s_cmp_eq_u32 s3, 2
    s_cbranch_scc1 PG144
    s_branch PG160
PW_S3:
    s_mov_b64 exec, -1
B1_W2:
    s_waitcnt vmcnt(0) lgkmcnt(0)
    s_barrier
    ds_read_b32 v45, v44
    v_lshlrev_b32 v40, 2, v1
    v_lshlrev_b32 v13, 4, v2
    buffer_load_dwordx4 v[16:19], v41, s[40:43], s58 offen sc1
    buffer_load_dwordx4 v[20:23], v41, s[40:43], s58 offen offset:1024 sc1
    buffer_load_dwordx4 v[24:27], v13, s[40:43], s39 offen offset:2048 sc1
    buffer_load_dwordx4 v[28:31], v13, s[40:43], s39 offen offset:2112 sc1
    s_mov_b32 s48, 2048*4
    s_cmp_eq_u32 s3, 0
    s_cselect_b32 s48, 1024*4, s48
    s_cmp_eq_u32 s3, 1
    s_cselect_b32 s48, 2560*4, s48
    s_lshl_b32 s49, s7, 8
    s_add_u32 s48, s48, s49
    s_add_u32 s49, s48, 0
    buffer_load_dword v232, v40, s[40:43], s49 offen sc1
    s_add_u32 s49, s48, 12288
    buffer_load_dword v233, v40, s[40:43], s49 offen sc1
    s_add_u32 s49, s48, 24576
    buffer_load_dword v234, v40, s[40:43], s49 offen sc1
    s_add_u32 s49, s48, 36864
    buffer_load_dword v235, v40, s[40:43], s49 offen sc1
    v_and_b32 v9, 1, v2
    v_lshrrev_b32 v42, 1, v2
    v_lshlrev_b32 v9, 14, v9
    v_lshl_add_u32 v9, v42, 8, v9
    v_lshl_add_u32 v9, v5, 4, v9
    s_lshl_b32 s55, s6, 16
    s_add_u32 s55, s55, 3145728
    s_lshl_b32 s48, s7, 2
    s_add_u32 s48, s48, s3
    s_lshl_b32 s48, s48, 9
    s_add_u32 s48, s48, s55
    s_add_u32 s49, s48, 32768
    s_mov_b32 s60, 0x358637bd
    ds_read_b64_tr_b16 a[0:1], v6 offset:0
    ds_read_b64_tr_b16 a[2:3], v6 offset:512
    ds_read_b64_tr_b16 a[4:5], v7 offset:0
    ds_read_b64_tr_b16 a[6:7], v7 offset:512
    ds_read_b64_tr_b16 a[8:9], v10 offset:0
    ds_read_b64_tr_b16 a[10:11], v10 offset:512
    ds_read_b64_tr_b16 a[12:13], v11 offset:0
    ds_read_b64_tr_b16 a[14:15], v11 offset:512
    ds_read_b64_tr_b16 a[16:17], v6 offset:4096
    ds_read_b64_tr_b16 a[18:19], v6 offset:4608
    ds_read_b64_tr_b16 a[20:21], v7 offset:4096
    ds_read_b64_tr_b16 a[22:23], v7 offset:4608
    ds_read_b64_tr_b16 a[24:25], v10 offset:4096
    ds_read_b64_tr_b16 a[26:27], v10 offset:4608
    ds_read_b64_tr_b16 a[28:29], v11 offset:4096
    ds_read_b64_tr_b16 a[30:31], v11 offset:4608
    ds_read_b64_tr_b16 a[32:33], v6 offset:8192
    ds_read_b64_tr_b16 a[34:35], v6 offset:8704
    ds_read_b64_tr_b16 a[36:37], v7 offset:8192
    ds_read_b64_tr_b16 a[38:39], v7 offset:8704
    ds_read_b64_tr_b16 a[40:41], v10 offset:8192
    ds_read_b64_tr_b16 a[42:43], v10 offset:8704
    ds_read_b64_tr_b16 a[44:45], v11 offset:8192
    ds_read_b64_tr_b16 a[46:47], v11 offset:8704
    ds_read_b64_tr_b16 a[48:49], v6 offset:12288
    ds_read_b64_tr_b16 a[50:51], v6 offset:12800
    ds_read_b64_tr_b16 a[52:53], v7 offset:12288
    ds_read_b64_tr_b16 a[54:55], v7 offset:12800
    ds_read_b64_tr_b16 a[56:57], v10 offset:12288
    ds_read_b64_tr_b16 a[58:59], v10 offset:12800
    ds_read_b64_tr_b16 a[60:61], v11 offset:12288
    ds_read_b64_tr_b16 a[62:63], v11 offset:12800
    ds_read_b64_tr_b16 a[64:65], v6 offset:16384
    ds_read_b64_tr_b16 a[66:67], v6 offset:16896
    ds_read_b64_tr_b16 a[68:69], v7 offset:16384
    ds_read_b64_tr_b16 a[70:71], v7 offset:16896
    ds_read_b64_tr_b16 a[72:73], v10 offset:16384
    ds_read_b64_tr_b16 a[74:75], v10 offset:16896
    ds_read_b64_tr_b16 a[76:77], v11 offset:16384
    ds_read_b64_tr_b16 a[78:79], v11 offset:16896
    ds_read_b64_tr_b16 a[80:81], v6 offset:20480
    ds_read_b64_tr_b16 a[82:83], v6 offset:20992
    ds_read_b64_tr_b16 a[84:85], v7 offset:20480
    ds_read_b64_tr_b16 a[86:87], v7 offset:20992
    ds_read_b64_tr_b16 a[88:89], v10 offset:20480
    ds_read_b64_tr_b16 a[90:91], v10 offset:20992
    ds_read_b64_tr_b16 a[92:93], v11 offset:20480
    ds_read_b64_tr_b16 a[94:95], v11 offset:20992
    s_waitcnt lgkmcnt(15)
    v_readfirstlane_b32 s71, v45
    s_waitcnt vmcnt(4)
    v_cvt_pk_bf16_f32 v16, v16, v17
    v_cvt_pk_bf16_f32 v17, v18, v19
    v_cvt_pk_bf16_f32 v18, v20, v21
    v_cvt_pk_bf16_f32 v19, v22, v23
    v_cvt_pk_bf16_f32 v20, v24, v25
    v_cvt_pk_bf16_f32 v21, v26, v27
    v_cvt_pk_bf16_f32 v22, v28, v29
    v_cvt_pk_bf16_f32 v23, v30, v31
    s_nop 0
    v_mfma_f32_16x16x32_bf16 v[132:135], v[20:23], v[64:67], 0
    v_mfma_f32_16x16x32_bf16 v[140:143], v[20:23], v[68:71], 0
    v_mfma_f32_16x16x32_bf16 v[148:151], v[20:23], v[72:75], 0
    v_mfma_f32_16x16x32_bf16 v[156:159], v[20:23], v[76:79], 0
    v_mfma_f32_16x16x32_bf16 v[128:131], v[16:19], v[64:67], 0
    v_mfma_f32_16x16x32_bf16 v[136:139], v[16:19], v[68:71], 0
    v_mfma_f32_16x16x32_bf16 v[144:147], v[16:19], v[72:75], 0
    v_mfma_f32_16x16x32_bf16 v[152:155], v[16:19], v[76:79], 0
    s_nop 1
    v_add_f32 v132, s60, v132
    v_add_f32 v140, s60, v140
    v_add_f32 v148, s60, v148
    v_add_f32 v156, s60, v156
    v_rcp_f32 v132, v132
    v_rcp_f32 v140, v140
    v_rcp_f32 v148, v148
    v_rcp_f32 v156, v156
    s_nop 3
    v_mul_f32 v128, v128, v132
    v_mul_f32 v129, v129, v132
    v_mul_f32 v130, v130, v132
    v_mul_f32 v131, v131, v132
    v_mul_f32 v136, v136, v140
    v_mul_f32 v137, v137, v140
    v_mul_f32 v138, v138, v140
    v_mul_f32 v139, v139, v140
    v_cvt_pk_bf16_f32 v160, v128, v129
    v_cvt_pk_bf16_f32 v161, v130, v131
    v_cvt_pk_bf16_f32 v162, v136, v137
    v_cvt_pk_bf16_f32 v163, v138, v139
    s_nop 0
    v_permlane16_swap_b32 v160, v162
    v_permlane16_swap_b32 v161, v163
    s_nop 0
    s_cmp_lg_u32 s71, 0
    s_cbranch_scc1 DS3453_F
    buffer_store_dwordx4 v[160:163], v9, s[40:43], s48 offen sc1
    s_branch DS3453_E
DS3453_F:
    buffer_store_dwordx4 v[160:163], v9, s[40:43], s48 offen
DS3453_E:
    v_mul_f32 v144, v144, v148
    v_mul_f32 v145, v145, v148
    v_mul_f32 v146, v146, v148
    v_mul_f32 v147, v147, v148
    v_mul_f32 v152, v152, v156
    v_mul_f32 v153, v153, v156
    v_mul_f32 v154, v154, v156
    v_mul_f32 v155, v155, v156
    v_cvt_pk_bf16_f32 v164, v144, v145
    v_cvt_pk_bf16_f32 v165, v146, v147
    v_cvt_pk_bf16_f32 v166, v152, v153
    v_cvt_pk_bf16_f32 v167, v154, v155
    s_nop 0
    v_permlane16_swap_b32 v164, v166
PG96:
    s_cbranch_execz PG112
    v_permlane16_swap_b32 v165, v167
    s_nop 0
    s_cmp_lg_u32 s71, 0
    s_cbranch_scc1 DS3476_F
    buffer_store_dwordx4 v[164:167], v9, s[40:43], s49 offen sc1
    s_branch DS3476_E
DS3476_F:
    buffer_store_dwordx4 v[164:167], v9, s[40:43], s49 offen
DS3476_E:
    ds_read_b64_tr_b16 a[96:97], v6 offset:24576
    ds_read_b64_tr_b16 a[98:99], v6 offset:25088
    ds_read_b64_tr_b16 a[100:101], v7 offset:24576
    ds_read_b64_tr_b16 a[102:103], v7 offset:25088
    ds_read_b64_tr_b16 a[104:105], v10 offset:24576
    ds_read_b64_tr_b16 a[106:107], v10 offset:25088
    ds_read_b64_tr_b16 a[108:109], v11 offset:24576
    ds_read_b64_tr_b16 a[110:111], v11 offset:25088
    ds_read_b64_tr_b16 a[112:113], v6 offset:28672
    ds_read_b64_tr_b16 a[114:115], v6 offset:29184
    ds_read_b64_tr_b16 a[116:117], v7 offset:28672
    ds_read_b64_tr_b16 a[118:119], v7 offset:29184
    ds_read_b64_tr_b16 a[120:121], v10 offset:28672
    ds_read_b64_tr_b16 a[122:123], v10 offset:29184
    ds_read_b64_tr_b16 a[124:125], v11 offset:28672
    ds_read_b64_tr_b16 a[126:127], v11 offset:29184
    ds_read_b64_tr_b16 a[128:129], v6 offset:32768
    ds_read_b64_tr_b16 a[130:131], v6 offset:33280
    ds_read_b64_tr_b16 a[132:133], v7 offset:32768
    ds_read_b64_tr_b16 a[134:135], v7 offset:33280
    ds_read_b64_tr_b16 a[136:137], v10 offset:32768
    ds_read_b64_tr_b16 a[138:139], v10 offset:33280
    ds_read_b64_tr_b16 a[140:141], v11 offset:32768
    ds_read_b64_tr_b16 a[142:143], v11 offset:33280
    ds_read_b64_tr_b16 a[144:145], v6 offset:36864
    ds_read_b64_tr_b16 a[146:147], v6 offset:37376
    ds_read_b64_tr_b16 a[148:149], v7 offset:36864
    ds_read_b64_tr_b16 a[150:151], v7 offset:37376
    ds_read_b64_tr_b16 a[152:153], v10 offset:36864
    ds_read_b64_tr_b16 a[154:155], v10 offset:37376
    ds_read_b64_tr_b16 a[156:157], v11 offset:36864
    ds_read_b64_tr_b16 a[158:159], v11 offset:37376
    ds_read_b64_tr_b16 a[160:161], v6 offset:40960
    ds_read_b64_tr_b16 a[162:163], v6 offset:41472
    ds_read_b64_tr_b16 a[164:165], v7 offset:40960
    ds_read_b64_tr_b16 a[166:167], v7 offset:41472
    ds_read_b64_tr_b16 a[168:169], v10 offset:40960
    ds_read_b64_tr_b16 a[170:171], v10 offset:41472
    ds_read_b64_tr_b16 a[172:173], v11 offset:40960
    ds_read_b64_tr_b16 a[174:175], v11 offset:41472
    s_waitcnt vmcnt(0)
    s_barrier
    s_lshl_b32 s48, s6, 7
    s_add_u32 s48, s48, 425984
    s_cmp_lg_u32 s3, 0
    s_cbranch_scc1 G2_A
    v_mov_b32 v13, 1
    v_mov_b32 v12, 0
    s_lshl_b32 s49, s7, 4
    s_add_u32 s49, s49, s48
    s_mov_b64 exec, 1
    s_cmp_lg_u32 s71, 0
    s_cbranch_scc1 DS3534_F
    buffer_store_dword v13, v12, s[40:43], s49 offen sc1
    s_branch DS3534_E
DS3534_F:
    buffer_store_dword v13, v12, s[40:43], s49 offen
DS3534_E:
    s_mov_b64 exec, -1
G2_A:
    ds_read_b64_tr_b16 a[176:177], v6 offset:45056
    ds_read_b64_tr_b16 a[178:179], v6 offset:45568
    ds_read_b64_tr_b16 a[180:181], v7 offset:45056
    ds_read_b64_tr_b16 a[182:183], v7 offset:45568
    ds_read_b64_tr_b16 a[184:185], v10 offset:45056
    ds_read_b64_tr_b16 a[186:187], v10 offset:45568
    ds_read_b64_tr_b16 a[188:189], v11 offset:45056
    ds_read_b64_tr_b16 a[190:191], v11 offset:45568
    ds_read_b64_tr_b16 a[192:193], v6 offset:49152
    ds_read_b64_tr_b16 a[194:195], v6 offset:49664
    ds_read_b64_tr_b16 a[196:197], v7 offset:49152
    ds_read_b64_tr_b16 a[198:199], v7 offset:49664
    ds_read_b64_tr_b16 a[200:201], v10 offset:49152
    ds_read_b64_tr_b16 a[202:203], v10 offset:49664
    ds_read_b64_tr_b16 a[204:205], v11 offset:49152
    ds_read_b64_tr_b16 a[206:207], v11 offset:49664
    ds_read_b64_tr_b16 a[208:209], v6 offset:53248
    ds_read_b64_tr_b16 a[210:211], v6 offset:53760
    ds_read_b64_tr_b16 a[212:213], v7 offset:53248
    ds_read_b64_tr_b16 a[214:215], v7 offset:53760
    ds_read_b64_tr_b16 a[216:217], v10 offset:53248
    ds_read_b64_tr_b16 a[218:219], v10 offset:53760
    ds_read_b64_tr_b16 a[220:221], v11 offset:53248
    ds_read_b64_tr_b16 a[222:223], v11 offset:53760
    ds_read_b64_tr_b16 a[224:225], v6 offset:57344
    ds_read_b64_tr_b16 a[226:227], v6 offset:57856
    ds_read_b64_tr_b16 a[228:229], v7 offset:57344
    ds_read_b64_tr_b16 a[230:231], v7 offset:57856
    ds_read_b64_tr_b16 a[232:233], v10 offset:57344
    ds_read_b64_tr_b16 a[234:235], v10 offset:57856
    ds_read_b64_tr_b16 a[236:237], v11 offset:57344
    ds_read_b64_tr_b16 a[238:239], v11 offset:57856
    ds_read_b64_tr_b16 a[240:241], v6 offset:61440
    ds_read_b64_tr_b16 a[242:243], v6 offset:61952
    ds_read_b64_tr_b16 a[244:245], v7 offset:61440
    ds_read_b64_tr_b16 a[246:247], v7 offset:61952
    ds_read_b64_tr_b16 a[248:249], v10 offset:61440
    ds_read_b64_tr_b16 a[250:251], v10 offset:61952
    ds_read_b64_tr_b16 a[252:253], v11 offset:61440
    ds_read_b64_tr_b16 a[254:255], v11 offset:61952
    v_add_f32 v232, v232, v233
    v_add_f32 v234, v234, v235
    v_add_f32 v232, v232, v234
    v_cvt_pk_bf16_f32 v232, v232, v232
    v_lshlrev_b32 v232, 16, v232
    s_cmp_ge_u32 s3, 2
    s_cselect_b32 s49, 1.0, 0
    v_add_f32 v232, s49, v232
    v_cvt_pk_bf16_f32 v232, v232, v232
    v_lshlrev_b32 v232, 16, v232
    s_min_u32 s49, s3, 2
    s_lshl_b32 s49, s49, 8
    s_add_u32 s49, s49, 159744
    v_add_u32 v40, s49, v40
    ds_write_b32 v40, v232
    s_lshl_b32 s50, s3, 14
    s_add_u32 s55, s55, s50
    s_cmp_lg_u32 s3, 0
    s_cbranch_scc1 G2_W
    s_mov_b64 exec, 255
    s_mov_b32 s49, 0
G2_P:
    buffer_load_dword v13, v8, s[40:43], s48 offen sc1
    s_add_u32 s49, s49, 1
    s_cmp_gt_u32 s49, 400000
    s_cbranch_scc1 G2_W
    s_waitcnt vmcnt(0)
    v_cmp_ne_u32 vcc, 1, v13
    s_cbranch_vccz G2_W
    s_sleep 3
    s_branch G2_P
G2_W:
    s_mov_b64 exec, -1
    s_waitcnt vmcnt(0) lgkmcnt(0)
    s_barrier
    s_add_u32 s48, s55, 0
    buffer_load_dwordx4 v[64:67], v8, s[40:43], s48 offen offset:0
    buffer_load_dwordx4 v[68:71], v8, s[40:43], s48 offen offset:1024
    buffer_load_dwordx4 v[72:75], v8, s[40:43], s48 offen offset:2048
    buffer_load_dwordx4 v[76:79], v8, s[40:43], s48 offen offset:3072
    s_add_u32 s48, s55, 4096
    buffer_load_dwordx4 v[80:83], v8, s[40:43], s48 offen offset:0
    buffer_load_dwordx4 v[84:87], v8, s[40:43], s48 offen offset:1024
    buffer_load_dwordx4 v[88:91], v8, s[40:43], s48 offen offset:2048
    buffer_load_dwordx4 v[92:95], v8, s[40:43], s48 offen offset:3072
    s_add_u32 s48, s55, 8192
    buffer_load_dwordx4 v[96:99], v8, s[40:43], s48 offen offset:0
    buffer_load_dwordx4 v[100:103], v8, s[40:43], s48 offen offset:1024
    buffer_load_dwordx4 v[104:107], v8, s[40:43], s48 offen offset:2048
    buffer_load_dwordx4 v[108:111], v8, s[40:43], s48 offen offset:3072
    s_add_u32 s48, s55, 12288
    buffer_load_dwordx4 v[112:115], v8, s[40:43], s48 offen offset:0
    buffer_load_dwordx4 v[116:119], v8, s[40:43], s48 offen offset:1024
    buffer_load_dwordx4 v[120:123], v8, s[40:43], s48 offen offset:2048
    buffer_load_dwordx4 v[124:127], v8, s[40:43], s48 offen offset:3072
    v_lshlrev_b32 v12, 4, v2
    v_add_u32 v12, 159744, v12
    ds_read_b128 v[232:235], v12 offset:0
    ds_read_b128 v[208:211], v12 offset:512
    ds_read_b128 v[236:239], v12 offset:64
    ds_read_b128 v[212:215], v12 offset:576
    ds_read_b128 v[240:243], v12 offset:128
    ds_read_b128 v[216:219], v12 offset:640
    ds_read_b128 v[244:247], v12 offset:192
    ds_read_b128 v[220:223], v12 offset:704
    s_waitcnt vmcnt(15)
    v_mfma_f32_16x16x32_bf16 v[24:27], a[0:3], v[64:67], 0
    s_add_u32 m0, s35, 0
    v_mfma_f32_16x16x32_bf16 v[28:31], a[4:7], v[64:67], 0
    s_add_u32 s50, s34, 616448
    v_mfma_f32_16x16x32_bf16 v[32:35], a[8:11], v[64:67], 0
    buffer_load_dwordx4 v60, s[28:31], s50 offen lds
    v_mfma_f32_16x16x32_bf16 v[36:39], a[12:15], v[64:67], 0
    s_waitcnt vmcnt(15)
    v_mfma_f32_16x16x32_bf16 v[24:27], a[16:19], v[68:71], v[24:27]
    s_add_u32 m0, s35, 1024
    v_mfma_f32_16x16x32_bf16 v[28:31], a[20:23], v[68:71], v[28:31]
    s_add_u32 s50, s34, 616448
    v_mfma_f32_16x16x32_bf16 v[32:35], a[24:27], v[68:71], v[32:35]
    buffer_load_dwordx4 v61, s[28:31], s50 offen lds
    v_mfma_f32_16x16x32_bf16 v[36:39], a[28:31], v[68:71], v[36:39]
    s_waitcnt vmcnt(15)
    v_mfma_f32_16x16x32_bf16 v[24:27], a[32:35], v[72:75], v[24:27]
    s_add_u32 m0, s35, 2048
    v_mfma_f32_16x16x32_bf16 v[28:31], a[36:39], v[72:75], v[28:31]
    s_add_u32 s50, s34, 616448
    v_mfma_f32_16x16x32_bf16 v[32:35], a[40:43], v[72:75], v[32:35]
    buffer_load_dwordx4 v62, s[28:31], s50 offen lds
    v_mfma_f32_16x16x32_bf16 v[36:39], a[44:47], v[72:75], v[36:39]
    s_waitcnt vmcnt(15)
    v_mfma_f32_16x16x32_bf16 v[24:27], a[48:51], v[76:79], v[24:27]
    s_add_u32 m0, s35, 12288
    v_mfma_f32_16x16x32_bf16 v[28:31], a[52:55], v[76:79], v[28:31]
    s_add_u32 s50, s34, 704512
    v_mfma_f32_16x16x32_bf16 v[32:35], a[56:59], v[76:79], v[32:35]
    buffer_load_dwordx4 v60, s[28:31], s50 offen lds
    v_mfma_f32_16x16x32_bf16 v[36:39], a[60:63], v[76:79], v[36:39]
    s_waitcnt vmcnt(15)
    v_mfma_f32_16x16x32_bf16 v[24:27], a[64:67], v[80:83], v[24:27]
    s_add_u32 m0, s35, 13312
    v_mfma_f32_16x16x32_bf16 v[28:31], a[68:71], v[80:83], v[28:31]
    s_add_u32 s50, s34, 704512
    v_mfma_f32_16x16x32_bf16 v[32:35], a[72:75], v[80:83], v[32:35]
    buffer_load_dwordx4 v61, s[28:31], s50 offen lds
    v_mfma_f32_16x16x32_bf16 v[36:39], a[76:79], v[80:83], v[36:39]
    s_waitcnt vmcnt(15)
    v_mfma_f32_16x16x32_bf16 v[24:27], a[80:83], v[84:87], v[24:27]
    s_add_u32 m0, s35, 14336
    v_mfma_f32_16x16x32_bf16 v[28:31], a[84:87], v[84:87], v[28:31]
    s_add_u32 s50, s34, 704512
    v_mfma_f32_16x16x32_bf16 v[32:35], a[88:91], v[84:87], v[32:35]
    buffer_load_dwordx4 v62, s[28:31], s50 offen lds
    v_mfma_f32_16x16x32_bf16 v[36:39], a[92:95], v[84:87], v[36:39]
    s_waitcnt vmcnt(15)
    v_mfma_f32_16x16x32_bf16 v[24:27], a[96:99], v[88:91], v[24:27]
    s_add_u32 m0, s35, 24576
    v_mfma_f32_16x16x32_bf16 v[28:31], a[100:103], v[88:91], v[28:31]
    s_add_u32 s50, s34, 792576
    v_mfma_f32_16x16x32_bf16 v[32:35], a[104:107], v[88:91], v[32:35]
    buffer_load_dwordx4 v60, s[28:31], s50 offen lds
    v_mfma_f32_16x16x32_bf16 v[36:39], a[108:111], v[88:91], v[36:39]
    s_waitcnt vmcnt(15)
    v_mfma_f32_16x16x32_bf16 v[24:27], a[112:115], v[92:95], v[24:27]
    s_add_u32 m0, s35, 25600
    s_add_u32 s50, s34, 792576
    v_mfma_f32_16x16x32_bf16 v[28:31], a[116:119], v[92:95], v[28:31]
    buffer_load_dwordx4 v61, s[28:31], s50 offen lds
    v_mfma_f32_16x16x32_bf16 v[32:35], a[120:123], v[92:95], v[32:35]
    s_add_u32 m0, s35, 26624
    s_add_u32 s50, s34, 792576
    v_mfma_f32_16x16x32_bf16 v[36:39], a[124:127], v[92:95], v[36:39]
    buffer_load_dwordx4 v62, s[28:31], s50 offen lds
    s_waitcnt vmcnt(16)
    v_mfma_f32_16x16x32_bf16 v[24:27], a[128:131], v[96:99], v[24:27]
    s_add_u32 m0, s35, 36864
    v_mfma_f32_16x16x32_bf16 v[28:31], a[132:135], v[96:99], v[28:31]
    s_add_u32 s50, s34, 880640
    v_mfma_f32_16x16x32_bf16 v[32:35], a[136:139], v[96:99], v[32:35]
    buffer_load_dwordx4 v60, s[28:31], s50 offen lds
    v_mfma_f32_16x16x32_bf16 v[36:39], a[140:143], v[96:99], v[36:39]
    s_waitcnt vmcnt(16)
    v_mfma_f32_16x16x32_bf16 v[24:27], a[144:147], v[100:103], v[24:27]
    s_add_u32 m0, s35, 37888
    v_mfma_f32_16x16x32_bf16 v[28:31], a[148:151], v[100:103], v[28:31]
    s_add_u32 s50, s34, 880640
    v_mfma_f32_16x16x32_bf16 v[32:35], a[152:155], v[100:103], v[32:35]
    buffer_load_dwordx4 v61, s[28:31], s50 offen lds
    v_mfma_f32_16x16x32_bf16 v[36:39], a[156:159], v[100:103], v[36:39]
    s_waitcnt vmcnt(16)
    v_mfma_f32_16x16x32_bf16 v[24:27], a[160:163], v[104:107], v[24:27]
    s_add_u32 m0, s35, 38912
    v_mfma_f32_16x16x32_bf16 v[28:31], a[164:167], v[104:107], v[28:31]
    s_add_u32 s50, s34, 880640
    v_mfma_f32_16x16x32_bf16 v[32:35], a[168:171], v[104:107], v[32:35]
    buffer_load_dwordx4 v62, s[28:31], s50 offen lds
    v_mfma_f32_16x16x32_bf16 v[36:39], a[172:175], v[104:107], v[36:39]
    s_waitcnt vmcnt(16)
    v_mfma_f32_16x16x32_bf16 v[24:27], a[176:179], v[108:111], v[24:27]
    s_add_u32 m0, s35, 49152
    v_mfma_f32_16x16x32_bf16 v[28:31], a[180:183], v[108:111], v[28:31]
    s_add_u32 s50, s34, 968704
    v_mfma_f32_16x16x32_bf16 v[32:35], a[184:187], v[108:111], v[32:35]
    buffer_load_dwordx4 v60, s[28:31], s50 offen lds
    v_mfma_f32_16x16x32_bf16 v[36:39], a[188:191], v[108:111], v[36:39]
    s_waitcnt vmcnt(16)
    v_mfma_f32_16x16x32_bf16 v[24:27], a[192:195], v[112:115], v[24:27]
    s_add_u32 m0, s35, 50176
    v_mfma_f32_16x16x32_bf16 v[28:31], a[196:199], v[112:115], v[28:31]
    s_add_u32 s50, s34, 968704
    v_mfma_f32_16x16x32_bf16 v[32:35], a[200:203], v[112:115], v[32:35]
    buffer_load_dwordx4 v61, s[28:31], s50 offen lds
    v_mfma_f32_16x16x32_bf16 v[36:39], a[204:207], v[112:115], v[36:39]
    s_waitcnt vmcnt(16)
    v_mfma_f32_16x16x32_bf16 v[24:27], a[208:211], v[116:119], v[24:27]
    s_add_u32 m0, s35, 51200
    v_mfma_f32_16x16x32_bf16 v[28:31], a[212:215], v[116:119], v[28:31]
    s_add_u32 s50, s34, 968704
    v_mfma_f32_16x16x32_bf16 v[32:35], a[216:219], v[116:119], v[32:35]
    buffer_load_dwordx4 v62, s[28:31], s50 offen lds
    v_mfma_f32_16x16x32_bf16 v[36:39], a[220:223], v[116:119], v[36:39]
    s_waitcnt vmcnt(16)
    v_mfma_f32_16x16x32_bf16 v[24:27], a[224:227], v[120:123], v[24:27]
    s_add_u32 m0, s35, 61440
    v_mfma_f32_16x16x32_bf16 v[28:31], a[228:231], v[120:123], v[28:31]
    s_add_u32 s50, s34, 1056768
    v_mfma_f32_16x16x32_bf16 v[32:35], a[232:235], v[120:123], v[32:35]
    buffer_load_dwordx4 v60, s[28:31], s50 offen lds
    v_mfma_f32_16x16x32_bf16 v[36:39], a[236:239], v[120:123], v[36:39]
    s_waitcnt vmcnt(16)
    v_mfma_f32_16x16x32_bf16 v[24:27], a[240:243], v[124:127], v[24:27]
    s_add_u32 m0, s35, 62464
    s_add_u32 s50, s34, 1056768
    v_mfma_f32_16x16x32_bf16 v[28:31], a[244:247], v[124:127], v[28:31]
    buffer_load_dwordx4 v61, s[28:31], s50 offen lds
    v_mfma_f32_16x16x32_bf16 v[32:35], a[248:251], v[124:127], v[32:35]
    s_add_u32 m0, s35, 63488
    s_add_u32 s50, s34, 1056768
    v_mfma_f32_16x16x32_bf16 v[36:39], a[252:255], v[124:127], v[36:39]
    buffer_load_dwordx4 v62, s[28:31], s50 offen lds
    v_lshlrev_b32 v64, 16, v224
    v_and_b32 v65, 0xffff0000, v224
    v_lshlrev_b32 v66, 16, v225
    v_and_b32 v67, 0xffff0000, v225
    v_lshlrev_b32 v68, 16, v226
    v_and_b32 v69, 0xffff0000, v226
    v_lshlrev_b32 v70, 16, v227
    v_and_b32 v71, 0xffff0000, v227
    v_lshlrev_b32 v72, 16, v228
    v_and_b32 v73, 0xffff0000, v228
    v_lshlrev_b32 v74, 16, v229
    v_and_b32 v75, 0xffff0000, v229
    v_lshlrev_b32 v76, 16, v230
    v_and_b32 v77, 0xffff0000, v230
    v_lshlrev_b32 v78, 16, v231
    v_and_b32 v79, 0xffff0000, v231
    s_waitcnt lgkmcnt(0)
    s_nop 3
    v_cvt_pk_bf16_f32 v24, v24, v25
    v_cvt_pk_bf16_f32 v26, v26, v27
    v_cvt_pk_bf16_f32 v28, v28, v29
    v_cvt_pk_bf16_f32 v30, v30, v31
    v_cvt_pk_bf16_f32 v32, v32, v33
    v_cvt_pk_bf16_f32 v34, v34, v35
    v_cvt_pk_bf16_f32 v36, v36, v37
    v_cvt_pk_bf16_f32 v38, v38, v39
    v_and_b32 v25, 0xffff0000, v24
    v_lshlrev_b32 v24, 16, v24
    v_and_b32 v27, 0xffff0000, v26
    v_lshlrev_b32 v26, 16, v26
    v_and_b32 v29, 0xffff0000, v28
    v_lshlrev_b32 v28, 16, v28
    v_and_b32 v31, 0xffff0000, v30
    v_lshlrev_b32 v30, 16, v30
    v_and_b32 v33, 0xffff0000, v32
    v_lshlrev_b32 v32, 16, v32
    v_and_b32 v35, 0xffff0000, v34
    v_lshlrev_b32 v34, 16, v34
    v_and_b32 v37, 0xffff0000, v36
    v_lshlrev_b32 v36, 16, v36
    v_and_b32 v39, 0xffff0000, v38
    v_lshlrev_b32 v38, 16, v38
    v_mul_f32 v24, v24, v232
    v_mul_f32 v25, v25, v233
    v_mul_f32 v26, v26, v234
    v_mul_f32 v27, v27, v235
    v_mul_f32 v28, v28, v236
    v_mul_f32 v29, v29, v237
    v_mul_f32 v30, v30, v238
    v_mul_f32 v31, v31, v239
    v_mul_f32 v32, v32, v240
    v_mul_f32 v33, v33, v241
    v_mul_f32 v34, v34, v242
    v_mul_f32 v35, v35, v243
    v_mul_f32 v36, v36, v244
    v_mul_f32 v37, v37, v245
    v_mul_f32 v38, v38, v246
    v_mul_f32 v39, v39, v247
    v_cvt_pk_bf16_f32 v24, v24, v25
    v_cvt_pk_bf16_f32 v26, v26, v27
    v_cvt_pk_bf16_f32 v28, v28, v29
    v_cvt_pk_bf16_f32 v30, v30, v31
    v_cvt_pk_bf16_f32 v32, v32, v33
    v_cvt_pk_bf16_f32 v34, v34, v35
    v_cvt_pk_bf16_f32 v36, v36, v37
    v_cvt_pk_bf16_f32 v38, v38, v39
    v_and_b32 v25, 0xffff0000, v24
    v_lshlrev_b32 v24, 16, v24
    v_and_b32 v27, 0xffff0000, v26
    v_lshlrev_b32 v26, 16, v26
    v_and_b32 v29, 0xffff0000, v28
    v_lshlrev_b32 v28, 16, v28
    v_and_b32 v31, 0xffff0000, v30
    v_lshlrev_b32 v30, 16, v30
    v_and_b32 v33, 0xffff0000, v32
    v_lshlrev_b32 v32, 16, v32
    v_and_b32 v35, 0xffff0000, v34
    v_lshlrev_b32 v34, 16, v34
    v_and_b32 v37, 0xffff0000, v36
    v_lshlrev_b32 v36, 16, v36
    v_and_b32 v39, 0xffff0000, v38
    v_lshlrev_b32 v38, 16, v38
    v_add_f32 v64, v64, v24
    v_add_f32 v65, v65, v25
    v_add_f32 v66, v66, v26
    v_add_f32 v67, v67, v27
    v_add_f32 v68, v68, v28
    v_add_f32 v69, v69, v29
    v_add_f32 v70, v70, v30
    v_add_f32 v71, v71, v31
    v_add_f32 v72, v72, v32
    v_add_f32 v73, v73, v33
    v_add_f32 v74, v74, v34
    v_add_f32 v75, v75, v35
    v_add_f32 v76, v76, v36
    v_add_f32 v77, v77, v37
    v_add_f32 v78, v78, v38
    v_add_f32 v79, v79, v39
    v_cvt_pk_bf16_f32 v80, v64, v65
    v_cvt_pk_bf16_f32 v81, v66, v67
    v_cvt_pk_bf16_f32 v82, v68, v69
    v_cvt_pk_bf16_f32 v83, v70, v71
    v_cvt_pk_bf16_f32 v84, v72, v73
    v_cvt_pk_bf16_f32 v85, v74, v75
    v_cvt_pk_bf16_f32 v86, v76, v77
    v_cvt_pk_bf16_f32 v87, v78, v79
    v_lshlrev_b32 v64, 16, v80
    v_and_b32 v65, 0xffff0000, v80
    v_lshlrev_b32 v66, 16, v81
    v_and_b32 v67, 0xffff0000, v81
    v_lshlrev_b32 v68, 16, v82
    v_and_b32 v69, 0xffff0000, v82
    v_lshlrev_b32 v70, 16, v83
    v_and_b32 v71, 0xffff0000, v83
    v_lshlrev_b32 v72, 16, v84
    v_and_b32 v73, 0xffff0000, v84
    v_lshlrev_b32 v74, 16, v85
    v_and_b32 v75, 0xffff0000, v85
    v_lshlrev_b32 v76, 16, v86
    v_and_b32 v77, 0xffff0000, v86
    v_lshlrev_b32 v78, 16, v87
    v_and_b32 v79, 0xffff0000, v87
    v_pk_mul_f32 v[96:97], v[64:65], v[208:209]
    v_pk_mul_f32 v[98:99], v[66:67], v[210:211]
    v_pk_mul_f32 v[100:101], v[68:69], v[212:213]
    v_pk_mul_f32 v[102:103], v[70:71], v[214:215]
    v_pk_mul_f32 v[104:105], v[72:73], v[216:217]
    v_pk_mul_f32 v[106:107], v[74:75], v[218:219]
    v_pk_mul_f32 v[108:109], v[76:77], v[220:221]
    v_pk_mul_f32 v[110:111], v[78:79], v[222:223]
    v_cvt_pk_bf16_f32 v96, v96, v97
    v_cvt_pk_bf16_f32 v97, v98, v99
    v_cvt_pk_bf16_f32 v98, v100, v101
    v_cvt_pk_bf16_f32 v99, v102, v103
    v_cvt_pk_bf16_f32 v100, v104, v105
    v_cvt_pk_bf16_f32 v101, v106, v107
    v_cvt_pk_bf16_f32 v102, v108, v109
    v_cvt_pk_bf16_f32 v103, v110, v111
    s_lshl_b32 s59, s54, 10
    s_lshl_b32 s57, s7, 11
    s_add_u32 s59, s59, s57
    s_add_u32 s59, s59, 7340032
    s_cmp_lg_u32 s71, 0
    s_cbranch_scc1 DS3924_F
    buffer_store_dwordx4 v[96:99], v8, s[40:43], s59 offen sc1
    buffer_store_dwordx4 v[100:103], v8, s[40:43], s59 offen offset:1024 sc1
    s_branch DS3924_E
DS3924_F:
    buffer_store_dwordx4 v[96:99], v8, s[40:43], s59 offen
    buffer_store_dwordx4 v[100:103], v8, s[40:43], s59 offen offset:1024
DS3924_E:
    s_mov_b32 s46, 0x3f803f80
    v_dot2_f32_bf16 v90, v80, s46, 0
    v_dot2_f32_bf16 v91, v80, v80, 0
    v_dot2_f32_bf16 v92, v81, s46, 0
    v_dot2_f32_bf16 v93, v81, v81, 0
    v_dot2_f32_bf16 v90, v82, s46, v90
    v_dot2_f32_bf16 v91, v82, v82, v91
    v_dot2_f32_bf16 v92, v83, s46, v92
    v_dot2_f32_bf16 v93, v83, v83, v93
    v_dot2_f32_bf16 v90, v84, s46, v90
    v_dot2_f32_bf16 v91, v84, v84, v91
    v_dot2_f32_bf16 v92, v85, s46, v92
    v_dot2_f32_bf16 v93, v85, v85, v93
    v_dot2_f32_bf16 v90, v86, s46, v90
    v_dot2_f32_bf16 v91, v86, v86, v91
    v_dot2_f32_bf16 v92, v87, s46, v92
    v_dot2_f32_bf16 v93, v87, v87, v93
    s_nop 3
    v_add_f32 v90, v90, v92
    v_add_f32 v91, v91, v93
    v_mov_b32 v92, v90
    v_mov_b32 v93, v91
    s_nop 0
    v_permlane16_swap_b32 v90, v92
    v_permlane16_swap_b32 v91, v93
    s_nop 0
    v_add_f32 v90, v90, v92
    v_add_f32 v91, v91, v93
    v_mov_b32 v92, v90
    v_mov_b32 v93, v91
    s_nop 0
    v_permlane32_swap_b32 v90, v92
    v_permlane32_swap_b32 v91, v93
    s_nop 0
    v_add_f32 v90, v90, v92
    v_add_f32 v91, v91, v93
    v_lshlrev_b32 v95, 3, v5
    s_lshl_b32 s57, s6, 3
    s_add_u32 s57, s57, s7
    s_lshl_b32 s57, s57, 9
    s_lshl_b32 s48, s3, 7
    s_add_u32 s57, s57, s48
    s_add_u32 s57, s57, 196608
    s_mov_b64 exec, 0xffff
    s_cmp_lg_u32 s71, 0
    s_cbranch_scc1 DS3977_F
    buffer_store_dwordx2 v[90:91], v95, s[40:43], s57 offen sc1
    s_branch DS3977_E
DS3977_F:
    buffer_store_dwordx2 v[90:91], v95, s[40:43], s57 offen
DS3977_E:
    s_mov_b64 exec, -1
    v_accvgpr_write_b32 a248, v80
    v_accvgpr_write_b32 a249, v81
    v_accvgpr_write_b32 a250, v82
    v_accvgpr_write_b32 a251, v83
    v_accvgpr_write_b32 a252, v84
    v_accvgpr_write_b32 a253, v85
    v_accvgpr_write_b32 a254, v86
    v_accvgpr_write_b32 a255, v87
    s_waitcnt vmcnt(0)
    s_barrier
    s_cmp_lg_u32 s3, 0
    s_cbranch_scc1 G3_A
    v_mov_b32 v13, 1
    v_mov_b32 v12, 0
    s_lshl_b32 s48, s6, 7
    s_lshl_b32 s49, s7, 4
    s_add_u32 s49, s49, s48
    s_add_u32 s49, s49, 430080
    s_mov_b64 exec, 1
    s_cmp_lg_u32 s71, 0
    s_cbranch_scc1 DS4004_F
    buffer_store_dword v13, v12, s[40:43], s49 offen sc1
    s_branch DS4004_E
DS4004_F:
    buffer_store_dword v13, v12, s[40:43], s49 offen
DS4004_E:
    s_mov_b64 exec, -1
G3_A:
    s_load_dwordx2 s[16:17], s[0:1], 56
    v_lshrrev_b32 v12, 3, v1
    v_and_b32 v13, 7, v1
    v_and_b32 v16, 3, v12
    v_lshrrev_b32 v17, 2, v12
    v_xor_b32 v16, v16, v17
    v_lshlrev_b32 v16, 1, v16
    v_xor_b32 v13, v13, v16
    v_lshlrev_b32 v12, 10, v12
    v_lshl_add_u32 v63, v13, 4, v12
    s_lshl_b32 s44, s3, 13
    s_lshl_b32 s45, s7, 7
    s_add_u32 s44, s44, s45
    s_lshl_b32 s45, s3, 10
    s_waitcnt lgkmcnt(0)
    s_mov_b32 s24, s16
    s_mov_b32 s25, s17
    s_and_b32 s25, s25, 0xffff
    s_mov_b32 s26, 0x158000
    s_mov_b32 s27, 0x00020000
    s_cmp_lt_u32 s2, 240
    s_cbranch_scc1 P3_GO
    s_cmp_eq_u32 s2, 255
    s_cbranch_scc1 P3X_S
    v_lshlrev_b32 v12, 3, v0
    s_mov_b32 s48, 6144
    buffer_load_dwordx2 v[16:17], v12, s[40:43], s48 offen sc1
    buffer_load_dwordx2 v[24:25], v12, s[40:43], s48 offen offset:2048 sc1
    s_mov_b32 s48, 18432
    buffer_load_dwordx2 v[18:19], v12, s[40:43], s48 offen sc1
    buffer_load_dwordx2 v[26:27], v12, s[40:43], s48 offen offset:2048 sc1
    s_mov_b32 s48, 30720
    buffer_load_dwordx2 v[20:21], v12, s[40:43], s48 offen sc1
    buffer_load_dwordx2 v[28:29], v12, s[40:43], s48 offen offset:2048 sc1
    s_mov_b32 s48, 43008
    buffer_load_dwordx2 v[22:23], v12, s[40:43], s48 offen sc1
    buffer_load_dwordx2 v[30:31], v12, s[40:43], s48 offen offset:2048 sc1
    v_lshl_add_u32 v12, v2, 2, v3
    v_mul_u32_u24 v12, 192, v12
    v_lshl_add_u32 v12, v4, 3, v12
    v_and_b32 v13, 1, v2
    s_and_b32 s48, s3, 1
    s_mul_i32 s48, s48, 3
    s_lshr_b32 s49, s3, 1
    s_mul_i32 s49, s49, 6144
    s_add_u32 s51, s48, 0
    v_xor_b32 v14, s51, v13
    v_lshl_add_u32 v32, v14, 5, v12
    v_add_u32 v32, s49, v32
    v_add_u32 v33, 0x10000, v32
    v_add_u32 v34, 0x20000, v32
    s_add_u32 s51, s48, 1
    v_xor_b32 v14, s51, v13
    v_lshl_add_u32 v35, v14, 5, v12
    v_add_u32 v35, s49, v35
    v_add_u32 v36, 0x10000, v35
    v_add_u32 v37, 0x20000, v35
    s_add_u32 s51, s48, 2
    v_xor_b32 v14, s51, v13
    v_lshl_add_u32 v38, v14, 5, v12
    v_add_u32 v38, s49, v38
    v_add_u32 v39, 0x10000, v38
    v_add_u32 v40, 0x20000, v38
    s_waitcnt vmcnt(0)
    v_pk_add_f32 v[16:17], v[16:17], v[18:19]
    v_pk_add_f32 v[20:21], v[20:21], v[22:23]
    v_pk_add_f32 v[24:25], v[24:25], v[26:27]
    v_pk_add_f32 v[28:29], v[28:29], v[30:31]
    v_pk_add_f32 v[16:17], v[16:17], v[20:21]
    v_pk_add_f32 v[24:25], v[24:25], v[28:29]
    v_cvt_pk_bf16_f32 v18, v16, v17
    v_cvt_pk_bf16_f32 v19, v24, v25
    v_lshlrev_b32 v20, 16, v19
    v_and_b32 v21, 0xffff0000, v19
    v_add_f32 v20, 1.0, v20
    v_add_f32 v21, 1.0, v21
    v_cvt_pk_bf16_f32 v19, v20, v21
    v_lshlrev_b32 v12, 2, v0
    v_add_u32 v12, 161792, v12
    ds_write_b32 v12, v19
    ds_write_b32 v12, v18 offset:1024
    v_and_b32 v12, 1, v5
    v_lshlrev_b32 v12, 10, v12
    v_lshl_add_u32 v12, v2, 3, v12
    v_add_u32 v12, 161792, v12
    s_waitcnt lgkmcnt(0)
    s_barrier
    ds_read_b64 v[64:65], v12 offset:0
    ds_read_b64 v[66:67], v12 offset:32
    ds_read_b64 v[68:69], v12 offset:64
    ds_read_b64 v[70:71], v12 offset:96
    ds_read_b64 v[72:73], v12 offset:128
    ds_read_b64 v[74:75], v12 offset:160
    ds_read_b64 v[76:77], v12 offset:192
    ds_read_b64 v[78:79], v12 offset:224
    ds_read_b64 v[80:81], v12 offset:256
PG112:
    s_cbranch_execz PW_S2
    ds_read_b64 v[82:83], v12 offset:288
    ds_read_b64 v[84:85], v12 offset:320
    ds_read_b64 v[86:87], v12 offset:352
    ds_read_b64 v[88:89], v12 offset:384
    ds_read_b64 v[90:91], v12 offset:416
    ds_read_b64 v[92:93], v12 offset:448
    ds_read_b64 v[94:95], v12 offset:480
    ds_read_b64 v[96:97], v12 offset:512
    ds_read_b64 v[98:99], v12 offset:544
    ds_read_b64 v[100:101], v12 offset:576
    ds_read_b64 v[102:103], v12 offset:608
    ds_read_b64 v[104:105], v12 offset:640
    ds_read_b64 v[106:107], v12 offset:672
    ds_read_b64 v[108:109], v12 offset:704
    ds_read_b64 v[110:111], v12 offset:736
    ds_read_b64 v[112:113], v12 offset:768
    ds_read_b64 v[114:115], v12 offset:800
    ds_read_b64 v[116:117], v12 offset:832
    ds_read_b64 v[118:119], v12 offset:864
    ds_read_b64 v[120:121], v12 offset:896
    ds_read_b64 v[122:123], v12 offset:928
    ds_read_b64 v[124:125], v12 offset:960
    ds_read_b64 v[126:127], v12 offset:992
    ds_read_b64_tr_b16 a[0:1], v33 offset:8192
    ds_read_b64_tr_b16 a[2:3], v33 offset:11264
    ds_read_b64_tr_b16 a[4:5], v36 offset:8192
    ds_read_b64_tr_b16 a[6:7], v36 offset:11264
    ds_read_b64_tr_b16 a[8:9], v39 offset:8192
    ds_read_b64_tr_b16 a[10:11], v39 offset:11264
    ds_read_b64_tr_b16 a[12:13], v33 offset:20480
    ds_read_b64_tr_b16 a[14:15], v33 offset:23552
    ds_read_b64_tr_b16 a[16:17], v36 offset:20480
    ds_read_b64_tr_b16 a[18:19], v36 offset:23552
    ds_read_b64_tr_b16 a[20:21], v39 offset:20480
    ds_read_b64_tr_b16 a[22:23], v39 offset:23552
    ds_read_b64_tr_b16 a[24:25], v33 offset:32768
    ds_read_b64_tr_b16 a[26:27], v33 offset:35840
    ds_read_b64_tr_b16 a[28:29], v36 offset:32768
    ds_read_b64_tr_b16 a[30:31], v36 offset:35840
    ds_read_b64_tr_b16 a[32:33], v39 offset:32768
    ds_read_b64_tr_b16 a[34:35], v39 offset:35840
    s_waitcnt lgkmcnt(0)
    s_barrier
    s_add_u32 m0, s35, 73728
    s_add_u32 s50, s34, 1144832
    buffer_load_dwordx4 v60, s[28:31], s50 offen lds
    s_add_u32 m0, s35, 74752
    s_add_u32 s50, s34, 1144832
    buffer_load_dwordx4 v61, s[28:31], s50 offen lds
    s_add_u32 m0, s35, 75776
    s_add_u32 s50, s34, 1144832
    buffer_load_dwordx4 v62, s[28:31], s50 offen lds
    s_add_u32 m0, s35, 86016
    s_add_u32 s50, s34, 1232896
    buffer_load_dwordx4 v60, s[28:31], s50 offen lds
    s_add_u32 m0, s35, 87040
    s_add_u32 s50, s34, 1232896
    buffer_load_dwordx4 v61, s[28:31], s50 offen lds
    s_add_u32 m0, s35, 88064
    s_add_u32 s50, s34, 1232896
    buffer_load_dwordx4 v62, s[28:31], s50 offen lds
    s_add_u32 m0, s35, 98304
    s_add_u32 s50, s34, 1320960
    buffer_load_dwordx4 v60, s[28:31], s50 offen lds
    s_add_u32 m0, s35, 99328
    s_add_u32 s50, s34, 1320960
    buffer_load_dwordx4 v61, s[28:31], s50 offen lds
    s_add_u32 m0, s35, 100352
    s_add_u32 s50, s34, 1320960
    buffer_load_dwordx4 v62, s[28:31], s50 offen lds
    ds_read_b64_tr_b16 a[36:37], v33 offset:45056
    ds_read_b64_tr_b16 a[38:39], v33 offset:48128
    ds_read_b64_tr_b16 a[40:41], v36 offset:45056
    ds_read_b64_tr_b16 a[42:43], v36 offset:48128
    ds_read_b64_tr_b16 a[44:45], v39 offset:45056
    ds_read_b64_tr_b16 a[46:47], v39 offset:48128
    ds_read_b64_tr_b16 a[48:49], v33 offset:57344
    ds_read_b64_tr_b16 a[50:51], v33 offset:60416
    ds_read_b64_tr_b16 a[52:53], v36 offset:57344
    ds_read_b64_tr_b16 a[54:55], v36 offset:60416
    ds_read_b64_tr_b16 a[56:57], v39 offset:57344
    ds_read_b64_tr_b16 a[58:59], v39 offset:60416
    ds_read_b64_tr_b16 a[60:61], v34 offset:4096
    ds_read_b64_tr_b16 a[62:63], v34 offset:7168
    ds_read_b64_tr_b16 a[64:65], v37 offset:4096
    ds_read_b64_tr_b16 a[66:67], v37 offset:7168
    ds_read_b64_tr_b16 a[68:69], v40 offset:4096
    ds_read_b64_tr_b16 a[70:71], v40 offset:7168
    ds_read_b64_tr_b16 a[72:73], v34 offset:16384
    ds_read_b64_tr_b16 a[74:75], v34 offset:19456
    ds_read_b64_tr_b16 a[76:77], v37 offset:16384
    ds_read_b64_tr_b16 a[78:79], v37 offset:19456
    ds_read_b64_tr_b16 a[80:81], v40 offset:16384
    ds_read_b64_tr_b16 a[82:83], v40 offset:19456
    ds_read_b64_tr_b16 a[84:85], v32 offset:0
    ds_read_b64_tr_b16 a[86:87], v32 offset:3072
    ds_read_b64_tr_b16 a[88:89], v35 offset:0
    ds_read_b64_tr_b16 a[90:91], v35 offset:3072
    ds_read_b64_tr_b16 a[92:93], v38 offset:0
    ds_read_b64_tr_b16 a[94:95], v38 offset:3072
    ds_read_b64_tr_b16 a[96:97], v32 offset:12288
    ds_read_b64_tr_b16 a[98:99], v32 offset:15360
    ds_read_b64_tr_b16 a[100:101], v35 offset:12288
    ds_read_b64_tr_b16 a[102:103], v35 offset:15360
    ds_read_b64_tr_b16 a[104:105], v38 offset:12288
    ds_read_b64_tr_b16 a[106:107], v38 offset:15360
    ds_read_b64_tr_b16 a[108:109], v32 offset:24576
    ds_read_b64_tr_b16 a[110:111], v32 offset:27648
    ds_read_b64_tr_b16 a[112:113], v35 offset:24576
    ds_read_b64_tr_b16 a[114:115], v35 offset:27648
    ds_read_b64_tr_b16 a[116:117], v38 offset:24576
    ds_read_b64_tr_b16 a[118:119], v38 offset:27648
    ds_read_b64_tr_b16 a[120:121], v32 offset:36864
    ds_read_b64_tr_b16 a[122:123], v32 offset:39936
    ds_read_b64_tr_b16 a[124:125], v35 offset:36864
    ds_read_b64_tr_b16 a[126:127], v35 offset:39936
    ds_read_b64_tr_b16 a[128:129], v38 offset:36864
    ds_read_b64_tr_b16 a[130:131], v38 offset:39936
    ds_read_b64_tr_b16 a[132:133], v32 offset:49152
    ds_read_b64_tr_b16 a[134:135], v32 offset:52224
    ds_read_b64_tr_b16 a[136:137], v35 offset:49152
    ds_read_b64_tr_b16 a[138:139], v35 offset:52224
    ds_read_b64_tr_b16 a[140:141], v38 offset:49152
    ds_read_b64_tr_b16 a[142:143], v38 offset:52224
    ds_read_b64_tr_b16 a[144:145], v32 offset:61440
    ds_read_b64_tr_b16 a[146:147], v32 offset:64512
    ds_read_b64_tr_b16 a[148:149], v35 offset:61440
    ds_read_b64_tr_b16 a[150:151], v35 offset:64512
    ds_read_b64_tr_b16 a[152:153], v38 offset:61440
    ds_read_b64_tr_b16 a[154:155], v38 offset:64512
    s_waitcnt lgkmcnt(0)
    v_mfma_f32_16x16x32_bf16 v[48:51], a[0:3], v[64:67], 0
    v_mfma_f32_16x16x32_bf16 v[52:55], a[4:7], v[64:67], 0
    v_mfma_f32_16x16x32_bf16 v[56:59], a[8:11], v[64:67], 0
    v_mfma_f32_16x16x32_bf16 v[48:51], a[12:15], v[68:71], v[48:51]
    v_mfma_f32_16x16x32_bf16 v[52:55], a[16:19], v[68:71], v[52:55]
    v_mfma_f32_16x16x32_bf16 v[56:59], a[20:23], v[68:71], v[56:59]
    v_mfma_f32_16x16x32_bf16 v[48:51], a[24:27], v[72:75], v[48:51]
    v_mfma_f32_16x16x32_bf16 v[52:55], a[28:31], v[72:75], v[52:55]
    v_mfma_f32_16x16x32_bf16 v[56:59], a[32:35], v[72:75], v[56:59]
    v_mfma_f32_16x16x32_bf16 v[48:51], a[36:39], v[76:79], v[48:51]
    v_mfma_f32_16x16x32_bf16 v[52:55], a[40:43], v[76:79], v[52:55]
    v_mfma_f32_16x16x32_bf16 v[56:59], a[44:47], v[76:79], v[56:59]
    v_mfma_f32_16x16x32_bf16 v[48:51], a[48:51], v[80:83], v[48:51]
    v_mfma_f32_16x16x32_bf16 v[52:55], a[52:55], v[80:83], v[52:55]
    v_mfma_f32_16x16x32_bf16 v[56:59], a[56:59], v[80:83], v[56:59]
    v_mfma_f32_16x16x32_bf16 v[48:51], a[60:63], v[84:87], v[48:51]
    v_mfma_f32_16x16x32_bf16 v[52:55], a[64:67], v[84:87], v[52:55]
    v_mfma_f32_16x16x32_bf16 v[56:59], a[68:71], v[84:87], v[56:59]
    v_mfma_f32_16x16x32_bf16 v[48:51], a[72:75], v[88:91], v[48:51]
    v_mfma_f32_16x16x32_bf16 v[52:55], a[76:79], v[88:91], v[52:55]
    v_mfma_f32_16x16x32_bf16 v[56:59], a[80:83], v[88:91], v[56:59]
    v_mfma_f32_16x16x32_bf16 v[48:51], a[84:87], v[92:95], v[48:51]
    v_mfma_f32_16x16x32_bf16 v[52:55], a[88:91], v[92:95], v[52:55]
    v_mfma_f32_16x16x32_bf16 v[56:59], a[92:95], v[92:95], v[56:59]
    v_mfma_f32_16x16x32_bf16 v[48:51], a[96:99], v[96:99], v[48:51]
    v_mfma_f32_16x16x32_bf16 v[52:55], a[100:103], v[96:99], v[52:55]
    v_mfma_f32_16x16x32_bf16 v[56:59], a[104:107], v[96:99], v[56:59]
    v_mfma_f32_16x16x32_bf16 v[48:51], a[108:111], v[100:103], v[48:51]
    v_mfma_f32_16x16x32_bf16 v[52:55], a[112:115], v[100:103], v[52:55]
    v_mfma_f32_16x16x32_bf16 v[56:59], a[116:119], v[100:103], v[56:59]
    v_mfma_f32_16x16x32_bf16 v[48:51], a[120:123], v[104:107], v[48:51]
    v_mfma_f32_16x16x32_bf16 v[52:55], a[124:127], v[104:107], v[52:55]
    v_mfma_f32_16x16x32_bf16 v[56:59], a[128:131], v[104:107], v[56:59]
    v_mfma_f32_16x16x32_bf16 v[48:51], a[132:135], v[108:111], v[48:51]
    v_mfma_f32_16x16x32_bf16 v[52:55], a[136:139], v[108:111], v[52:55]
    v_mfma_f32_16x16x32_bf16 v[56:59], a[140:143], v[108:111], v[56:59]
    v_mfma_f32_16x16x32_bf16 v[48:51], a[144:147], v[112:115], v[48:51]
    v_mfma_f32_16x16x32_bf16 v[52:55], a[148:151], v[112:115], v[52:55]
    v_mfma_f32_16x16x32_bf16 v[56:59], a[152:155], v[112:115], v[56:59]
    s_waitcnt vmcnt(0)
    s_barrier
    ds_read_b64_tr_b16 a[156:157], v33 offset:8192
    ds_read_b64_tr_b16 a[158:159], v33 offset:11264
    ds_read_b64_tr_b16 a[160:161], v36 offset:8192
    ds_read_b64_tr_b16 a[162:163], v36 offset:11264
    ds_read_b64_tr_b16 a[164:165], v39 offset:8192
    ds_read_b64_tr_b16 a[166:167], v39 offset:11264
    ds_read_b64_tr_b16 a[168:169], v33 offset:20480
    ds_read_b64_tr_b16 a[170:171], v33 offset:23552
    ds_read_b64_tr_b16 a[172:173], v36 offset:20480
    ds_read_b64_tr_b16 a[174:175], v36 offset:23552
    ds_read_b64_tr_b16 a[176:177], v39 offset:20480
    ds_read_b64_tr_b16 a[178:179], v39 offset:23552
    ds_read_b64_tr_b16 a[180:181], v33 offset:32768
    ds_read_b64_tr_b16 a[182:183], v33 offset:35840
    ds_read_b64_tr_b16 a[184:185], v36 offset:32768
    ds_read_b64_tr_b16 a[186:187], v36 offset:35840
    ds_read_b64_tr_b16 a[188:189], v39 offset:32768
    ds_read_b64_tr_b16 a[190:191], v39 offset:35840
    s_waitcnt lgkmcnt(0)
    v_mfma_f32_16x16x32_bf16 v[48:51], a[156:159], v[116:119], v[48:51]
    v_mfma_f32_16x16x32_bf16 v[52:55], a[160:163], v[116:119], v[52:55]
    v_mfma_f32_16x16x32_bf16 v[56:59], a[164:167], v[116:119], v[56:59]
    v_mfma_f32_16x16x32_bf16 v[48:51], a[168:171], v[120:123], v[48:51]
    v_mfma_f32_16x16x32_bf16 v[52:55], a[172:175], v[120:123], v[52:55]
    v_mfma_f32_16x16x32_bf16 v[56:59], a[176:179], v[120:123], v[56:59]
    v_mfma_f32_16x16x32_bf16 v[48:51], a[180:183], v[124:127], v[48:51]
    v_mfma_f32_16x16x32_bf16 v[52:55], a[184:187], v[124:127], v[52:55]
    v_mfma_f32_16x16x32_bf16 v[56:59], a[188:191], v[124:127], v[56:59]
    v_lshlrev_b32 v12, 6, v5
    v_lshl_add_u32 v12, v2, 4, v12
    s_mul_i32 s48, s32, 1536
    s_mul_i32 s49, s3, 384
    s_add_u32 s48, s48, s49
    s_add_u32 s48, s48, 327680
    s_mov_b32 s50, 0x00030003
    s_mov_b32 s51, 0x00030003
    s_nop 3
    s_mov_b64 exec, s[50:51]
    buffer_store_dwordx4 v[48:51], v12, s[40:43], s48 offen offset:0 sc1
    buffer_store_dwordx4 v[52:55], v12, s[40:43], s48 offen offset:128 sc1
    buffer_store_dwordx4 v[56:59], v12, s[40:43], s48 offen offset:256 sc1
    s_mov_b64 exec, -1
    s_waitcnt vmcnt(0)
    s_barrier
    s_cmp_lg_u32 s3, 0
    s_cbranch_scc1 P3X_E
    v_mov_b32 v13, 1
    v_mov_b32 v12, 0
    s_lshl_b32 s48, s32, 7
    s_add_u32 s48, s48, 438272
    s_mov_b64 exec, 1
    buffer_store_dword v13, v12, s[40:43], s48 offen sc1
    s_mov_b64 exec, -1
P3X_E:
P3X_S:
    s_waitcnt vmcnt(0)
    s_barrier
    s_add_u32 m0, s45, 110592
    s_add_u32 s50, s44, 0
    buffer_load_dwordx4 v63, s[24:27], s50 offen lds
    s_add_u32 m0, s45, 114688
    s_add_u32 s50, s44, 32768
    buffer_load_dwordx4 v63, s[24:27], s50 offen lds
    s_add_u32 m0, s45, 118784
    s_add_u32 s50, s44, 65536
    buffer_load_dwordx4 v63, s[24:27], s50 offen lds
    s_add_u32 m0, s45, 122880
    s_add_u32 s50, s44, 98304
    buffer_load_dwordx4 v63, s[24:27], s50 offen lds
    s_add_u32 m0, s45, 126976
    s_add_u32 s50, s44, 131072
    buffer_load_dwordx4 v63, s[24:27], s50 offen lds
    s_add_u32 m0, s45, 131072
    s_add_u32 s50, s44, 163840
    buffer_load_dwordx4 v63, s[24:27], s50 offen lds
    s_add_u32 m0, s45, 135168
    s_add_u32 s50, s44, 196608
    buffer_load_dwordx4 v63, s[24:27], s50 offen lds
    s_add_u32 m0, s45, 139264
    s_add_u32 s50, s44, 229376
    buffer_load_dwordx4 v63, s[24:27], s50 offen lds
    s_add_u32 m0, s45, 143360
    s_add_u32 s50, s44, 262144
    buffer_load_dwordx4 v63, s[24:27], s50 offen lds
    s_add_u32 m0, s45, 147456
    s_add_u32 s50, s44, 294912
    buffer_load_dwordx4 v63, s[24:27], s50 offen lds
    s_add_u32 m0, s45, 151552
    s_add_u32 s50, s44, 327680
    buffer_load_dwordx4 v63, s[24:27], s50 offen lds
    s_add_u32 m0, s45, 155648
    s_add_u32 s50, s44, 360448
    buffer_load_dwordx4 v63, s[24:27], s50 offen lds
    s_add_u32 m0, s45, 0
    s_add_u32 s50, s44, 393216
    buffer_load_dwordx4 v63, s[24:27], s50 offen lds
    s_add_u32 m0, s45, 4096
    s_add_u32 s50, s44, 425984
    buffer_load_dwordx4 v63, s[24:27], s50 offen lds
    s_add_u32 m0, s45, 8192
    s_add_u32 s50, s44, 458752
    buffer_load_dwordx4 v63, s[24:27], s50 offen lds
    s_add_u32 m0, s45, 12288
    s_add_u32 s50, s44, 491520
    buffer_load_dwordx4 v63, s[24:27], s50 offen lds
    s_add_u32 m0, s45, 16384
    s_add_u32 s50, s44, 524288
    buffer_load_dwordx4 v63, s[24:27], s50 offen lds
    s_add_u32 m0, s45, 20480
    s_add_u32 s50, s44, 557056
    buffer_load_dwordx4 v63, s[24:27], s50 offen lds
    s_add_u32 m0, s45, 24576
    s_add_u32 s50, s44, 589824
    buffer_load_dwordx4 v63, s[24:27], s50 offen lds
    s_add_u32 m0, s45, 28672
    s_add_u32 s50, s44, 622592
    buffer_load_dwordx4 v63, s[24:27], s50 offen lds
    s_add_u32 m0, s45, 32768
    s_add_u32 s50, s44, 655360
    buffer_load_dwordx4 v63, s[24:27], s50 offen lds
    s_add_u32 m0, s45, 36864
    s_add_u32 s50, s44, 688128
    buffer_load_dwordx4 v63, s[24:27], s50 offen lds
    s_add_u32 m0, s45, 40960
    s_add_u32 s50, s44, 720896
    buffer_load_dwordx4 v63, s[24:27], s50 offen lds
    s_add_u32 m0, s45, 45056
    s_add_u32 s50, s44, 753664
    buffer_load_dwordx4 v63, s[24:27], s50 offen lds
    s_add_u32 m0, s45, 49152
    s_add_u32 s50, s44, 786432
    buffer_load_dwordx4 v63, s[24:27], s50 offen lds
    s_add_u32 m0, s45, 53248
    s_add_u32 s50, s44, 819200
    buffer_load_dwordx4 v63, s[24:27], s50 offen lds
    s_add_u32 m0, s45, 57344
    s_add_u32 s50, s44, 851968
    buffer_load_dwordx4 v63, s[24:27], s50 offen lds
    s_add_u32 m0, s45, 61440
    s_add_u32 s50, s44, 884736
    buffer_load_dwordx4 v63, s[24:27], s50 offen lds
    s_add_u32 m0, s45, 65536
    s_add_u32 s50, s44, 917504
    buffer_load_dwordx4 v63, s[24:27], s50 offen lds
    s_add_u32 m0, s45, 69632
    s_add_u32 s50, s44, 950272
    buffer_load_dwordx4 v63, s[24:27], s50 offen lds
    s_add_u32 m0, s45, 73728
    s_add_u32 s50, s44, 983040
    buffer_load_dwordx4 v63, s[24:27], s50 offen lds
    s_add_u32 m0, s45, 77824
    s_add_u32 s50, s44, 1015808
    buffer_load_dwordx4 v63, s[24:27], s50 offen lds
    s_add_u32 m0, s45, 81920
    s_add_u32 s50, s44, 1048576
    buffer_load_dwordx4 v63, s[24:27], s50 offen lds
    s_add_u32 m0, s45, 86016
    s_add_u32 s50, s44, 1081344
    buffer_load_dwordx4 v63, s[24:27], s50 offen lds
    s_add_u32 m0, s45, 90112
    s_add_u32 s50, s44, 1114112
    buffer_load_dwordx4 v63, s[24:27], s50 offen lds
    s_add_u32 m0, s45, 94208
    s_add_u32 s50, s44, 1146880
    buffer_load_dwordx4 v63, s[24:27], s50 offen lds
    s_add_u32 m0, s45, 98304
    s_add_u32 s50, s44, 1179648
    buffer_load_dwordx4 v63, s[24:27], s50 offen lds
    s_add_u32 m0, s45, 102400
    s_add_u32 s50, s44, 1212416
    buffer_load_dwordx4 v63, s[24:27], s50 offen lds
    s_add_u32 m0, s45, 106496
    s_add_u32 s50, s44, 1245184
    buffer_load_dwordx4 v63, s[24:27], s50 offen lds
    s_cmp_lt_u32 s2, 248
    s_cbranch_scc1 P3_END
    s_cmp_lg_u32 s3, 0
    s_cbranch_scc1 P3_END
    s_waitcnt vmcnt(0)
    s_sleep 16
    buffer_wbl2 sc1
    s_branch P3_END
P3_GO:
    s_lshl_b32 s54, s33, 7
    s_lshl_b32 s55, s3, 5
    s_add_u32 s54, s54, s55
    s_lshl_b32 s55, s54, 10
    s_add_u32 s55, s55, 7340032
    s_add_u32 s56, s55, 16384
    v_lshl_add_u32 v12, v2, 2, v3
    v_mul_u32_u24 v12, 192, v12
    v_lshl_add_u32 v12, v4, 3, v12
    v_and_b32 v13, 1, v2
    v_lshlrev_b32 v13, 5, v13
    v_add_u32 v6, v12, v13
    v_sub_u32 v10, v12, v13
    v_add_u32 v10, 32, v10
    v_add_u32 v7, 65536, v6
    v_add_u32 v11, 65536, v10
    v_add_u32 v9, 131072, v6
    v_add_u32 v14, 131072, v10
    s_mov_b32 s47, 0xffff0000
    v_lshlrev_b32 v15, 3, v5
    v_lshl_add_u32 v15, v2, 9, v15
    v_lshlrev_b32 v48, 4, v2
    v_add_u32 v48, 161792, v48
    s_lshl_b32 s52, s33, 1
    s_lshr_b32 s53, s3, 1
    s_add_u32 s52, s52, s53
    s_lshl_b32 s52, s52, 12
    s_and_b32 s53, s3, 1
    s_lshl_b32 s53, s53, 8
    s_add_u32 s52, s52, s53
    s_add_u32 s52, s52, 196608
    s_mul_i32 s53, s32, 1536
    s_add_u32 s53, s53, 327680
    s_and_b32 s59, s3, 1
    s_lshl_b32 s59, s59, 10
    s_add_u32 s53, s53, s59
    s_add_u32 s59, s59, 161792
    s_lshl_b32 s51, s32, 7
    s_add_u32 s51, s51, 438272
    s_lshl_b32 s48, s33, 8
    s_add_u32 s48, s48, 430080
    s_cmp_lg_u32 s3, 0
    s_cbranch_scc1 G3_W
    s_mov_b64 exec, 65535
    s_mov_b32 s49, 0
G3_P:
    buffer_load_dword v13, v8, s[40:43], s48 offen sc1
    s_add_u32 s49, s49, 1
    s_cmp_gt_u32 s49, 400000
    s_cbranch_scc1 G3_W
    s_waitcnt vmcnt(0)
    v_cmp_ne_u32 vcc, 1, v13
    s_cbranch_vccz G3_W
    s_sleep 3
    s_branch G3_P
G3_W:
    s_mov_b64 exec, -1
    s_waitcnt vmcnt(0)
    s_barrier
    s_add_u32 s57, s55, 0
    buffer_load_dwordx4 a[144:147], v8, s[40:43], s57 offen offset:0
    s_add_u32 s58, s56, 0
    buffer_load_dwordx4 a[148:151], v8, s[40:43], s58 offen offset:0
    buffer_load_dwordx4 a[152:155], v8, s[40:43], s57 offen offset:1024
    buffer_load_dwordx4 a[156:159], v8, s[40:43], s58 offen offset:1024
    buffer_load_dwordx4 a[160:163], v8, s[40:43], s57 offen offset:2048
    buffer_load_dwordx4 a[164:167], v8, s[40:43], s58 offen offset:2048
    buffer_load_dwordx4 a[168:171], v8, s[40:43], s57 offen offset:3072
    buffer_load_dwordx4 a[172:175], v8, s[40:43], s58 offen offset:3072
    ds_read_b64_tr_b16 a[0:1], v7 offset:8192
    ds_read_b64_tr_b16 a[2:3], v7 offset:11264
    ds_read_b64_tr_b16 a[4:5], v11 offset:8192
    ds_read_b64_tr_b16 a[6:7], v11 offset:11264
    ds_read_b64_tr_b16 a[8:9], v7 offset:8256
    ds_read_b64_tr_b16 a[10:11], v7 offset:11328
    ds_read_b64_tr_b16 a[12:13], v11 offset:8256
    ds_read_b64_tr_b16 a[14:15], v11 offset:11328
    ds_read_b64_tr_b16 a[16:17], v7 offset:8320
    ds_read_b64_tr_b16 a[18:19], v7 offset:11392
    ds_read_b64_tr_b16 a[20:21], v11 offset:8320
    ds_read_b64_tr_b16 a[22:23], v11 offset:11392
    ds_read_b64_tr_b16 a[24:25], v7 offset:14336
    ds_read_b64_tr_b16 a[26:27], v7 offset:17408
    ds_read_b64_tr_b16 a[28:29], v11 offset:14336
    ds_read_b64_tr_b16 a[30:31], v11 offset:17408
    ds_read_b64_tr_b16 a[32:33], v7 offset:14400
    ds_read_b64_tr_b16 a[34:35], v7 offset:17472
    ds_read_b64_tr_b16 a[36:37], v11 offset:14400
    ds_read_b64_tr_b16 a[38:39], v11 offset:17472
    ds_read_b64_tr_b16 a[40:41], v7 offset:14464
    ds_read_b64_tr_b16 a[42:43], v7 offset:17536
    ds_read_b64_tr_b16 a[44:45], v11 offset:14464
    ds_read_b64_tr_b16 a[46:47], v11 offset:17536
    ds_read_b64_tr_b16 a[48:49], v7 offset:20480
    ds_read_b64_tr_b16 a[50:51], v7 offset:23552
    ds_read_b64_tr_b16 a[52:53], v11 offset:20480
    ds_read_b64_tr_b16 a[54:55], v11 offset:23552
    ds_read_b64_tr_b16 a[56:57], v7 offset:20544
    ds_read_b64_tr_b16 a[58:59], v7 offset:23616
    ds_read_b64_tr_b16 a[60:61], v11 offset:20544
    ds_read_b64_tr_b16 a[62:63], v11 offset:23616
    ds_read_b64_tr_b16 a[64:65], v7 offset:20608
    ds_read_b64_tr_b16 a[66:67], v7 offset:23680
    ds_read_b64_tr_b16 a[68:69], v11 offset:20608
    ds_read_b64_tr_b16 a[70:71], v11 offset:23680
    ds_read_b64_tr_b16 a[72:73], v7 offset:26624
    ds_read_b64_tr_b16 a[74:75], v7 offset:29696
    ds_read_b64_tr_b16 a[76:77], v11 offset:26624
    ds_read_b64_tr_b16 a[78:79], v11 offset:29696
    ds_read_b64_tr_b16 a[80:81], v7 offset:26688
    ds_read_b64_tr_b16 a[82:83], v7 offset:29760
    ds_read_b64_tr_b16 a[84:85], v11 offset:26688
    ds_read_b64_tr_b16 a[86:87], v11 offset:29760
    ds_read_b64_tr_b16 a[88:89], v7 offset:26752
    ds_read_b64_tr_b16 a[90:91], v7 offset:29824
    ds_read_b64_tr_b16 a[92:93], v11 offset:26752
    ds_read_b64_tr_b16 a[94:95], v11 offset:29824
    s_waitcnt vmcnt(6)
    s_waitcnt lgkmcnt(15)
    v_mfma_f32_16x16x32_bf16 v[64:67], a[0:3], a[144:147], 0
    ds_read_b64_tr_b16 a[96:97], v7 offset:32768
    ds_read_b64_tr_b16 a[98:99], v7 offset:35840
    v_mfma_f32_16x16x32_bf16 v[72:75], a[4:7], a[144:147], 0
    ds_read_b64_tr_b16 a[100:101], v11 offset:32768
    v_mfma_f32_16x16x32_bf16 v[80:83], a[8:11], a[144:147], 0
    ds_read_b64_tr_b16 a[102:103], v11 offset:35840
    v_mfma_f32_16x16x32_bf16 v[88:91], a[12:15], a[144:147], 0
    s_add_u32 s57, s55, 4096
    v_mfma_f32_16x16x32_bf16 v[96:99], a[16:19], a[144:147], 0
    ds_read_b64_tr_b16 a[104:105], v7 offset:32832
    ds_read_b64_tr_b16 a[106:107], v7 offset:35904
    v_mfma_f32_16x16x32_bf16 v[104:107], a[20:23], a[144:147], 0
    ds_read_b64_tr_b16 a[108:109], v11 offset:32832
    v_mfma_f32_16x16x32_bf16 v[112:115], a[24:27], a[144:147], 0
    ds_read_b64_tr_b16 a[110:111], v11 offset:35904
    v_mfma_f32_16x16x32_bf16 v[120:123], a[28:31], a[144:147], 0
    buffer_load_dwordx4 a[176:179], v8, s[40:43], s57 offen offset:0
    v_mfma_f32_16x16x32_bf16 v[128:131], a[32:35], a[144:147], 0
    ds_read_b64_tr_b16 a[112:113], v7 offset:32896
    ds_read_b64_tr_b16 a[114:115], v7 offset:35968
    v_mfma_f32_16x16x32_bf16 v[136:139], a[36:39], a[144:147], 0
    ds_read_b64_tr_b16 a[116:117], v11 offset:32896
    v_mfma_f32_16x16x32_bf16 v[144:147], a[40:43], a[144:147], 0
    ds_read_b64_tr_b16 a[118:119], v11 offset:35968
    v_mfma_f32_16x16x32_bf16 v[152:155], a[44:47], a[144:147], 0
    s_add_u32 s58, s56, 4096
    v_mfma_f32_16x16x32_bf16 v[68:71], a[0:3], a[148:151], 0
    ds_read_b64_tr_b16 a[120:121], v7 offset:38912
    ds_read_b64_tr_b16 a[122:123], v7 offset:41984
    v_mfma_f32_16x16x32_bf16 v[76:79], a[4:7], a[148:151], 0
    ds_read_b64_tr_b16 a[124:125], v11 offset:38912
    v_mfma_f32_16x16x32_bf16 v[84:87], a[8:11], a[148:151], 0
    ds_read_b64_tr_b16 a[126:127], v11 offset:41984
    v_mfma_f32_16x16x32_bf16 v[92:95], a[12:15], a[148:151], 0
    buffer_load_dwordx4 a[180:183], v8, s[40:43], s58 offen offset:0
    v_mfma_f32_16x16x32_bf16 v[100:103], a[16:19], a[148:151], 0
    ds_read_b64_tr_b16 a[128:129], v7 offset:38976
    ds_read_b64_tr_b16 a[130:131], v7 offset:42048
    v_mfma_f32_16x16x32_bf16 v[108:111], a[20:23], a[148:151], 0
    ds_read_b64_tr_b16 a[132:133], v11 offset:38976
    v_mfma_f32_16x16x32_bf16 v[116:119], a[24:27], a[148:151], 0
    ds_read_b64_tr_b16 a[134:135], v11 offset:42048
    v_mfma_f32_16x16x32_bf16 v[124:127], a[28:31], a[148:151], 0
    buffer_load_dwordx4 a[184:187], v8, s[40:43], s57 offen offset:1024
    v_mfma_f32_16x16x32_bf16 v[132:135], a[32:35], a[148:151], 0
    ds_read_b64_tr_b16 a[136:137], v7 offset:39040
    ds_read_b64_tr_b16 a[138:139], v7 offset:42112
    v_mfma_f32_16x16x32_bf16 v[140:143], a[36:39], a[148:151], 0
    ds_read_b64_tr_b16 a[140:141], v11 offset:39040
    v_mfma_f32_16x16x32_bf16 v[148:151], a[40:43], a[148:151], 0
    ds_read_b64_tr_b16 a[142:143], v11 offset:42112
    v_mfma_f32_16x16x32_bf16 v[156:159], a[44:47], a[148:151], 0
    buffer_load_dwordx4 a[188:191], v8, s[40:43], s58 offen offset:1024
    s_waitcnt vmcnt(8)
    s_waitcnt lgkmcnt(15)
    v_mfma_f32_16x16x32_bf16 v[64:67], a[48:51], a[152:155], v[64:67]
    ds_read_b64_tr_b16 a[0:1], v7 offset:45056
    ds_read_b64_tr_b16 a[2:3], v7 offset:48128
    v_mfma_f32_16x16x32_bf16 v[72:75], a[52:55], a[152:155], v[72:75]
    ds_read_b64_tr_b16 a[4:5], v11 offset:45056
    v_mfma_f32_16x16x32_bf16 v[80:83], a[56:59], a[152:155], v[80:83]
    ds_read_b64_tr_b16 a[6:7], v11 offset:48128
    v_mfma_f32_16x16x32_bf16 v[88:91], a[60:63], a[152:155], v[88:91]
    ds_read_b64_tr_b16 a[8:9], v7 offset:45120
    v_mfma_f32_16x16x32_bf16 v[96:99], a[64:67], a[152:155], v[96:99]
    ds_read_b64_tr_b16 a[10:11], v7 offset:48192
    v_mfma_f32_16x16x32_bf16 v[104:107], a[68:71], a[152:155], v[104:107]
    buffer_load_dwordx4 a[192:195], v8, s[40:43], s57 offen offset:2048
    v_mfma_f32_16x16x32_bf16 v[112:115], a[72:75], a[152:155], v[112:115]
    ds_read_b64_tr_b16 a[12:13], v11 offset:45120
    ds_read_b64_tr_b16 a[14:15], v11 offset:48192
    v_mfma_f32_16x16x32_bf16 v[120:123], a[76:79], a[152:155], v[120:123]
    ds_read_b64_tr_b16 a[16:17], v7 offset:45184
    v_mfma_f32_16x16x32_bf16 v[128:131], a[80:83], a[152:155], v[128:131]
    ds_read_b64_tr_b16 a[18:19], v7 offset:48256
    v_mfma_f32_16x16x32_bf16 v[136:139], a[84:87], a[152:155], v[136:139]
    ds_read_b64_tr_b16 a[20:21], v11 offset:45184
    v_mfma_f32_16x16x32_bf16 v[144:147], a[88:91], a[152:155], v[144:147]
PG128:
    s_cbranch_execz PW_S3
    ds_read_b64_tr_b16 a[22:23], v11 offset:48256
    v_mfma_f32_16x16x32_bf16 v[152:155], a[92:95], a[152:155], v[152:155]
    buffer_load_dwordx4 a[196:199], v8, s[40:43], s58 offen offset:2048
    v_mfma_f32_16x16x32_bf16 v[68:71], a[48:51], a[156:159], v[68:71]
    ds_read_b64_tr_b16 a[24:25], v7 offset:51200
    ds_read_b64_tr_b16 a[26:27], v7 offset:54272
    v_mfma_f32_16x16x32_bf16 v[76:79], a[52:55], a[156:159], v[76:79]
    ds_read_b64_tr_b16 a[28:29], v11 offset:51200
    v_mfma_f32_16x16x32_bf16 v[84:87], a[56:59], a[156:159], v[84:87]
    ds_read_b64_tr_b16 a[30:31], v11 offset:54272
    v_mfma_f32_16x16x32_bf16 v[92:95], a[60:63], a[156:159], v[92:95]
    ds_read_b64_tr_b16 a[32:33], v7 offset:51264
    v_mfma_f32_16x16x32_bf16 v[100:103], a[64:67], a[156:159], v[100:103]
    ds_read_b64_tr_b16 a[34:35], v7 offset:54336
    v_mfma_f32_16x16x32_bf16 v[108:111], a[68:71], a[156:159], v[108:111]
    buffer_load_dwordx4 a[200:203], v8, s[40:43], s57 offen offset:3072
    v_mfma_f32_16x16x32_bf16 v[116:119], a[72:75], a[156:159], v[116:119]
    ds_read_b64_tr_b16 a[36:37], v11 offset:51264
    ds_read_b64_tr_b16 a[38:39], v11 offset:54336
    v_mfma_f32_16x16x32_bf16 v[124:127], a[76:79], a[156:159], v[124:127]
    ds_read_b64_tr_b16 a[40:41], v7 offset:51328
    v_mfma_f32_16x16x32_bf16 v[132:135], a[80:83], a[156:159], v[132:135]
    ds_read_b64_tr_b16 a[42:43], v7 offset:54400
    v_mfma_f32_16x16x32_bf16 v[140:143], a[84:87], a[156:159], v[140:143]
    ds_read_b64_tr_b16 a[44:45], v11 offset:51328
    v_mfma_f32_16x16x32_bf16 v[148:151], a[88:91], a[156:159], v[148:151]
    ds_read_b64_tr_b16 a[46:47], v11 offset:54400
    v_mfma_f32_16x16x32_bf16 v[156:159], a[92:95], a[156:159], v[156:159]
    buffer_load_dwordx4 a[204:207], v8, s[40:43], s58 offen offset:3072
    s_waitcnt vmcnt(10)
    s_waitcnt lgkmcnt(15)
    v_mfma_f32_16x16x32_bf16 v[64:67], a[96:99], a[160:163], v[64:67]
    ds_read_b64_tr_b16 a[48:49], v7 offset:57344
    ds_read_b64_tr_b16 a[50:51], v7 offset:60416
    v_mfma_f32_16x16x32_bf16 v[72:75], a[100:103], a[160:163], v[72:75]
    ds_read_b64_tr_b16 a[52:53], v11 offset:57344
    v_mfma_f32_16x16x32_bf16 v[80:83], a[104:107], a[160:163], v[80:83]
    ds_read_b64_tr_b16 a[54:55], v11 offset:60416
    v_mfma_f32_16x16x32_bf16 v[88:91], a[108:111], a[160:163], v[88:91]
    s_add_u32 s57, s55, 8192
    v_mfma_f32_16x16x32_bf16 v[96:99], a[112:115], a[160:163], v[96:99]
    ds_read_b64_tr_b16 a[56:57], v7 offset:57408
    ds_read_b64_tr_b16 a[58:59], v7 offset:60480
    v_mfma_f32_16x16x32_bf16 v[104:107], a[116:119], a[160:163], v[104:107]
    ds_read_b64_tr_b16 a[60:61], v11 offset:57408
    v_mfma_f32_16x16x32_bf16 v[112:115], a[120:123], a[160:163], v[112:115]
    ds_read_b64_tr_b16 a[62:63], v11 offset:60480
    v_mfma_f32_16x16x32_bf16 v[120:123], a[124:127], a[160:163], v[120:123]
    buffer_load_dwordx4 a[208:211], v8, s[40:43], s57 offen offset:0
    v_mfma_f32_16x16x32_bf16 v[128:131], a[128:131], a[160:163], v[128:131]
    ds_read_b64_tr_b16 a[64:65], v7 offset:57472
    ds_read_b64_tr_b16 a[66:67], v7 offset:60544
    v_mfma_f32_16x16x32_bf16 v[136:139], a[132:135], a[160:163], v[136:139]
    ds_read_b64_tr_b16 a[68:69], v11 offset:57472
    v_mfma_f32_16x16x32_bf16 v[144:147], a[136:139], a[160:163], v[144:147]
    ds_read_b64_tr_b16 a[70:71], v11 offset:60544
    v_mfma_f32_16x16x32_bf16 v[152:155], a[140:143], a[160:163], v[152:155]
    s_add_u32 s58, s56, 8192
    v_mfma_f32_16x16x32_bf16 v[68:71], a[96:99], a[164:167], v[68:71]
    ds_read_b64_tr_b16 a[72:73], v7 offset:63488
    ds_read_b64_tr_b16 a[74:75], v9 offset:1024
    v_mfma_f32_16x16x32_bf16 v[76:79], a[100:103], a[164:167], v[76:79]
    ds_read_b64_tr_b16 a[76:77], v11 offset:63488
    v_mfma_f32_16x16x32_bf16 v[84:87], a[104:107], a[164:167], v[84:87]
    ds_read_b64_tr_b16 a[78:79], v14 offset:1024
    v_mfma_f32_16x16x32_bf16 v[92:95], a[108:111], a[164:167], v[92:95]
    buffer_load_dwordx4 a[212:215], v8, s[40:43], s58 offen offset:0
    v_mfma_f32_16x16x32_bf16 v[100:103], a[112:115], a[164:167], v[100:103]
    ds_read_b64_tr_b16 a[80:81], v7 offset:63552
    ds_read_b64_tr_b16 a[82:83], v9 offset:1088
    v_mfma_f32_16x16x32_bf16 v[108:111], a[116:119], a[164:167], v[108:111]
    ds_read_b64_tr_b16 a[84:85], v11 offset:63552
    v_mfma_f32_16x16x32_bf16 v[116:119], a[120:123], a[164:167], v[116:119]
    ds_read_b64_tr_b16 a[86:87], v14 offset:1088
    v_mfma_f32_16x16x32_bf16 v[124:127], a[124:127], a[164:167], v[124:127]
    buffer_load_dwordx4 a[216:219], v8, s[40:43], s57 offen offset:1024
    v_mfma_f32_16x16x32_bf16 v[132:135], a[128:131], a[164:167], v[132:135]
    ds_read_b64_tr_b16 a[88:89], v7 offset:63616
    ds_read_b64_tr_b16 a[90:91], v9 offset:1152
    v_mfma_f32_16x16x32_bf16 v[140:143], a[132:135], a[164:167], v[140:143]
    ds_read_b64_tr_b16 a[92:93], v11 offset:63616
    v_mfma_f32_16x16x32_bf16 v[148:151], a[136:139], a[164:167], v[148:151]
    ds_read_b64_tr_b16 a[94:95], v14 offset:1152
    v_mfma_f32_16x16x32_bf16 v[156:159], a[140:143], a[164:167], v[156:159]
    buffer_load_dwordx4 a[220:223], v8, s[40:43], s58 offen offset:1024
    s_waitcnt lgkmcnt(15)
    s_barrier
    s_waitcnt vmcnt(12)
    s_waitcnt lgkmcnt(15)
    v_mfma_f32_16x16x32_bf16 v[64:67], a[0:3], a[168:171], v[64:67]
    ds_read_b64_tr_b16 a[96:97], v9 offset:4096
    ds_read_b64_tr_b16 a[98:99], v9 offset:7168
    v_mfma_f32_16x16x32_bf16 v[72:75], a[4:7], a[168:171], v[72:75]
    ds_read_b64_tr_b16 a[100:101], v14 offset:4096
    v_mfma_f32_16x16x32_bf16 v[80:83], a[8:11], a[168:171], v[80:83]
    buffer_load_dwordx4 a[224:227], v8, s[40:43], s57 offen offset:2048
    ds_read_b64_tr_b16 a[102:103], v14 offset:7168
    v_mfma_f32_16x16x32_bf16 v[88:91], a[12:15], a[168:171], v[88:91]
    ds_read_b64_tr_b16 a[104:105], v9 offset:4160
    v_mfma_f32_16x16x32_bf16 v[96:99], a[16:19], a[168:171], v[96:99]
    buffer_load_dwordx4 a[228:231], v8, s[40:43], s58 offen offset:2048
    ds_read_b64_tr_b16 a[106:107], v9 offset:7232
    v_mfma_f32_16x16x32_bf16 v[104:107], a[20:23], a[168:171], v[104:107]
    ds_read_b64_tr_b16 a[108:109], v14 offset:4160
    v_mfma_f32_16x16x32_bf16 v[112:115], a[24:27], a[168:171], v[112:115]
    s_add_u32 m0, s35, 73728
    ds_read_b64_tr_b16 a[110:111], v14 offset:7232
    v_mfma_f32_16x16x32_bf16 v[120:123], a[28:31], a[168:171], v[120:123]
    ds_read_b64_tr_b16 a[112:113], v9 offset:4224
    v_mfma_f32_16x16x32_bf16 v[128:131], a[32:35], a[168:171], v[128:131]
    s_add_u32 s50, s34, 1144832
    ds_read_b64_tr_b16 a[114:115], v9 offset:7296
    v_mfma_f32_16x16x32_bf16 v[136:139], a[36:39], a[168:171], v[136:139]
    ds_read_b64_tr_b16 a[116:117], v14 offset:4224
    v_mfma_f32_16x16x32_bf16 v[144:147], a[40:43], a[168:171], v[144:147]
    buffer_load_dwordx4 v60, s[28:31], s50 offen lds
    ds_read_b64_tr_b16 a[118:119], v14 offset:7296
    v_mfma_f32_16x16x32_bf16 v[152:155], a[44:47], a[168:171], v[152:155]
    ds_read_b64_tr_b16 a[120:121], v9 offset:10240
    v_mfma_f32_16x16x32_bf16 v[68:71], a[0:3], a[172:175], v[68:71]
    ds_read_b64_tr_b16 a[122:123], v9 offset:13312
    v_mfma_f32_16x16x32_bf16 v[76:79], a[4:7], a[172:175], v[76:79]
    s_add_u32 m0, s35, 74752
    ds_read_b64_tr_b16 a[124:125], v14 offset:10240
    v_mfma_f32_16x16x32_bf16 v[84:87], a[8:11], a[172:175], v[84:87]
    ds_read_b64_tr_b16 a[126:127], v14 offset:13312
    v_mfma_f32_16x16x32_bf16 v[92:95], a[12:15], a[172:175], v[92:95]
    s_add_u32 s50, s34, 1144832
    ds_read_b64_tr_b16 a[128:129], v9 offset:10304
    v_mfma_f32_16x16x32_bf16 v[100:103], a[16:19], a[172:175], v[100:103]
    ds_read_b64_tr_b16 a[130:131], v9 offset:13376
    v_mfma_f32_16x16x32_bf16 v[108:111], a[20:23], a[172:175], v[108:111]
    buffer_load_dwordx4 v61, s[28:31], s50 offen lds
    ds_read_b64_tr_b16 a[132:133], v14 offset:10304
    v_mfma_f32_16x16x32_bf16 v[116:119], a[24:27], a[172:175], v[116:119]
    ds_read_b64_tr_b16 a[134:135], v14 offset:13376
    v_mfma_f32_16x16x32_bf16 v[124:127], a[28:31], a[172:175], v[124:127]
    s_add_u32 m0, s35, 75776
    ds_read_b64_tr_b16 a[136:137], v9 offset:10368
    v_mfma_f32_16x16x32_bf16 v[132:135], a[32:35], a[172:175], v[132:135]
    ds_read_b64_tr_b16 a[138:139], v9 offset:13440
    v_mfma_f32_16x16x32_bf16 v[140:143], a[36:39], a[172:175], v[140:143]
    s_add_u32 s50, s34, 1144832
    ds_read_b64_tr_b16 a[140:141], v14 offset:10368
    v_mfma_f32_16x16x32_bf16 v[148:151], a[40:43], a[172:175], v[148:151]
    ds_read_b64_tr_b16 a[142:143], v14 offset:13440
    v_mfma_f32_16x16x32_bf16 v[156:159], a[44:47], a[172:175], v[156:159]
    buffer_load_dwordx4 v62, s[28:31], s50 offen lds
    s_waitcnt vmcnt(15)
    s_waitcnt lgkmcnt(15)
    v_mfma_f32_16x16x32_bf16 v[64:67], a[48:51], a[176:179], v[64:67]
    ds_read_b64_tr_b16 a[0:1], v9 offset:16384
    ds_read_b64_tr_b16 a[2:3], v9 offset:19456
    v_mfma_f32_16x16x32_bf16 v[72:75], a[52:55], a[176:179], v[72:75]
    ds_read_b64_tr_b16 a[4:5], v14 offset:16384
    v_mfma_f32_16x16x32_bf16 v[80:83], a[56:59], a[176:179], v[80:83]
    buffer_load_dwordx4 a[232:235], v8, s[40:43], s57 offen offset:3072
    ds_read_b64_tr_b16 a[6:7], v14 offset:19456
    v_mfma_f32_16x16x32_bf16 v[88:91], a[60:63], a[176:179], v[88:91]
    ds_read_b64_tr_b16 a[8:9], v9 offset:16448
    v_mfma_f32_16x16x32_bf16 v[96:99], a[64:67], a[176:179], v[96:99]
    buffer_load_dwordx4 a[236:239], v8, s[40:43], s58 offen offset:3072
    ds_read_b64_tr_b16 a[10:11], v9 offset:19520
    v_mfma_f32_16x16x32_bf16 v[104:107], a[68:71], a[176:179], v[104:107]
    ds_read_b64_tr_b16 a[12:13], v14 offset:16448
    v_mfma_f32_16x16x32_bf16 v[112:115], a[72:75], a[176:179], v[112:115]
    s_add_u32 m0, s35, 86016
    ds_read_b64_tr_b16 a[14:15], v14 offset:19520
    v_mfma_f32_16x16x32_bf16 v[120:123], a[76:79], a[176:179], v[120:123]
    ds_read_b64_tr_b16 a[16:17], v9 offset:16512
    v_mfma_f32_16x16x32_bf16 v[128:131], a[80:83], a[176:179], v[128:131]
    s_add_u32 s50, s34, 1232896
    ds_read_b64_tr_b16 a[18:19], v9 offset:19584
    v_mfma_f32_16x16x32_bf16 v[136:139], a[84:87], a[176:179], v[136:139]
    ds_read_b64_tr_b16 a[20:21], v14 offset:16512
    v_mfma_f32_16x16x32_bf16 v[144:147], a[88:91], a[176:179], v[144:147]
    buffer_load_dwordx4 v60, s[28:31], s50 offen lds
    ds_read_b64_tr_b16 a[22:23], v14 offset:19584
    v_mfma_f32_16x16x32_bf16 v[152:155], a[92:95], a[176:179], v[152:155]
    ds_read_b64_tr_b16 a[24:25], v9 offset:22528
    v_mfma_f32_16x16x32_bf16 v[68:71], a[48:51], a[180:183], v[68:71]
    ds_read_b64_tr_b16 a[26:27], v9 offset:25600
    v_mfma_f32_16x16x32_bf16 v[76:79], a[52:55], a[180:183], v[76:79]
    s_add_u32 m0, s35, 87040
    ds_read_b64_tr_b16 a[28:29], v14 offset:22528
    v_mfma_f32_16x16x32_bf16 v[84:87], a[56:59], a[180:183], v[84:87]
    ds_read_b64_tr_b16 a[30:31], v14 offset:25600
    v_mfma_f32_16x16x32_bf16 v[92:95], a[60:63], a[180:183], v[92:95]
    s_add_u32 s50, s34, 1232896
    ds_read_b64_tr_b16 a[32:33], v9 offset:22592
    v_mfma_f32_16x16x32_bf16 v[100:103], a[64:67], a[180:183], v[100:103]
    ds_read_b64_tr_b16 a[34:35], v9 offset:25664
    v_mfma_f32_16x16x32_bf16 v[108:111], a[68:71], a[180:183], v[108:111]
    buffer_load_dwordx4 v61, s[28:31], s50 offen lds
    ds_read_b64_tr_b16 a[36:37], v14 offset:22592
    v_mfma_f32_16x16x32_bf16 v[116:119], a[72:75], a[180:183], v[116:119]
    ds_read_b64_tr_b16 a[38:39], v14 offset:25664
    v_mfma_f32_16x16x32_bf16 v[124:127], a[76:79], a[180:183], v[124:127]
    s_add_u32 m0, s35, 88064
    ds_read_b64_tr_b16 a[40:41], v9 offset:22656
    v_mfma_f32_16x16x32_bf16 v[132:135], a[80:83], a[180:183], v[132:135]
    ds_read_b64_tr_b16 a[42:43], v9 offset:25728
    v_mfma_f32_16x16x32_bf16 v[140:143], a[84:87], a[180:183], v[140:143]
    s_add_u32 s50, s34, 1232896
    ds_read_b64_tr_b16 a[44:45], v14 offset:22656
    v_mfma_f32_16x16x32_bf16 v[148:151], a[88:91], a[180:183], v[148:151]
    ds_read_b64_tr_b16 a[46:47], v14 offset:25728
    v_mfma_f32_16x16x32_bf16 v[156:159], a[92:95], a[180:183], v[156:159]
    buffer_load_dwordx4 v62, s[28:31], s50 offen lds
    s_waitcnt vmcnt(18)
    s_waitcnt lgkmcnt(15)
    v_mfma_f32_16x16x32_bf16 v[64:67], a[96:99], a[184:187], v[64:67]
    ds_read_b64_tr_b16 a[48:49], v6 offset:0
    ds_read_b64_tr_b16 a[50:51], v6 offset:3072
    v_mfma_f32_16x16x32_bf16 v[72:75], a[100:103], a[184:187], v[72:75]
    s_add_u32 s57, s55, 12288
    ds_read_b64_tr_b16 a[52:53], v10 offset:0
    v_mfma_f32_16x16x32_bf16 v[80:83], a[104:107], a[184:187], v[80:83]
    ds_read_b64_tr_b16 a[54:55], v10 offset:3072
    v_mfma_f32_16x16x32_bf16 v[88:91], a[108:111], a[184:187], v[88:91]
    buffer_load_dwordx4 v[160:163], v8, s[40:43], s57 offen offset:0
    ds_read_b64_tr_b16 a[56:57], v6 offset:64
    v_mfma_f32_16x16x32_bf16 v[96:99], a[112:115], a[184:187], v[96:99]
    ds_read_b64_tr_b16 a[58:59], v6 offset:3136
    v_mfma_f32_16x16x32_bf16 v[104:107], a[116:119], a[184:187], v[104:107]
    s_add_u32 s58, s56, 12288
    ds_read_b64_tr_b16 a[60:61], v10 offset:64
    v_mfma_f32_16x16x32_bf16 v[112:115], a[120:123], a[184:187], v[112:115]
    ds_read_b64_tr_b16 a[62:63], v10 offset:3136
    v_mfma_f32_16x16x32_bf16 v[120:123], a[124:127], a[184:187], v[120:123]
    buffer_load_dwordx4 v[164:167], v8, s[40:43], s58 offen offset:0
    ds_read_b64_tr_b16 a[64:65], v6 offset:128
    v_mfma_f32_16x16x32_bf16 v[128:131], a[128:131], a[184:187], v[128:131]
    ds_read_b64_tr_b16 a[66:67], v6 offset:3200
    v_mfma_f32_16x16x32_bf16 v[136:139], a[132:135], a[184:187], v[136:139]
    s_add_u32 m0, s35, 98304
    ds_read_b64_tr_b16 a[68:69], v10 offset:128
    v_mfma_f32_16x16x32_bf16 v[144:147], a[136:139], a[184:187], v[144:147]
    ds_read_b64_tr_b16 a[70:71], v10 offset:3200
    v_mfma_f32_16x16x32_bf16 v[152:155], a[140:143], a[184:187], v[152:155]
    s_add_u32 s50, s34, 1320960
    ds_read_b64_tr_b16 a[72:73], v6 offset:6144
    v_mfma_f32_16x16x32_bf16 v[68:71], a[96:99], a[188:191], v[68:71]
    buffer_load_dwordx4 v60, s[28:31], s50 offen lds
    ds_read_b64_tr_b16 a[74:75], v6 offset:9216
    v_mfma_f32_16x16x32_bf16 v[76:79], a[100:103], a[188:191], v[76:79]
    ds_read_b64_tr_b16 a[76:77], v10 offset:6144
    v_mfma_f32_16x16x32_bf16 v[84:87], a[104:107], a[188:191], v[84:87]
    s_add_u32 m0, s35, 99328
    ds_read_b64_tr_b16 a[78:79], v10 offset:9216
    v_mfma_f32_16x16x32_bf16 v[92:95], a[108:111], a[188:191], v[92:95]
    ds_read_b64_tr_b16 a[80:81], v6 offset:6208
    v_mfma_f32_16x16x32_bf16 v[100:103], a[112:115], a[188:191], v[100:103]
    s_add_u32 s50, s34, 1320960
    ds_read_b64_tr_b16 a[82:83], v6 offset:9280
    v_mfma_f32_16x16x32_bf16 v[108:111], a[116:119], a[188:191], v[108:111]
    ds_read_b64_tr_b16 a[84:85], v10 offset:6208
    v_mfma_f32_16x16x32_bf16 v[116:119], a[120:123], a[188:191], v[116:119]
    buffer_load_dwordx4 v61, s[28:31], s50 offen lds
    ds_read_b64_tr_b16 a[86:87], v10 offset:9280
    v_mfma_f32_16x16x32_bf16 v[124:127], a[124:127], a[188:191], v[124:127]
    ds_read_b64_tr_b16 a[88:89], v6 offset:6272
    v_mfma_f32_16x16x32_bf16 v[132:135], a[128:131], a[188:191], v[132:135]
    s_add_u32 m0, s35, 100352
    ds_read_b64_tr_b16 a[90:91], v6 offset:9344
    v_mfma_f32_16x16x32_bf16 v[140:143], a[132:135], a[188:191], v[140:143]
    ds_read_b64_tr_b16 a[92:93], v10 offset:6272
    v_mfma_f32_16x16x32_bf16 v[148:151], a[136:139], a[188:191], v[148:151]
    s_add_u32 s50, s34, 1320960
    ds_read_b64_tr_b16 a[94:95], v10 offset:9344
    v_mfma_f32_16x16x32_bf16 v[156:159], a[140:143], a[188:191], v[156:159]
    buffer_load_dwordx4 v62, s[28:31], s50 offen lds
    s_waitcnt vmcnt(21)
    s_waitcnt lgkmcnt(15)
    v_mfma_f32_16x16x32_bf16 v[64:67], a[0:3], a[192:195], v[64:67]
    ds_read_b64_tr_b16 a[96:97], v6 offset:12288
    ds_read_b64_tr_b16 a[98:99], v6 offset:15360
    v_mfma_f32_16x16x32_bf16 v[72:75], a[4:7], a[192:195], v[72:75]
    ds_read_b64_tr_b16 a[100:101], v10 offset:12288
    v_mfma_f32_16x16x32_bf16 v[80:83], a[8:11], a[192:195], v[80:83]
    ds_read_b64_tr_b16 a[102:103], v10 offset:15360
    v_mfma_f32_16x16x32_bf16 v[88:91], a[12:15], a[192:195], v[88:91]
    buffer_load_dwordx4 v[168:171], v8, s[40:43], s57 offen offset:1024
    v_mfma_f32_16x16x32_bf16 v[96:99], a[16:19], a[192:195], v[96:99]
    ds_read_b64_tr_b16 a[104:105], v6 offset:12352
    ds_read_b64_tr_b16 a[106:107], v6 offset:15424
    v_mfma_f32_16x16x32_bf16 v[104:107], a[20:23], a[192:195], v[104:107]
    ds_read_b64_tr_b16 a[108:109], v10 offset:12352
    v_mfma_f32_16x16x32_bf16 v[112:115], a[24:27], a[192:195], v[112:115]
    ds_read_b64_tr_b16 a[110:111], v10 offset:15424
    v_mfma_f32_16x16x32_bf16 v[120:123], a[28:31], a[192:195], v[120:123]
    buffer_load_dwordx4 v[172:175], v8, s[40:43], s58 offen offset:1024
    v_mfma_f32_16x16x32_bf16 v[128:131], a[32:35], a[192:195], v[128:131]
    ds_read_b64_tr_b16 a[112:113], v6 offset:12416
    ds_read_b64_tr_b16 a[114:115], v6 offset:15488
    v_mfma_f32_16x16x32_bf16 v[136:139], a[36:39], a[192:195], v[136:139]
    ds_read_b64_tr_b16 a[116:117], v10 offset:12416
    v_mfma_f32_16x16x32_bf16 v[144:147], a[40:43], a[192:195], v[144:147]
    ds_read_b64_tr_b16 a[118:119], v10 offset:15488
    v_mfma_f32_16x16x32_bf16 v[152:155], a[44:47], a[192:195], v[152:155]
    buffer_load_dwordx2 v[192:193], v15, s[40:43], s52 offen offset:0 sc1
    v_mfma_f32_16x16x32_bf16 v[68:71], a[0:3], a[196:199], v[68:71]
    ds_read_b64_tr_b16 a[120:121], v6 offset:18432
    ds_read_b64_tr_b16 a[122:123], v6 offset:21504
    v_mfma_f32_16x16x32_bf16 v[76:79], a[4:7], a[196:199], v[76:79]
    ds_read_b64_tr_b16 a[124:125], v10 offset:18432
    v_mfma_f32_16x16x32_bf16 v[84:87], a[8:11], a[196:199], v[84:87]
    ds_read_b64_tr_b16 a[126:127], v10 offset:21504
    v_mfma_f32_16x16x32_bf16 v[92:95], a[12:15], a[196:199], v[92:95]
    buffer_load_dwordx2 v[196:197], v15, s[40:43], s52 offen offset:2048 sc1
    v_mfma_f32_16x16x32_bf16 v[100:103], a[16:19], a[196:199], v[100:103]
    ds_read_b64_tr_b16 a[128:129], v6 offset:18496
    ds_read_b64_tr_b16 a[130:131], v6 offset:21568
    v_mfma_f32_16x16x32_bf16 v[108:111], a[20:23], a[196:199], v[108:111]
    ds_read_b64_tr_b16 a[132:133], v10 offset:18496
    v_mfma_f32_16x16x32_bf16 v[116:119], a[24:27], a[196:199], v[116:119]
    ds_read_b64_tr_b16 a[134:135], v10 offset:21568
    v_mfma_f32_16x16x32_bf16 v[124:127], a[28:31], a[196:199], v[124:127]
    buffer_load_dwordx2 v[194:195], v15, s[40:43], s52 offen offset:128 sc1
    v_mfma_f32_16x16x32_bf16 v[132:135], a[32:35], a[196:199], v[132:135]
    ds_read_b64_tr_b16 a[136:137], v6 offset:18560
    ds_read_b64_tr_b16 a[138:139], v6 offset:21632
    v_mfma_f32_16x16x32_bf16 v[140:143], a[36:39], a[196:199], v[140:143]
    ds_read_b64_tr_b16 a[140:141], v10 offset:18560
    v_mfma_f32_16x16x32_bf16 v[148:151], a[40:43], a[196:199], v[148:151]
    ds_read_b64_tr_b16 a[142:143], v10 offset:21632
    v_mfma_f32_16x16x32_bf16 v[156:159], a[44:47], a[196:199], v[156:159]
    buffer_load_dwordx2 v[198:199], v15, s[40:43], s52 offen offset:2176 sc1
    s_waitcnt lgkmcnt(15)
    s_barrier
    s_waitcnt vmcnt(25)
    s_waitcnt lgkmcnt(15)
    v_mfma_f32_16x16x32_bf16 v[64:67], a[48:51], a[200:203], v[64:67]
    ds_read_b64_tr_b16 a[0:1], v6 offset:24576
    ds_read_b64_tr_b16 a[2:3], v6 offset:27648
    v_mfma_f32_16x16x32_bf16 v[72:75], a[52:55], a[200:203], v[72:75]
    ds_read_b64_tr_b16 a[4:5], v10 offset:24576
    v_mfma_f32_16x16x32_bf16 v[80:83], a[56:59], a[200:203], v[80:83]
    buffer_load_dwordx4 v[176:179], v8, s[40:43], s57 offen offset:2048
    ds_read_b64_tr_b16 a[6:7], v10 offset:27648
    v_mfma_f32_16x16x32_bf16 v[88:91], a[60:63], a[200:203], v[88:91]
    ds_read_b64_tr_b16 a[8:9], v6 offset:24640
    v_mfma_f32_16x16x32_bf16 v[96:99], a[64:67], a[200:203], v[96:99]
    buffer_load_dwordx4 v[180:183], v8, s[40:43], s58 offen offset:2048
    ds_read_b64_tr_b16 a[10:11], v6 offset:27712
    v_mfma_f32_16x16x32_bf16 v[104:107], a[68:71], a[200:203], v[104:107]
    ds_read_b64_tr_b16 a[12:13], v10 offset:24640
    v_mfma_f32_16x16x32_bf16 v[112:115], a[72:75], a[200:203], v[112:115]
    s_add_u32 m0, s45, 110592
    ds_read_b64_tr_b16 a[14:15], v10 offset:27712
    v_mfma_f32_16x16x32_bf16 v[120:123], a[76:79], a[200:203], v[120:123]
    ds_read_b64_tr_b16 a[16:17], v6 offset:24704
    v_mfma_f32_16x16x32_bf16 v[128:131], a[80:83], a[200:203], v[128:131]
    s_add_u32 s50, s44, 0
    ds_read_b64_tr_b16 a[18:19], v6 offset:27776
    v_mfma_f32_16x16x32_bf16 v[136:139], a[84:87], a[200:203], v[136:139]
    ds_read_b64_tr_b16 a[20:21], v10 offset:24704
    v_mfma_f32_16x16x32_bf16 v[144:147], a[88:91], a[200:203], v[144:147]
    buffer_load_dwordx4 v63, s[24:27], s50 offen lds
    ds_read_b64_tr_b16 a[22:23], v10 offset:27776
    v_mfma_f32_16x16x32_bf16 v[152:155], a[92:95], a[200:203], v[152:155]
    ds_read_b64_tr_b16 a[24:25], v6 offset:30720
    v_mfma_f32_16x16x32_bf16 v[68:71], a[48:51], a[204:207], v[68:71]
    ds_read_b64_tr_b16 a[26:27], v6 offset:33792
    v_mfma_f32_16x16x32_bf16 v[76:79], a[52:55], a[204:207], v[76:79]
    s_add_u32 m0, s45, 114688
    ds_read_b64_tr_b16 a[28:29], v10 offset:30720
    v_mfma_f32_16x16x32_bf16 v[84:87], a[56:59], a[204:207], v[84:87]
    ds_read_b64_tr_b16 a[30:31], v10 offset:33792
    v_mfma_f32_16x16x32_bf16 v[92:95], a[60:63], a[204:207], v[92:95]
    s_add_u32 s50, s44, 32768
    ds_read_b64_tr_b16 a[32:33], v6 offset:30784
    v_mfma_f32_16x16x32_bf16 v[100:103], a[64:67], a[204:207], v[100:103]
    ds_read_b64_tr_b16 a[34:35], v6 offset:33856
    v_mfma_f32_16x16x32_bf16 v[108:111], a[68:71], a[204:207], v[108:111]
    buffer_load_dwordx4 v63, s[24:27], s50 offen lds
    ds_read_b64_tr_b16 a[36:37], v10 offset:30784
    v_mfma_f32_16x16x32_bf16 v[116:119], a[72:75], a[204:207], v[116:119]
    ds_read_b64_tr_b16 a[38:39], v10 offset:33856
    v_mfma_f32_16x16x32_bf16 v[124:127], a[76:79], a[204:207], v[124:127]
    s_add_u32 m0, s45, 118784
    ds_read_b64_tr_b16 a[40:41], v6 offset:30848
    v_mfma_f32_16x16x32_bf16 v[132:135], a[80:83], a[204:207], v[132:135]
    ds_read_b64_tr_b16 a[42:43], v6 offset:33920
    v_mfma_f32_16x16x32_bf16 v[140:143], a[84:87], a[204:207], v[140:143]
    s_add_u32 s50, s44, 65536
    ds_read_b64_tr_b16 a[44:45], v10 offset:30848
    v_mfma_f32_16x16x32_bf16 v[148:151], a[88:91], a[204:207], v[148:151]
    ds_read_b64_tr_b16 a[46:47], v10 offset:33920
    v_mfma_f32_16x16x32_bf16 v[156:159], a[92:95], a[204:207], v[156:159]
    buffer_load_dwordx4 v63, s[24:27], s50 offen lds
    s_waitcnt vmcnt(28)
    s_waitcnt lgkmcnt(15)
    v_mfma_f32_16x16x32_bf16 v[64:67], a[96:99], a[208:211], v[64:67]
    ds_read_b64_tr_b16 a[48:49], v6 offset:36864
    ds_read_b64_tr_b16 a[50:51], v6 offset:39936
    v_mfma_f32_16x16x32_bf16 v[72:75], a[100:103], a[208:211], v[72:75]
    ds_read_b64_tr_b16 a[52:53], v10 offset:36864
    v_mfma_f32_16x16x32_bf16 v[80:83], a[104:107], a[208:211], v[80:83]
    buffer_load_dwordx4 v[184:187], v8, s[40:43], s57 offen offset:3072
    ds_read_b64_tr_b16 a[54:55], v10 offset:39936
    v_mfma_f32_16x16x32_bf16 v[88:91], a[108:111], a[208:211], v[88:91]
    ds_read_b64_tr_b16 a[56:57], v6 offset:36928
    v_mfma_f32_16x16x32_bf16 v[96:99], a[112:115], a[208:211], v[96:99]
    buffer_load_dwordx4 v[188:191], v8, s[40:43], s58 offen offset:3072
    ds_read_b64_tr_b16 a[58:59], v6 offset:40000
    v_mfma_f32_16x16x32_bf16 v[104:107], a[116:119], a[208:211], v[104:107]
    ds_read_b64_tr_b16 a[60:61], v10 offset:36928
    v_mfma_f32_16x16x32_bf16 v[112:115], a[120:123], a[208:211], v[112:115]
    s_add_u32 m0, s45, 122880
    ds_read_b64_tr_b16 a[62:63], v10 offset:40000
    v_mfma_f32_16x16x32_bf16 v[120:123], a[124:127], a[208:211], v[120:123]
    ds_read_b64_tr_b16 a[64:65], v6 offset:36992
    v_mfma_f32_16x16x32_bf16 v[128:131], a[128:131], a[208:211], v[128:131]
    s_add_u32 s50, s44, 98304
    ds_read_b64_tr_b16 a[66:67], v6 offset:40064
    v_mfma_f32_16x16x32_bf16 v[136:139], a[132:135], a[208:211], v[136:139]
    ds_read_b64_tr_b16 a[68:69], v10 offset:36992
    v_mfma_f32_16x16x32_bf16 v[144:147], a[136:139], a[208:211], v[144:147]
    buffer_load_dwordx4 v63, s[24:27], s50 offen lds
    ds_read_b64_tr_b16 a[70:71], v10 offset:40064
    v_mfma_f32_16x16x32_bf16 v[152:155], a[140:143], a[208:211], v[152:155]
    ds_read_b64_tr_b16 a[72:73], v6 offset:43008
    v_mfma_f32_16x16x32_bf16 v[68:71], a[96:99], a[212:215], v[68:71]
    ds_read_b64_tr_b16 a[74:75], v6 offset:46080
    v_mfma_f32_16x16x32_bf16 v[76:79], a[100:103], a[212:215], v[76:79]
    s_add_u32 m0, s45, 126976
    ds_read_b64_tr_b16 a[76:77], v10 offset:43008
    v_mfma_f32_16x16x32_bf16 v[84:87], a[104:107], a[212:215], v[84:87]
    ds_read_b64_tr_b16 a[78:79], v10 offset:46080
    v_mfma_f32_16x16x32_bf16 v[92:95], a[108:111], a[212:215], v[92:95]
    s_add_u32 s50, s44, 131072
    ds_read_b64_tr_b16 a[80:81], v6 offset:43072
    v_mfma_f32_16x16x32_bf16 v[100:103], a[112:115], a[212:215], v[100:103]
    ds_read_b64_tr_b16 a[82:83], v6 offset:46144
    v_mfma_f32_16x16x32_bf16 v[108:111], a[116:119], a[212:215], v[108:111]
    buffer_load_dwordx4 v63, s[24:27], s50 offen lds
    ds_read_b64_tr_b16 a[84:85], v10 offset:43072
    v_mfma_f32_16x16x32_bf16 v[116:119], a[120:123], a[212:215], v[116:119]
    ds_read_b64_tr_b16 a[86:87], v10 offset:46144
    v_mfma_f32_16x16x32_bf16 v[124:127], a[124:127], a[212:215], v[124:127]
    s_add_u32 m0, s45, 131072
    ds_read_b64_tr_b16 a[88:89], v6 offset:43136
    v_mfma_f32_16x16x32_bf16 v[132:135], a[128:131], a[212:215], v[132:135]
    ds_read_b64_tr_b16 a[90:91], v6 offset:46208
    v_mfma_f32_16x16x32_bf16 v[140:143], a[132:135], a[212:215], v[140:143]
    s_add_u32 s50, s44, 163840
    ds_read_b64_tr_b16 a[92:93], v10 offset:43136
    v_mfma_f32_16x16x32_bf16 v[148:151], a[136:139], a[212:215], v[148:151]
    ds_read_b64_tr_b16 a[94:95], v10 offset:46208
    v_mfma_f32_16x16x32_bf16 v[156:159], a[140:143], a[212:215], v[156:159]
    buffer_load_dwordx4 v63, s[24:27], s50 offen lds
    s_waitcnt vmcnt(31)
    s_waitcnt lgkmcnt(15)
    v_mfma_f32_16x16x32_bf16 v[64:67], a[0:3], a[216:219], v[64:67]
    ds_read_b64_tr_b16 a[96:97], v6 offset:49152
    ds_read_b64_tr_b16 a[98:99], v6 offset:52224
    v_mfma_f32_16x16x32_bf16 v[72:75], a[4:7], a[216:219], v[72:75]
    ds_read_b64_tr_b16 a[100:101], v10 offset:49152
    v_mfma_f32_16x16x32_bf16 v[80:83], a[8:11], a[216:219], v[80:83]
    v_mov_b32 v12, 0
    ds_read_b64_tr_b16 a[102:103], v10 offset:52224
    v_mfma_f32_16x16x32_bf16 v[88:91], a[12:15], a[216:219], v[88:91]
    ds_read_b64_tr_b16 a[104:105], v6 offset:49216
    v_mfma_f32_16x16x32_bf16 v[96:99], a[16:19], a[216:219], v[96:99]
    buffer_load_dword v13, v12, s[40:43], s51 offen sc1
    ds_read_b64_tr_b16 a[106:107], v6 offset:52288
    v_mfma_f32_16x16x32_bf16 v[104:107], a[20:23], a[216:219], v[104:107]
    ds_read_b64_tr_b16 a[108:109], v10 offset:49216
    v_mfma_f32_16x16x32_bf16 v[112:115], a[24:27], a[216:219], v[112:115]
    s_add_u32 m0, s45, 135168
    ds_read_b64_tr_b16 a[110:111], v10 offset:52288
    v_mfma_f32_16x16x32_bf16 v[120:123], a[28:31], a[216:219], v[120:123]
    ds_read_b64_tr_b16 a[112:113], v6 offset:49280
    v_mfma_f32_16x16x32_bf16 v[128:131], a[32:35], a[216:219], v[128:131]
    s_add_u32 s50, s44, 196608
    ds_read_b64_tr_b16 a[114:115], v6 offset:52352
    v_mfma_f32_16x16x32_bf16 v[136:139], a[36:39], a[216:219], v[136:139]
    ds_read_b64_tr_b16 a[116:117], v10 offset:49280
    v_mfma_f32_16x16x32_bf16 v[144:147], a[40:43], a[216:219], v[144:147]
    buffer_load_dwordx4 v63, s[24:27], s50 offen lds
    ds_read_b64_tr_b16 a[118:119], v10 offset:52352
    v_mfma_f32_16x16x32_bf16 v[152:155], a[44:47], a[216:219], v[152:155]
    ds_read_b64_tr_b16 a[120:121], v6 offset:55296
    v_mfma_f32_16x16x32_bf16 v[68:71], a[0:3], a[220:223], v[68:71]
    ds_read_b64_tr_b16 a[122:123], v6 offset:58368
    v_mfma_f32_16x16x32_bf16 v[76:79], a[4:7], a[220:223], v[76:79]
    s_add_u32 m0, s45, 139264
    ds_read_b64_tr_b16 a[124:125], v10 offset:55296
    v_mfma_f32_16x16x32_bf16 v[84:87], a[8:11], a[220:223], v[84:87]
    ds_read_b64_tr_b16 a[126:127], v10 offset:58368
    v_mfma_f32_16x16x32_bf16 v[92:95], a[12:15], a[220:223], v[92:95]
    s_add_u32 s50, s44, 229376
    ds_read_b64_tr_b16 a[128:129], v6 offset:55360
    v_mfma_f32_16x16x32_bf16 v[100:103], a[16:19], a[220:223], v[100:103]
    ds_read_b64_tr_b16 a[130:131], v6 offset:58432
    v_mfma_f32_16x16x32_bf16 v[108:111], a[20:23], a[220:223], v[108:111]
    buffer_load_dwordx4 v63, s[24:27], s50 offen lds
    ds_read_b64_tr_b16 a[132:133], v10 offset:55360
    v_mfma_f32_16x16x32_bf16 v[116:119], a[24:27], a[220:223], v[116:119]
    ds_read_b64_tr_b16 a[134:135], v10 offset:58432
    v_mfma_f32_16x16x32_bf16 v[124:127], a[28:31], a[220:223], v[124:127]
    s_add_u32 m0, s45, 143360
    ds_read_b64_tr_b16 a[136:137], v6 offset:55424
    v_mfma_f32_16x16x32_bf16 v[132:135], a[32:35], a[220:223], v[132:135]
    ds_read_b64_tr_b16 a[138:139], v6 offset:58496
    v_mfma_f32_16x16x32_bf16 v[140:143], a[36:39], a[220:223], v[140:143]
    s_add_u32 s50, s44, 262144
    ds_read_b64_tr_b16 a[140:141], v10 offset:55424
    v_mfma_f32_16x16x32_bf16 v[148:151], a[40:43], a[220:223], v[148:151]
    ds_read_b64_tr_b16 a[142:143], v10 offset:58496
    v_mfma_f32_16x16x32_bf16 v[156:159], a[44:47], a[220:223], v[156:159]
    buffer_load_dwordx4 v63, s[24:27], s50 offen lds
    s_waitcnt vmcnt(33)
    s_waitcnt lgkmcnt(15)
    v_mfma_f32_16x16x32_bf16 v[64:67], a[48:51], a[224:227], v[64:67]
    ds_read_b64_tr_b16 a[0:1], v6 offset:61440
    s_add_u32 m0, s45, 147456
    s_add_u32 s50, s44, 294912
    ds_read_b64_tr_b16 a[2:3], v6 offset:64512
    v_mfma_f32_16x16x32_bf16 v[72:75], a[52:55], a[224:227], v[72:75]
    buffer_load_dwordx4 v63, s[24:27], s50 offen lds
    s_add_u32 m0, s45, 151552
PG144:
    s_cbranch_execz PW_S3
    ds_read_b64_tr_b16 a[4:5], v10 offset:61440
    v_mfma_f32_16x16x32_bf16 v[80:83], a[56:59], a[224:227], v[80:83]
    s_add_u32 s50, s44, 327680
    buffer_load_dwordx4 v63, s[24:27], s50 offen lds
    s_add_u32 m0, s45, 155648
    ds_read_b64_tr_b16 a[6:7], v10 offset:64512
    v_mfma_f32_16x16x32_bf16 v[88:91], a[60:63], a[224:227], v[88:91]
    s_add_u32 s50, s44, 360448
    buffer_load_dwordx4 v63, s[24:27], s50 offen lds
    ds_read_b64_tr_b16 a[8:9], v6 offset:61504
    v_mfma_f32_16x16x32_bf16 v[96:99], a[64:67], a[224:227], v[96:99]
    s_waitcnt vmcnt(17)
    v_add_f32 v192, v192, v196
    v_add_f32 v193, v193, v197
    ds_read_b64_tr_b16 a[10:11], v6 offset:64576
    v_mfma_f32_16x16x32_bf16 v[104:107], a[68:71], a[224:227], v[104:107]
    v_add_f32 v194, v194, v198
    v_add_f32 v195, v195, v199
    ds_read_b64_tr_b16 a[12:13], v10 offset:61504
    v_mfma_f32_16x16x32_bf16 v[112:115], a[72:75], a[224:227], v[112:115]
    v_mov_b32 v196, v192
    v_mov_b32 v197, v193
    v_mov_b32 v198, v194
    ds_read_b64_tr_b16 a[14:15], v10 offset:64576
    v_mfma_f32_16x16x32_bf16 v[120:123], a[76:79], a[224:227], v[120:123]
    v_mov_b32 v199, v195
    s_nop 0
    ds_read_b64_tr_b16 a[16:17], v6 offset:61568
    v_mfma_f32_16x16x32_bf16 v[128:131], a[80:83], a[224:227], v[128:131]
    v_permlane16_swap_b32 v192, v196
    v_permlane16_swap_b32 v193, v197
    v_permlane16_swap_b32 v194, v198
    ds_read_b64_tr_b16 a[18:19], v6 offset:64640
    v_mfma_f32_16x16x32_bf16 v[136:139], a[84:87], a[224:227], v[136:139]
    v_permlane16_swap_b32 v195, v199
    s_nop 0
    ds_read_b64_tr_b16 a[20:21], v10 offset:61568
    v_mfma_f32_16x16x32_bf16 v[144:147], a[88:91], a[224:227], v[144:147]
    v_add_f32 v192, v192, v196
    v_add_f32 v193, v193, v197
    v_add_f32 v194, v194, v198
    ds_read_b64_tr_b16 a[22:23], v10 offset:64640
    v_mfma_f32_16x16x32_bf16 v[152:155], a[92:95], a[224:227], v[152:155]
    v_add_f32 v195, v195, v199
    v_mov_b32 v196, v192
    ds_read_b64_tr_b16 a[24:25], v7 offset:2048
    v_mfma_f32_16x16x32_bf16 v[68:71], a[48:51], a[228:231], v[68:71]
    v_mov_b32 v197, v193
    v_mov_b32 v198, v194
    ds_read_b64_tr_b16 a[26:27], v7 offset:5120
    v_mfma_f32_16x16x32_bf16 v[76:79], a[52:55], a[228:231], v[76:79]
    v_mov_b32 v199, v195
    s_nop 0
    v_permlane32_swap_b32 v192, v196
    ds_read_b64_tr_b16 a[28:29], v11 offset:2048
    v_mfma_f32_16x16x32_bf16 v[84:87], a[56:59], a[228:231], v[84:87]
    v_permlane32_swap_b32 v193, v197
    v_permlane32_swap_b32 v194, v198
    ds_read_b64_tr_b16 a[30:31], v11 offset:5120
    v_mfma_f32_16x16x32_bf16 v[92:95], a[60:63], a[228:231], v[92:95]
    v_permlane32_swap_b32 v195, v199
    s_nop 0
    v_add_f32 v192, v192, v196
    ds_read_b64_tr_b16 a[32:33], v7 offset:2112
    v_mfma_f32_16x16x32_bf16 v[100:103], a[64:67], a[228:231], v[100:103]
    v_add_f32 v193, v193, v197
    v_add_f32 v194, v194, v198
    ds_read_b64_tr_b16 a[34:35], v7 offset:5184
    v_mfma_f32_16x16x32_bf16 v[108:111], a[68:71], a[228:231], v[108:111]
    v_add_f32 v195, v195, v199
    v_mul_f32 v192, 0x3b000000, v192
    v_mul_f32 v193, 0x3b000000, v193
    ds_read_b64_tr_b16 a[36:37], v11 offset:2112
    v_mfma_f32_16x16x32_bf16 v[116:119], a[72:75], a[228:231], v[116:119]
    v_mul_f32 v194, 0x3b000000, v194
    v_mul_f32 v195, 0x3b000000, v195
    ds_read_b64_tr_b16 a[38:39], v11 offset:5184
    v_mfma_f32_16x16x32_bf16 v[124:127], a[76:79], a[228:231], v[124:127]
    v_fma_f32 v193, -v192, v192, v193
    v_fma_f32 v195, -v194, v194, v195
    v_max_f32 v193, 0, v193
    ds_read_b64_tr_b16 a[40:41], v7 offset:2176
    v_mfma_f32_16x16x32_bf16 v[132:135], a[80:83], a[228:231], v[132:135]
    v_max_f32 v195, 0, v195
    v_add_f32 v193, 0x3727c5ac, v193
    ds_read_b64_tr_b16 a[42:43], v7 offset:5248
    v_mfma_f32_16x16x32_bf16 v[140:143], a[84:87], a[228:231], v[140:143]
    v_add_f32 v195, 0x3727c5ac, v195
    v_rsq_f32 v50, v193
    v_rsq_f32 v52, v195
    ds_read_b64_tr_b16 a[44:45], v11 offset:2176
    v_mfma_f32_16x16x32_bf16 v[148:151], a[88:91], a[228:231], v[148:151]
    s_nop 1
    v_mul_f32 v54, v192, v50
    ds_read_b64_tr_b16 a[46:47], v11 offset:5248
    v_mfma_f32_16x16x32_bf16 v[156:159], a[92:95], a[228:231], v[156:159]
    v_mul_f32 v56, v194, v52
    v_sub_f32 v54, 0, v54
    v_sub_f32 v56, 0, v56
    s_waitcnt vmcnt(23)
    s_waitcnt lgkmcnt(15)
    s_barrier
    s_waitcnt vmcnt(6)
    v_cmp_ne_u32 vcc, 1, v13
    s_cbranch_vccz G5_OK
    s_mov_b32 s49, 0
G5_P:
    buffer_load_dword v13, v12, s[40:43], s51 offen sc1
    s_add_u32 s49, s49, 1
    s_cmp_gt_u32 s49, 400000
    s_cbranch_scc1 G5_OK
    s_waitcnt vmcnt(0)
    v_cmp_ne_u32 vcc, 1, v13
    s_cbranch_vccz G5_OK
    s_sleep 3
    s_branch G5_P
G5_OK:
    s_waitcnt vmcnt(31)
    s_waitcnt lgkmcnt(15)
    v_mfma_f32_16x16x32_bf16 v[64:67], a[96:99], a[232:235], v[64:67]
    ds_read_b64_tr_b16 a[48:49], v7 offset:8192
    ds_read_b64_tr_b16 a[50:51], v7 offset:11264
    v_mfma_f32_16x16x32_bf16 v[72:75], a[100:103], a[232:235], v[72:75]
    s_mov_b32 m0, s59
    v_mfma_f32_16x16x32_bf16 v[80:83], a[104:107], a[232:235], v[80:83]
    ds_read_b64_tr_b16 a[52:53], v11 offset:8192
    ds_read_b64_tr_b16 a[54:55], v11 offset:11264
    v_mfma_f32_16x16x32_bf16 v[88:91], a[108:111], a[232:235], v[88:91]
    s_nop 0
    v_mfma_f32_16x16x32_bf16 v[96:99], a[112:115], a[232:235], v[96:99]
    ds_read_b64_tr_b16 a[56:57], v7 offset:8256
    ds_read_b64_tr_b16 a[58:59], v7 offset:11328
    v_mfma_f32_16x16x32_bf16 v[104:107], a[116:119], a[232:235], v[104:107]
    buffer_load_dwordx4 v8, s[40:43], s53 offen sc1 lds
    v_mfma_f32_16x16x32_bf16 v[112:115], a[120:123], a[232:235], v[112:115]
    ds_read_b64_tr_b16 a[60:61], v11 offset:8256
    ds_read_b64_tr_b16 a[62:63], v11 offset:11328
    v_mfma_f32_16x16x32_bf16 v[120:123], a[124:127], a[232:235], v[120:123]
    s_add_u32 m0, s45, 0
    v_mfma_f32_16x16x32_bf16 v[128:131], a[128:131], a[232:235], v[128:131]
    ds_read_b64_tr_b16 a[64:65], v7 offset:8320
    ds_read_b64_tr_b16 a[66:67], v7 offset:11392
    v_mfma_f32_16x16x32_bf16 v[136:139], a[132:135], a[232:235], v[136:139]
    s_add_u32 s50, s44, 393216
    v_mfma_f32_16x16x32_bf16 v[144:147], a[136:139], a[232:235], v[144:147]
    ds_read_b64_tr_b16 a[68:69], v11 offset:8320
    ds_read_b64_tr_b16 a[70:71], v11 offset:11392
    v_mfma_f32_16x16x32_bf16 v[152:155], a[140:143], a[232:235], v[152:155]
    buffer_load_dwordx4 v63, s[24:27], s50 offen lds
    v_mfma_f32_16x16x32_bf16 v[68:71], a[96:99], a[236:239], v[68:71]
    ds_read_b64_tr_b16 a[72:73], v7 offset:14336
    ds_read_b64_tr_b16 a[74:75], v7 offset:17408
    v_mfma_f32_16x16x32_bf16 v[76:79], a[100:103], a[236:239], v[76:79]
    s_add_u32 m0, s45, 4096
    v_mfma_f32_16x16x32_bf16 v[84:87], a[104:107], a[236:239], v[84:87]
    ds_read_b64_tr_b16 a[76:77], v11 offset:14336
    ds_read_b64_tr_b16 a[78:79], v11 offset:17408
    v_mfma_f32_16x16x32_bf16 v[92:95], a[108:111], a[236:239], v[92:95]
    s_add_u32 s50, s44, 425984
    v_mfma_f32_16x16x32_bf16 v[100:103], a[112:115], a[236:239], v[100:103]
    ds_read_b64_tr_b16 a[80:81], v7 offset:14400
    ds_read_b64_tr_b16 a[82:83], v7 offset:17472
    v_mfma_f32_16x16x32_bf16 v[108:111], a[116:119], a[236:239], v[108:111]
    buffer_load_dwordx4 v63, s[24:27], s50 offen lds
    v_mfma_f32_16x16x32_bf16 v[116:119], a[120:123], a[236:239], v[116:119]
    ds_read_b64_tr_b16 a[84:85], v11 offset:14400
    ds_read_b64_tr_b16 a[86:87], v11 offset:17472
    v_mfma_f32_16x16x32_bf16 v[124:127], a[124:127], a[236:239], v[124:127]
    s_add_u32 m0, s45, 8192
    v_mfma_f32_16x16x32_bf16 v[132:135], a[128:131], a[236:239], v[132:135]
    ds_read_b64_tr_b16 a[88:89], v7 offset:14464
    ds_read_b64_tr_b16 a[90:91], v7 offset:17536
    v_mfma_f32_16x16x32_bf16 v[140:143], a[132:135], a[236:239], v[140:143]
    s_add_u32 s50, s44, 458752
    v_mfma_f32_16x16x32_bf16 v[148:151], a[136:139], a[236:239], v[148:151]
    ds_read_b64_tr_b16 a[92:93], v11 offset:14464
    ds_read_b64_tr_b16 a[94:95], v11 offset:17536
    v_mfma_f32_16x16x32_bf16 v[156:159], a[140:143], a[236:239], v[156:159]
    buffer_load_dwordx4 v63, s[24:27], s50 offen lds
    s_waitcnt vmcnt(30)
    s_waitcnt lgkmcnt(15)
    v_mfma_f32_16x16x32_bf16 v[64:67], a[0:3], v[160:163], v[64:67]
    ds_read_b64_tr_b16 a[96:97], v7 offset:20480
    ds_read_b64_tr_b16 a[98:99], v7 offset:23552
    v_mfma_f32_16x16x32_bf16 v[72:75], a[4:7], v[160:163], v[72:75]
    ds_read_b64_tr_b16 a[100:101], v11 offset:20480
    v_mfma_f32_16x16x32_bf16 v[80:83], a[8:11], v[160:163], v[80:83]
    s_add_u32 m0, s45, 12288
    ds_read_b64_tr_b16 a[102:103], v11 offset:23552
    v_mfma_f32_16x16x32_bf16 v[88:91], a[12:15], v[160:163], v[88:91]
    ds_read_b64_tr_b16 a[104:105], v7 offset:20544
    v_mfma_f32_16x16x32_bf16 v[96:99], a[16:19], v[160:163], v[96:99]
    ds_read_b64_tr_b16 a[106:107], v7 offset:23616
    v_mfma_f32_16x16x32_bf16 v[104:107], a[20:23], v[160:163], v[104:107]
    s_add_u32 s50, s44, 491520
    ds_read_b64_tr_b16 a[108:109], v11 offset:20544
    v_mfma_f32_16x16x32_bf16 v[112:115], a[24:27], v[160:163], v[112:115]
    ds_read_b64_tr_b16 a[110:111], v11 offset:23616
    v_mfma_f32_16x16x32_bf16 v[120:123], a[28:31], v[160:163], v[120:123]
    buffer_load_dwordx4 v63, s[24:27], s50 offen lds
    v_mfma_f32_16x16x32_bf16 v[128:131], a[32:35], v[160:163], v[128:131]
    ds_read_b64_tr_b16 a[112:113], v7 offset:20608
    ds_read_b64_tr_b16 a[114:115], v7 offset:23680
    v_mfma_f32_16x16x32_bf16 v[136:139], a[36:39], v[160:163], v[136:139]
    ds_read_b64_tr_b16 a[116:117], v11 offset:20608
    v_mfma_f32_16x16x32_bf16 v[144:147], a[40:43], v[160:163], v[144:147]
    s_add_u32 m0, s45, 16384
    ds_read_b64_tr_b16 a[118:119], v11 offset:23680
    v_mfma_f32_16x16x32_bf16 v[152:155], a[44:47], v[160:163], v[152:155]
    ds_read_b64_tr_b16 a[120:121], v7 offset:26624
    v_mfma_f32_16x16x32_bf16 v[68:71], a[0:3], v[164:167], v[68:71]
    ds_read_b64_tr_b16 a[122:123], v7 offset:29696
    v_mfma_f32_16x16x32_bf16 v[76:79], a[4:7], v[164:167], v[76:79]
    s_add_u32 s50, s44, 524288
    ds_read_b64_tr_b16 a[124:125], v11 offset:26624
    v_mfma_f32_16x16x32_bf16 v[84:87], a[8:11], v[164:167], v[84:87]
    ds_read_b64_tr_b16 a[126:127], v11 offset:29696
    v_mfma_f32_16x16x32_bf16 v[92:95], a[12:15], v[164:167], v[92:95]
    buffer_load_dwordx4 v63, s[24:27], s50 offen lds
    v_mfma_f32_16x16x32_bf16 v[100:103], a[16:19], v[164:167], v[100:103]
    ds_read_b64_tr_b16 a[128:129], v7 offset:26688
    ds_read_b64_tr_b16 a[130:131], v7 offset:29760
    v_mfma_f32_16x16x32_bf16 v[108:111], a[20:23], v[164:167], v[108:111]
    ds_read_b64_tr_b16 a[132:133], v11 offset:26688
    v_mfma_f32_16x16x32_bf16 v[116:119], a[24:27], v[164:167], v[116:119]
    s_add_u32 m0, s45, 20480
    ds_read_b64_tr_b16 a[134:135], v11 offset:29760
    v_mfma_f32_16x16x32_bf16 v[124:127], a[28:31], v[164:167], v[124:127]
    ds_read_b64_tr_b16 a[136:137], v7 offset:26752
    v_mfma_f32_16x16x32_bf16 v[132:135], a[32:35], v[164:167], v[132:135]
    ds_read_b64_tr_b16 a[138:139], v7 offset:29824
    v_mfma_f32_16x16x32_bf16 v[140:143], a[36:39], v[164:167], v[140:143]
    s_add_u32 s50, s44, 557056
    ds_read_b64_tr_b16 a[140:141], v11 offset:26752
    v_mfma_f32_16x16x32_bf16 v[148:151], a[40:43], v[164:167], v[148:151]
    ds_read_b64_tr_b16 a[142:143], v11 offset:29824
    v_mfma_f32_16x16x32_bf16 v[156:159], a[44:47], v[164:167], v[156:159]
    buffer_load_dwordx4 v63, s[24:27], s50 offen lds
    s_waitcnt vmcnt(28)
    s_waitcnt lgkmcnt(15)
    v_mfma_f32_16x16x32_bf16 v[64:67], a[48:51], v[168:171], v[64:67]
    ds_read_b64_tr_b16 a[0:1], v7 offset:32768
    ds_read_b64_tr_b16 a[2:3], v7 offset:35840
    v_mfma_f32_16x16x32_bf16 v[72:75], a[52:55], v[168:171], v[72:75]
    ds_read_b64_tr_b16 a[4:5], v11 offset:32768
    v_mfma_f32_16x16x32_bf16 v[80:83], a[56:59], v[168:171], v[80:83]
    s_add_u32 m0, s45, 24576
    ds_read_b64_tr_b16 a[6:7], v11 offset:35840
    v_mfma_f32_16x16x32_bf16 v[88:91], a[60:63], v[168:171], v[88:91]
    ds_read_b64_tr_b16 a[8:9], v7 offset:32832
    v_mfma_f32_16x16x32_bf16 v[96:99], a[64:67], v[168:171], v[96:99]
    ds_read_b64_tr_b16 a[10:11], v7 offset:35904
    v_mfma_f32_16x16x32_bf16 v[104:107], a[68:71], v[168:171], v[104:107]
    s_add_u32 s50, s44, 589824
    ds_read_b64_tr_b16 a[12:13], v11 offset:32832
    v_mfma_f32_16x16x32_bf16 v[112:115], a[72:75], v[168:171], v[112:115]
    ds_read_b64_tr_b16 a[14:15], v11 offset:35904
    v_mfma_f32_16x16x32_bf16 v[120:123], a[76:79], v[168:171], v[120:123]
    buffer_load_dwordx4 v63, s[24:27], s50 offen lds
    v_mfma_f32_16x16x32_bf16 v[128:131], a[80:83], v[168:171], v[128:131]
    ds_read_b64_tr_b16 a[16:17], v7 offset:32896
    ds_read_b64_tr_b16 a[18:19], v7 offset:35968
    v_mfma_f32_16x16x32_bf16 v[136:139], a[84:87], v[168:171], v[136:139]
    ds_read_b64_tr_b16 a[20:21], v11 offset:32896
    v_mfma_f32_16x16x32_bf16 v[144:147], a[88:91], v[168:171], v[144:147]
    s_add_u32 m0, s45, 28672
    ds_read_b64_tr_b16 a[22:23], v11 offset:35968
    v_mfma_f32_16x16x32_bf16 v[152:155], a[92:95], v[168:171], v[152:155]
    ds_read_b64_tr_b16 a[24:25], v7 offset:38912
    v_mfma_f32_16x16x32_bf16 v[68:71], a[48:51], v[172:175], v[68:71]
    ds_read_b64_tr_b16 a[26:27], v7 offset:41984
    v_mfma_f32_16x16x32_bf16 v[76:79], a[52:55], v[172:175], v[76:79]
    s_add_u32 s50, s44, 622592
    ds_read_b64_tr_b16 a[28:29], v11 offset:38912
    v_mfma_f32_16x16x32_bf16 v[84:87], a[56:59], v[172:175], v[84:87]
    ds_read_b64_tr_b16 a[30:31], v11 offset:41984
    v_mfma_f32_16x16x32_bf16 v[92:95], a[60:63], v[172:175], v[92:95]
    buffer_load_dwordx4 v63, s[24:27], s50 offen lds
    v_mfma_f32_16x16x32_bf16 v[100:103], a[64:67], v[172:175], v[100:103]
    ds_read_b64_tr_b16 a[32:33], v7 offset:38976
    ds_read_b64_tr_b16 a[34:35], v7 offset:42048
    v_mfma_f32_16x16x32_bf16 v[108:111], a[68:71], v[172:175], v[108:111]
    ds_read_b64_tr_b16 a[36:37], v11 offset:38976
    v_mfma_f32_16x16x32_bf16 v[116:119], a[72:75], v[172:175], v[116:119]
    s_add_u32 m0, s45, 32768
    ds_read_b64_tr_b16 a[38:39], v11 offset:42048
    v_mfma_f32_16x16x32_bf16 v[124:127], a[76:79], v[172:175], v[124:127]
    ds_read_b64_tr_b16 a[40:41], v7 offset:39040
    v_mfma_f32_16x16x32_bf16 v[132:135], a[80:83], v[172:175], v[132:135]
    ds_read_b64_tr_b16 a[42:43], v7 offset:42112
    v_mfma_f32_16x16x32_bf16 v[140:143], a[84:87], v[172:175], v[140:143]
    s_add_u32 s50, s44, 655360
    ds_read_b64_tr_b16 a[44:45], v11 offset:39040
    v_mfma_f32_16x16x32_bf16 v[148:151], a[88:91], v[172:175], v[148:151]
    ds_read_b64_tr_b16 a[46:47], v11 offset:42112
    v_mfma_f32_16x16x32_bf16 v[156:159], a[92:95], v[172:175], v[156:159]
    buffer_load_dwordx4 v63, s[24:27], s50 offen lds
    s_waitcnt vmcnt(9)
    s_waitcnt lgkmcnt(15)
    s_barrier
    s_waitcnt vmcnt(25)
    s_waitcnt lgkmcnt(15)
    v_mfma_f32_16x16x32_bf16 v[64:67], a[96:99], v[176:179], v[64:67]
    s_add_u32 m0, s45, 36864
    s_add_u32 s50, s44, 688128
    v_mfma_f32_16x16x32_bf16 v[72:75], a[100:103], v[176:179], v[72:75]
    buffer_load_dwordx4 v63, s[24:27], s50 offen lds
    s_add_u32 m0, s45, 40960
    v_mfma_f32_16x16x32_bf16 v[80:83], a[104:107], v[176:179], v[80:83]
    s_add_u32 s50, s44, 720896
    v_mfma_f32_16x16x32_bf16 v[88:91], a[108:111], v[176:179], v[88:91]
    buffer_load_dwordx4 v63, s[24:27], s50 offen lds
    s_add_u32 m0, s45, 45056
    v_mfma_f32_16x16x32_bf16 v[96:99], a[112:115], v[176:179], v[96:99]
    s_add_u32 s50, s44, 753664
    buffer_load_dwordx4 v63, s[24:27], s50 offen lds
    v_mfma_f32_16x16x32_bf16 v[104:107], a[116:119], v[176:179], v[104:107]
    s_add_u32 m0, s45, 49152
    v_mfma_f32_16x16x32_bf16 v[112:115], a[120:123], v[176:179], v[112:115]
    s_add_u32 s50, s44, 786432
    buffer_load_dwordx4 v63, s[24:27], s50 offen lds
    v_mfma_f32_16x16x32_bf16 v[120:123], a[124:127], v[176:179], v[120:123]
    s_add_u32 m0, s45, 53248
    v_mfma_f32_16x16x32_bf16 v[128:131], a[128:131], v[176:179], v[128:131]
    s_add_u32 s50, s44, 819200
    buffer_load_dwordx4 v63, s[24:27], s50 offen lds
    v_mfma_f32_16x16x32_bf16 v[136:139], a[132:135], v[176:179], v[136:139]
    s_add_u32 m0, s45, 57344
    s_add_u32 s50, s44, 851968
    v_mfma_f32_16x16x32_bf16 v[144:147], a[136:139], v[176:179], v[144:147]
    buffer_load_dwordx4 v63, s[24:27], s50 offen lds
    v_mfma_f32_16x16x32_bf16 v[152:155], a[140:143], v[176:179], v[152:155]
    s_add_u32 m0, s45, 61440
    s_add_u32 s50, s44, 884736
    v_mfma_f32_16x16x32_bf16 v[68:71], a[96:99], v[180:183], v[68:71]
    buffer_load_dwordx4 v63, s[24:27], s50 offen lds
    s_add_u32 m0, s45, 65536
    v_mfma_f32_16x16x32_bf16 v[76:79], a[100:103], v[180:183], v[76:79]
    s_add_u32 s50, s44, 917504
    v_mfma_f32_16x16x32_bf16 v[84:87], a[104:107], v[180:183], v[84:87]
    buffer_load_dwordx4 v63, s[24:27], s50 offen lds
    s_add_u32 m0, s45, 69632
    v_mfma_f32_16x16x32_bf16 v[92:95], a[108:111], v[180:183], v[92:95]
    s_add_u32 s50, s44, 950272
    v_mfma_f32_16x16x32_bf16 v[100:103], a[112:115], v[180:183], v[100:103]
    buffer_load_dwordx4 v63, s[24:27], s50 offen lds
    ds_read_b128 v[192:195], v48 offset:0
    v_mfma_f32_16x16x32_bf16 v[108:111], a[116:119], v[180:183], v[108:111]
    ds_read_b128 v[196:199], v48 offset:64
    ds_read_b128 v[200:203], v48 offset:128
    v_mfma_f32_16x16x32_bf16 v[116:119], a[120:123], v[180:183], v[116:119]
    ds_read_b128 v[204:207], v48 offset:192
    v_mfma_f32_16x16x32_bf16 v[124:127], a[124:127], v[180:183], v[124:127]
    ds_read_b128 v[208:211], v48 offset:256
    ds_read_b128 v[212:215], v48 offset:320
    v_mfma_f32_16x16x32_bf16 v[132:135], a[128:131], v[180:183], v[132:135]
    ds_read_b128 v[216:219], v48 offset:384
    ds_read_b128 v[220:223], v48 offset:448
    v_mfma_f32_16x16x32_bf16 v[140:143], a[132:135], v[180:183], v[140:143]
    ds_read_b128 v[224:227], v48 offset:512
    v_mfma_f32_16x16x32_bf16 v[148:151], a[136:139], v[180:183], v[148:151]
    ds_read_b128 v[228:231], v48 offset:576
    ds_read_b128 v[232:235], v48 offset:640
    v_mfma_f32_16x16x32_bf16 v[156:159], a[140:143], v[180:183], v[156:159]
    ds_read_b128 v[236:239], v48 offset:704
    s_waitcnt vmcnt(29)
    s_waitcnt lgkmcnt(12)
    v_mfma_f32_16x16x32_bf16 v[64:67], a[0:3], v[184:187], v[64:67]
    s_add_u32 m0, s45, 73728
    s_add_u32 s50, s44, 983040
    v_mfma_f32_16x16x32_bf16 v[72:75], a[4:7], v[184:187], v[72:75]
    buffer_load_dwordx4 v63, s[24:27], s50 offen lds
    v_mfma_f32_16x16x32_bf16 v[80:83], a[8:11], v[184:187], v[80:83]
    s_add_u32 m0, s45, 77824
    v_mfma_f32_16x16x32_bf16 v[88:91], a[12:15], v[184:187], v[88:91]
    s_add_u32 s50, s44, 1015808
    v_mfma_f32_16x16x32_bf16 v[96:99], a[16:19], v[184:187], v[96:99]
    buffer_load_dwordx4 v63, s[24:27], s50 offen lds
    s_add_u32 m0, s45, 81920
    v_mfma_f32_16x16x32_bf16 v[104:107], a[20:23], v[184:187], v[104:107]
    s_add_u32 s50, s44, 1048576
    v_mfma_f32_16x16x32_bf16 v[112:115], a[24:27], v[184:187], v[112:115]
    buffer_load_dwordx4 v63, s[24:27], s50 offen lds
    v_mfma_f32_16x16x32_bf16 v[120:123], a[28:31], v[184:187], v[120:123]
    s_add_u32 m0, s45, 86016
    v_mfma_f32_16x16x32_bf16 v[128:131], a[32:35], v[184:187], v[128:131]
    s_add_u32 s50, s44, 1081344
    buffer_load_dwordx4 v63, s[24:27], s50 offen lds
    v_mfma_f32_16x16x32_bf16 v[136:139], a[36:39], v[184:187], v[136:139]
    s_add_u32 m0, s45, 90112
    v_mfma_f32_16x16x32_bf16 v[144:147], a[40:43], v[184:187], v[144:147]
    s_add_u32 s50, s44, 1114112
    v_mfma_f32_16x16x32_bf16 v[152:155], a[44:47], v[184:187], v[152:155]
    buffer_load_dwordx4 v63, s[24:27], s50 offen lds
    v_mfma_f32_16x16x32_bf16 v[68:71], a[0:3], v[188:191], v[68:71]
    s_add_u32 m0, s45, 94208
    s_add_u32 s50, s44, 1146880
    v_mfma_f32_16x16x32_bf16 v[76:79], a[4:7], v[188:191], v[76:79]
    buffer_load_dwordx4 v63, s[24:27], s50 offen lds
    v_mfma_f32_16x16x32_bf16 v[84:87], a[8:11], v[188:191], v[84:87]
    ds_read_b128 v[240:243], v48 offset:768
    v_mfma_f32_16x16x32_bf16 v[92:95], a[12:15], v[188:191], v[92:95]
    ds_read_b128 v[244:247], v48 offset:832
    v_mfma_f32_16x16x32_bf16 v[100:103], a[16:19], v[188:191], v[100:103]
    ds_read_b128 v[248:251], v48 offset:896
    ds_read_b128 v[252:255], v48 offset:960
    v_mfma_f32_16x16x32_bf16 v[108:111], a[20:23], v[188:191], v[108:111]
    ds_read_b128 v[16:19], v48 offset:1024
    v_mfma_f32_16x16x32_bf16 v[116:119], a[24:27], v[188:191], v[116:119]
    ds_read_b128 v[20:23], v48 offset:1088
    v_mfma_f32_16x16x32_bf16 v[124:127], a[28:31], v[188:191], v[124:127]
    ds_read_b128 v[24:27], v48 offset:1152
    v_mfma_f32_16x16x32_bf16 v[132:135], a[32:35], v[188:191], v[132:135]
    ds_read_b128 v[28:31], v48 offset:1216
    ds_read_b128 v[32:35], v48 offset:1280
    v_mfma_f32_16x16x32_bf16 v[140:143], a[36:39], v[188:191], v[140:143]
    ds_read_b128 v[36:39], v48 offset:1344
    v_mfma_f32_16x16x32_bf16 v[148:151], a[40:43], v[188:191], v[148:151]
    ds_read_b128 v[40:43], v48 offset:1408
    v_mfma_f32_16x16x32_bf16 v[156:159], a[44:47], v[188:191], v[156:159]
    ds_read_b128 v[44:47], v48 offset:1472
    s_barrier
    s_mov_b32 s60, 0xbdd2d3e8
    s_mov_b32 s61, 0xc0135761
    s_mov_b32 s62, 0xc0135761
    s_mov_b32 s63, 0xc0135761
    s_waitcnt lgkmcnt(0)
    s_nop 3
    s_lshr_b32 s57, s54, 4
    s_mul_i32 s57, s57, 43
    s_mul_i32 s58, s32, 3
    s_add_u32 s57, s57, s58
    s_lshl_b32 s57, s57, 10
    s_add_u32 s57, s57, 9437184
    s_add_u32 s58, s57, 43*1024
    v_pk_fma_f32 v[160:161], v[192:193], v[54:55], v[196:197] op_sel_hi:[1,0,1]
    v_pk_fma_f32 v[162:163], v[194:195], v[54:55], v[198:199] op_sel_hi:[1,0,1]
    v_pk_fma_f32 v[64:65], v[64:65], v[50:51], v[160:161] op_sel_hi:[1,0,1]
    v_pk_fma_f32 v[66:67], v[66:67], v[50:51], v[162:163] op_sel_hi:[1,0,1]
    v_pk_fma_f32 v[164:165], v[192:193], v[56:57], v[196:197] op_sel_hi:[1,0,1]
    v_pk_fma_f32 v[166:167], v[194:195], v[56:57], v[198:199] op_sel_hi:[1,0,1]
    v_pk_fma_f32 v[68:69], v[68:69], v[52:53], v[164:165] op_sel_hi:[1,0,1]
    v_pk_fma_f32 v[70:71], v[70:71], v[52:53], v[166:167] op_sel_hi:[1,0,1]
    s_add_u32 m0, s45, 98304
    s_add_u32 s50, s44, 1179648
    buffer_load_dwordx4 v63, s[24:27], s50 offen lds
    v_pk_fma_f32 v[168:169], v[200:201], v[54:55], v[204:205] op_sel_hi:[1,0,1]
    v_pk_fma_f32 v[170:171], v[202:203], v[54:55], v[206:207] op_sel_hi:[1,0,1]
    v_pk_fma_f32 v[72:73], v[72:73], v[50:51], v[168:169] op_sel_hi:[1,0,1]
    v_pk_fma_f32 v[74:75], v[74:75], v[50:51], v[170:171] op_sel_hi:[1,0,1]
    v_pk_fma_f32 v[172:173], v[200:201], v[56:57], v[204:205] op_sel_hi:[1,0,1]
    v_pk_fma_f32 v[174:175], v[202:203], v[56:57], v[206:207] op_sel_hi:[1,0,1]
    v_pk_fma_f32 v[76:77], v[76:77], v[52:53], v[172:173] op_sel_hi:[1,0,1]
    v_pk_fma_f32 v[78:79], v[78:79], v[52:53], v[174:175] op_sel_hi:[1,0,1]
    s_add_u32 m0, s45, 102400
    s_add_u32 s50, s44, 1212416
    buffer_load_dwordx4 v63, s[24:27], s50 offen lds
    v_pk_fma_f32 v[160:161], v[240:241], v[54:55], v[244:245] op_sel_hi:[1,0,1]
    v_pk_fma_f32 v[162:163], v[242:243], v[54:55], v[246:247] op_sel_hi:[1,0,1]
    v_pk_fma_f32 v[112:113], v[112:113], v[50:51], v[160:161] op_sel_hi:[1,0,1]
    v_pk_fma_f32 v[114:115], v[114:115], v[50:51], v[162:163] op_sel_hi:[1,0,1]
    v_pk_fma_f32 v[164:165], v[240:241], v[56:57], v[244:245] op_sel_hi:[1,0,1]
    v_pk_fma_f32 v[166:167], v[242:243], v[56:57], v[246:247] op_sel_hi:[1,0,1]
    v_pk_fma_f32 v[116:117], v[116:117], v[52:53], v[164:165] op_sel_hi:[1,0,1]
    v_pk_fma_f32 v[118:119], v[118:119], v[52:53], v[166:167] op_sel_hi:[1,0,1]
    s_add_u32 m0, s45, 106496
    s_add_u32 s50, s44, 1245184
    buffer_load_dwordx4 v63, s[24:27], s50 offen lds
    v_pk_fma_f32 v[168:169], v[248:249], v[54:55], v[252:253] op_sel_hi:[1,0,1]
    v_pk_fma_f32 v[170:171], v[250:251], v[54:55], v[254:255] op_sel_hi:[1,0,1]
    v_pk_fma_f32 v[120:121], v[120:121], v[50:51], v[168:169] op_sel_hi:[1,0,1]
    v_pk_fma_f32 v[122:123], v[122:123], v[50:51], v[170:171] op_sel_hi:[1,0,1]
    v_pk_fma_f32 v[172:173], v[248:249], v[56:57], v[252:253] op_sel_hi:[1,0,1]
    v_pk_fma_f32 v[174:175], v[250:251], v[56:57], v[254:255] op_sel_hi:[1,0,1]
    v_pk_fma_f32 v[124:125], v[124:125], v[52:53], v[172:173] op_sel_hi:[1,0,1]
    v_pk_fma_f32 v[126:127], v[126:127], v[52:53], v[174:175] op_sel_hi:[1,0,1]
    v_pk_mul_f32 v[176:177], v[64:65], v[64:65]
    v_pk_mul_f32 v[178:179], v[66:67], v[66:67]
    v_pk_mul_f32 v[180:181], v[68:69], v[68:69]
    v_pk_mul_f32 v[182:183], v[70:71], v[70:71]
    v_pk_mul_f32 v[184:185], v[72:73], v[72:73]
    v_pk_mul_f32 v[186:187], v[74:75], v[74:75]
    v_pk_mul_f32 v[188:189], v[76:77], v[76:77]
    v_pk_mul_f32 v[190:191], v[78:79], v[78:79]
    v_pk_fma_f32 v[176:177], v[176:177], s[60:61], s[60:61] op_sel:[0,0,1] op_sel_hi:[1,0,1]
    v_pk_fma_f32 v[178:179], v[178:179], s[60:61], s[60:61] op_sel:[0,0,1] op_sel_hi:[1,0,1]
    v_pk_fma_f32 v[180:181], v[180:181], s[60:61], s[60:61] op_sel:[0,0,1] op_sel_hi:[1,0,1]
    v_pk_fma_f32 v[182:183], v[182:183], s[60:61], s[60:61] op_sel:[0,0,1] op_sel_hi:[1,0,1]
    v_pk_fma_f32 v[184:185], v[184:185], s[60:61], s[60:61] op_sel:[0,0,1] op_sel_hi:[1,0,1]
    v_pk_fma_f32 v[186:187], v[186:187], s[60:61], s[60:61] op_sel:[0,0,1] op_sel_hi:[1,0,1]
    v_pk_fma_f32 v[188:189], v[188:189], s[60:61], s[60:61] op_sel:[0,0,1] op_sel_hi:[1,0,1]
    v_pk_fma_f32 v[190:191], v[190:191], s[60:61], s[60:61] op_sel:[0,0,1] op_sel_hi:[1,0,1]
    v_pk_mul_f32 v[176:177], v[176:177], v[64:65]
    v_pk_mul_f32 v[178:179], v[178:179], v[66:67]
    v_pk_mul_f32 v[180:181], v[180:181], v[68:69]
    v_pk_mul_f32 v[182:183], v[182:183], v[70:71]
    v_pk_mul_f32 v[184:185], v[184:185], v[72:73]
    v_pk_mul_f32 v[186:187], v[186:187], v[74:75]
    v_pk_mul_f32 v[188:189], v[188:189], v[76:77]
    v_pk_mul_f32 v[190:191], v[190:191], v[78:79]
    v_exp_f32 v176, v176
    v_exp_f32 v177, v177
    v_pk_mul_f32 v[112:113], v[112:113], v[64:65]
    v_exp_f32 v178, v178
    v_exp_f32 v179, v179
    v_pk_mul_f32 v[114:115], v[114:115], v[66:67]
    v_exp_f32 v180, v180
    v_exp_f32 v181, v181
    v_pk_mul_f32 v[116:117], v[116:117], v[68:69]
    v_exp_f32 v182, v182
    v_exp_f32 v183, v183
    v_pk_mul_f32 v[118:119], v[118:119], v[70:71]
    v_exp_f32 v184, v184
    v_exp_f32 v185, v185
    v_pk_mul_f32 v[120:121], v[120:121], v[72:73]
    v_exp_f32 v186, v186
    v_exp_f32 v187, v187
    v_pk_mul_f32 v[122:123], v[122:123], v[74:75]
    v_exp_f32 v188, v188
    v_exp_f32 v189, v189
    v_pk_mul_f32 v[124:125], v[124:125], v[76:77]
    v_exp_f32 v190, v190
    v_exp_f32 v191, v191
    v_pk_mul_f32 v[126:127], v[126:127], v[78:79]
    v_pk_add_f32 v[176:177], v[176:177], 1.0 op_sel_hi:[1,0]
    v_pk_add_f32 v[178:179], v[178:179], 1.0 op_sel_hi:[1,0]
    v_pk_add_f32 v[180:181], v[180:181], 1.0 op_sel_hi:[1,0]
    v_pk_add_f32 v[182:183], v[182:183], 1.0 op_sel_hi:[1,0]
    v_pk_add_f32 v[184:185], v[184:185], 1.0 op_sel_hi:[1,0]
    v_pk_add_f32 v[186:187], v[186:187], 1.0 op_sel_hi:[1,0]
    v_pk_add_f32 v[188:189], v[188:189], 1.0 op_sel_hi:[1,0]
    v_pk_add_f32 v[190:191], v[190:191], 1.0 op_sel_hi:[1,0]
    v_rcp_f32 v176, v176
    v_rcp_f32 v177, v177
    v_rcp_f32 v178, v178
    v_rcp_f32 v179, v179
    v_rcp_f32 v180, v180
    v_rcp_f32 v181, v181
    v_rcp_f32 v182, v182
    v_rcp_f32 v183, v183
    v_rcp_f32 v184, v184
    v_rcp_f32 v185, v185
    v_rcp_f32 v186, v186
    v_rcp_f32 v187, v187
    v_rcp_f32 v188, v188
    v_rcp_f32 v189, v189
    v_rcp_f32 v190, v190
    v_rcp_f32 v191, v191
    v_pk_mul_f32 v[176:177], v[176:177], v[112:113]
    v_pk_mul_f32 v[178:179], v[178:179], v[114:115]
    v_pk_mul_f32 v[180:181], v[180:181], v[116:117]
    v_pk_mul_f32 v[182:183], v[182:183], v[118:119]
    v_pk_mul_f32 v[184:185], v[184:185], v[120:121]
    v_pk_mul_f32 v[186:187], v[186:187], v[122:123]
    v_pk_mul_f32 v[188:189], v[188:189], v[124:125]
    v_pk_mul_f32 v[190:191], v[190:191], v[126:127]
    v_cvt_pk_bf16_f32 v64, v176, v177
    v_cvt_pk_bf16_f32 v65, v178, v179
    v_cvt_pk_bf16_f32 v66, v184, v185
    v_cvt_pk_bf16_f32 v67, v186, v187
    v_cvt_pk_bf16_f32 v68, v180, v181
    v_cvt_pk_bf16_f32 v69, v182, v183
    v_cvt_pk_bf16_f32 v70, v188, v189
    v_cvt_pk_bf16_f32 v71, v190, v191
    buffer_store_dwordx4 v[64:67], v8, s[40:43], s57 offen offset:0 sc1
    buffer_store_dwordx4 v[68:71], v8, s[40:43], s58 offen offset:0 sc1
    s_cmp_eq_u32 s32, 14
    s_cbranch_scc1 P3_ST
    v_pk_fma_f32 v[160:161], v[208:209], v[54:55], v[212:213] op_sel_hi:[1,0,1]
    v_pk_fma_f32 v[162:163], v[210:211], v[54:55], v[214:215] op_sel_hi:[1,0,1]
    v_pk_fma_f32 v[80:81], v[80:81], v[50:51], v[160:161] op_sel_hi:[1,0,1]
PG160:
    s_cbranch_execz PG176
    v_pk_fma_f32 v[82:83], v[82:83], v[50:51], v[162:163] op_sel_hi:[1,0,1]
    v_pk_fma_f32 v[164:165], v[208:209], v[56:57], v[212:213] op_sel_hi:[1,0,1]
    v_pk_fma_f32 v[166:167], v[210:211], v[56:57], v[214:215] op_sel_hi:[1,0,1]
    v_pk_fma_f32 v[84:85], v[84:85], v[52:53], v[164:165] op_sel_hi:[1,0,1]
    v_pk_fma_f32 v[86:87], v[86:87], v[52:53], v[166:167] op_sel_hi:[1,0,1]
    v_pk_fma_f32 v[168:169], v[216:217], v[54:55], v[220:221] op_sel_hi:[1,0,1]
    v_pk_fma_f32 v[170:171], v[218:219], v[54:55], v[222:223] op_sel_hi:[1,0,1]
    v_pk_fma_f32 v[88:89], v[88:89], v[50:51], v[168:169] op_sel_hi:[1,0,1]
    v_pk_fma_f32 v[90:91], v[90:91], v[50:51], v[170:171] op_sel_hi:[1,0,1]
    v_pk_fma_f32 v[172:173], v[216:217], v[56:57], v[220:221] op_sel_hi:[1,0,1]
    v_pk_fma_f32 v[174:175], v[218:219], v[56:57], v[222:223] op_sel_hi:[1,0,1]
    v_pk_fma_f32 v[92:93], v[92:93], v[52:53], v[172:173] op_sel_hi:[1,0,1]
    v_pk_fma_f32 v[94:95], v[94:95], v[52:53], v[174:175] op_sel_hi:[1,0,1]
    v_pk_fma_f32 v[160:161], v[16:17], v[54:55], v[20:21] op_sel_hi:[1,0,1]
    v_pk_fma_f32 v[162:163], v[18:19], v[54:55], v[22:23] op_sel_hi:[1,0,1]
    v_pk_fma_f32 v[128:129], v[128:129], v[50:51], v[160:161] op_sel_hi:[1,0,1]
    v_pk_fma_f32 v[130:131], v[130:131], v[50:51], v[162:163] op_sel_hi:[1,0,1]
    v_pk_fma_f32 v[164:165], v[16:17], v[56:57], v[20:21] op_sel_hi:[1,0,1]
    v_pk_fma_f32 v[166:167], v[18:19], v[56:57], v[22:23] op_sel_hi:[1,0,1]
    v_pk_fma_f32 v[132:133], v[132:133], v[52:53], v[164:165] op_sel_hi:[1,0,1]
    v_pk_fma_f32 v[134:135], v[134:135], v[52:53], v[166:167] op_sel_hi:[1,0,1]
    v_pk_fma_f32 v[168:169], v[24:25], v[54:55], v[28:29] op_sel_hi:[1,0,1]
    v_pk_fma_f32 v[170:171], v[26:27], v[54:55], v[30:31] op_sel_hi:[1,0,1]
    v_pk_fma_f32 v[136:137], v[136:137], v[50:51], v[168:169] op_sel_hi:[1,0,1]
    v_pk_fma_f32 v[138:139], v[138:139], v[50:51], v[170:171] op_sel_hi:[1,0,1]
    v_pk_fma_f32 v[172:173], v[24:25], v[56:57], v[28:29] op_sel_hi:[1,0,1]
    v_pk_fma_f32 v[174:175], v[26:27], v[56:57], v[30:31] op_sel_hi:[1,0,1]
    v_pk_fma_f32 v[140:141], v[140:141], v[52:53], v[172:173] op_sel_hi:[1,0,1]
    v_pk_fma_f32 v[142:143], v[142:143], v[52:53], v[174:175] op_sel_hi:[1,0,1]
    v_pk_mul_f32 v[176:177], v[80:81], v[80:81]
    v_pk_mul_f32 v[178:179], v[82:83], v[82:83]
    v_pk_mul_f32 v[180:181], v[84:85], v[84:85]
    v_pk_mul_f32 v[182:183], v[86:87], v[86:87]
    v_pk_mul_f32 v[184:185], v[88:89], v[88:89]
    v_pk_mul_f32 v[186:187], v[90:91], v[90:91]
    v_pk_mul_f32 v[188:189], v[92:93], v[92:93]
    v_pk_mul_f32 v[190:191], v[94:95], v[94:95]
    v_pk_fma_f32 v[176:177], v[176:177], s[60:61], s[60:61] op_sel:[0,0,1] op_sel_hi:[1,0,1]
    v_pk_fma_f32 v[178:179], v[178:179], s[60:61], s[60:61] op_sel:[0,0,1] op_sel_hi:[1,0,1]
    v_pk_fma_f32 v[180:181], v[180:181], s[60:61], s[60:61] op_sel:[0,0,1] op_sel_hi:[1,0,1]
    v_pk_fma_f32 v[182:183], v[182:183], s[60:61], s[60:61] op_sel:[0,0,1] op_sel_hi:[1,0,1]
    v_pk_fma_f32 v[184:185], v[184:185], s[60:61], s[60:61] op_sel:[0,0,1] op_sel_hi:[1,0,1]
    v_pk_fma_f32 v[186:187], v[186:187], s[60:61], s[60:61] op_sel:[0,0,1] op_sel_hi:[1,0,1]
    v_pk_fma_f32 v[188:189], v[188:189], s[60:61], s[60:61] op_sel:[0,0,1] op_sel_hi:[1,0,1]
    v_pk_fma_f32 v[190:191], v[190:191], s[60:61], s[60:61] op_sel:[0,0,1] op_sel_hi:[1,0,1]
    v_pk_mul_f32 v[176:177], v[176:177], v[80:81]
    v_pk_mul_f32 v[178:179], v[178:179], v[82:83]
    v_pk_mul_f32 v[180:181], v[180:181], v[84:85]
    v_pk_mul_f32 v[182:183], v[182:183], v[86:87]
    v_pk_mul_f32 v[184:185], v[184:185], v[88:89]
    v_pk_mul_f32 v[186:187], v[186:187], v[90:91]
    v_pk_mul_f32 v[188:189], v[188:189], v[92:93]
    v_pk_mul_f32 v[190:191], v[190:191], v[94:95]
    v_exp_f32 v176, v176
    v_exp_f32 v177, v177
    v_pk_mul_f32 v[128:129], v[128:129], v[80:81]
    v_exp_f32 v178, v178
    v_exp_f32 v179, v179
    v_pk_mul_f32 v[130:131], v[130:131], v[82:83]
    v_exp_f32 v180, v180
    v_exp_f32 v181, v181
    v_pk_mul_f32 v[132:133], v[132:133], v[84:85]
    v_exp_f32 v182, v182
    v_exp_f32 v183, v183
    v_pk_mul_f32 v[134:135], v[134:135], v[86:87]
    v_exp_f32 v184, v184
    v_exp_f32 v185, v185
    v_pk_mul_f32 v[136:137], v[136:137], v[88:89]
    v_exp_f32 v186, v186
    v_exp_f32 v187, v187
    v_pk_mul_f32 v[138:139], v[138:139], v[90:91]
    v_exp_f32 v188, v188
    v_exp_f32 v189, v189
    v_pk_mul_f32 v[140:141], v[140:141], v[92:93]
    v_exp_f32 v190, v190
    v_exp_f32 v191, v191
    v_pk_mul_f32 v[142:143], v[142:143], v[94:95]
    v_pk_add_f32 v[176:177], v[176:177], 1.0 op_sel_hi:[1,0]
    v_pk_add_f32 v[178:179], v[178:179], 1.0 op_sel_hi:[1,0]
    v_pk_add_f32 v[180:181], v[180:181], 1.0 op_sel_hi:[1,0]
    v_pk_add_f32 v[182:183], v[182:183], 1.0 op_sel_hi:[1,0]
    v_pk_add_f32 v[184:185], v[184:185], 1.0 op_sel_hi:[1,0]
    v_pk_add_f32 v[186:187], v[186:187], 1.0 op_sel_hi:[1,0]
    v_pk_add_f32 v[188:189], v[188:189], 1.0 op_sel_hi:[1,0]
    v_pk_add_f32 v[190:191], v[190:191], 1.0 op_sel_hi:[1,0]
    v_rcp_f32 v176, v176
    v_rcp_f32 v177, v177
    v_rcp_f32 v178, v178
    v_rcp_f32 v179, v179
    v_rcp_f32 v180, v180
    v_rcp_f32 v181, v181
    v_rcp_f32 v182, v182
    v_rcp_f32 v183, v183
    v_rcp_f32 v184, v184
    v_rcp_f32 v185, v185
    v_rcp_f32 v186, v186
    v_rcp_f32 v187, v187
    v_rcp_f32 v188, v188
    v_rcp_f32 v189, v189
    v_rcp_f32 v190, v190
    v_rcp_f32 v191, v191
    v_pk_mul_f32 v[176:177], v[176:177], v[128:129]
    v_pk_mul_f32 v[178:179], v[178:179], v[130:131]
    v_pk_mul_f32 v[180:181], v[180:181], v[132:133]
    v_pk_mul_f32 v[182:183], v[182:183], v[134:135]
    v_pk_mul_f32 v[184:185], v[184:185], v[136:137]
    v_pk_mul_f32 v[186:187], v[186:187], v[138:139]
    v_pk_mul_f32 v[188:189], v[188:189], v[140:141]
    v_pk_mul_f32 v[190:191], v[190:191], v[142:143]
    v_cvt_pk_bf16_f32 v80, v176, v177
    v_cvt_pk_bf16_f32 v81, v178, v179
    v_cvt_pk_bf16_f32 v82, v184, v185
    v_cvt_pk_bf16_f32 v83, v186, v187
    v_cvt_pk_bf16_f32 v84, v180, v181
    v_cvt_pk_bf16_f32 v85, v182, v183
    v_cvt_pk_bf16_f32 v86, v188, v189
    v_cvt_pk_bf16_f32 v87, v190, v191
    buffer_store_dwordx4 v[80:83], v8, s[40:43], s57 offen offset:1024 sc1
    buffer_store_dwordx4 v[84:87], v8, s[40:43], s58 offen offset:1024 sc1
    v_pk_fma_f32 v[160:161], v[224:225], v[54:55], v[228:229] op_sel_hi:[1,0,1]
    v_pk_fma_f32 v[162:163], v[226:227], v[54:55], v[230:231] op_sel_hi:[1,0,1]
    v_pk_fma_f32 v[96:97], v[96:97], v[50:51], v[160:161] op_sel_hi:[1,0,1]
    v_pk_fma_f32 v[98:99], v[98:99], v[50:51], v[162:163] op_sel_hi:[1,0,1]
    v_pk_fma_f32 v[164:165], v[224:225], v[56:57], v[228:229] op_sel_hi:[1,0,1]
    v_pk_fma_f32 v[166:167], v[226:227], v[56:57], v[230:231] op_sel_hi:[1,0,1]
    v_pk_fma_f32 v[100:101], v[100:101], v[52:53], v[164:165] op_sel_hi:[1,0,1]
    v_pk_fma_f32 v[102:103], v[102:103], v[52:53], v[166:167] op_sel_hi:[1,0,1]
    v_pk_fma_f32 v[168:169], v[232:233], v[54:55], v[236:237] op_sel_hi:[1,0,1]
    v_pk_fma_f32 v[170:171], v[234:235], v[54:55], v[238:239] op_sel_hi:[1,0,1]
    v_pk_fma_f32 v[104:105], v[104:105], v[50:51], v[168:169] op_sel_hi:[1,0,1]
    v_pk_fma_f32 v[106:107], v[106:107], v[50:51], v[170:171] op_sel_hi:[1,0,1]
    v_pk_fma_f32 v[172:173], v[232:233], v[56:57], v[236:237] op_sel_hi:[1,0,1]
    v_pk_fma_f32 v[174:175], v[234:235], v[56:57], v[238:239] op_sel_hi:[1,0,1]
    v_pk_fma_f32 v[108:109], v[108:109], v[52:53], v[172:173] op_sel_hi:[1,0,1]
    v_pk_fma_f32 v[110:111], v[110:111], v[52:53], v[174:175] op_sel_hi:[1,0,1]
    v_pk_fma_f32 v[160:161], v[32:33], v[54:55], v[36:37] op_sel_hi:[1,0,1]
    v_pk_fma_f32 v[162:163], v[34:35], v[54:55], v[38:39] op_sel_hi:[1,0,1]
    v_pk_fma_f32 v[144:145], v[144:145], v[50:51], v[160:161] op_sel_hi:[1,0,1]
    v_pk_fma_f32 v[146:147], v[146:147], v[50:51], v[162:163] op_sel_hi:[1,0,1]
    v_pk_fma_f32 v[164:165], v[32:33], v[56:57], v[36:37] op_sel_hi:[1,0,1]
    v_pk_fma_f32 v[166:167], v[34:35], v[56:57], v[38:39] op_sel_hi:[1,0,1]
    v_pk_fma_f32 v[148:149], v[148:149], v[52:53], v[164:165] op_sel_hi:[1,0,1]
    v_pk_fma_f32 v[150:151], v[150:151], v[52:53], v[166:167] op_sel_hi:[1,0,1]
    v_pk_fma_f32 v[168:169], v[40:41], v[54:55], v[44:45] op_sel_hi:[1,0,1]
    v_pk_fma_f32 v[170:171], v[42:43], v[54:55], v[46:47] op_sel_hi:[1,0,1]
    v_pk_fma_f32 v[152:153], v[152:153], v[50:51], v[168:169] op_sel_hi:[1,0,1]
    v_pk_fma_f32 v[154:155], v[154:155], v[50:51], v[170:171] op_sel_hi:[1,0,1]
    v_pk_fma_f32 v[172:173], v[40:41], v[56:57], v[44:45] op_sel_hi:[1,0,1]
    v_pk_fma_f32 v[174:175], v[42:43], v[56:57], v[46:47] op_sel_hi:[1,0,1]
    v_pk_fma_f32 v[156:157], v[156:157], v[52:53], v[172:173] op_sel_hi:[1,0,1]
    v_pk_fma_f32 v[158:159], v[158:159], v[52:53], v[174:175] op_sel_hi:[1,0,1]
    v_pk_mul_f32 v[176:177], v[96:97], v[96:97]
    v_pk_mul_f32 v[178:179], v[98:99], v[98:99]
    v_pk_mul_f32 v[180:181], v[100:101], v[100:101]
    v_pk_mul_f32 v[182:183], v[102:103], v[102:103]
    v_pk_mul_f32 v[184:185], v[104:105], v[104:105]
    v_pk_mul_f32 v[186:187], v[106:107], v[106:107]
    v_pk_mul_f32 v[188:189], v[108:109], v[108:109]
    v_pk_mul_f32 v[190:191], v[110:111], v[110:111]
    v_pk_fma_f32 v[176:177], v[176:177], s[60:61], s[60:61] op_sel:[0,0,1] op_sel_hi:[1,0,1]
    v_pk_fma_f32 v[178:179], v[178:179], s[60:61], s[60:61] op_sel:[0,0,1] op_sel_hi:[1,0,1]
    v_pk_fma_f32 v[180:181], v[180:181], s[60:61], s[60:61] op_sel:[0,0,1] op_sel_hi:[1,0,1]
    v_pk_fma_f32 v[182:183], v[182:183], s[60:61], s[60:61] op_sel:[0,0,1] op_sel_hi:[1,0,1]
    v_pk_fma_f32 v[184:185], v[184:185], s[60:61], s[60:61] op_sel:[0,0,1] op_sel_hi:[1,0,1]
    v_pk_fma_f32 v[186:187], v[186:187], s[60:61], s[60:61] op_sel:[0,0,1] op_sel_hi:[1,0,1]
    v_pk_fma_f32 v[188:189], v[188:189], s[60:61], s[60:61] op_sel:[0,0,1] op_sel_hi:[1,0,1]
    v_pk_fma_f32 v[190:191], v[190:191], s[60:61], s[60:61] op_sel:[0,0,1] op_sel_hi:[1,0,1]
    v_pk_mul_f32 v[176:177], v[176:177], v[96:97]
    v_pk_mul_f32 v[178:179], v[178:179], v[98:99]
    v_pk_mul_f32 v[180:181], v[180:181], v[100:101]
    v_pk_mul_f32 v[182:183], v[182:183], v[102:103]
    v_pk_mul_f32 v[184:185], v[184:185], v[104:105]
    v_pk_mul_f32 v[186:187], v[186:187], v[106:107]
    v_pk_mul_f32 v[188:189], v[188:189], v[108:109]
    v_pk_mul_f32 v[190:191], v[190:191], v[110:111]
    v_exp_f32 v176, v176
    v_exp_f32 v177, v177
    v_pk_mul_f32 v[144:145], v[144:145], v[96:97]
    v_exp_f32 v178, v178
    v_exp_f32 v179, v179
    v_pk_mul_f32 v[146:147], v[146:147], v[98:99]
    v_exp_f32 v180, v180
    v_exp_f32 v181, v181
    v_pk_mul_f32 v[148:149], v[148:149], v[100:101]
    v_exp_f32 v182, v182
    v_exp_f32 v183, v183
    v_pk_mul_f32 v[150:151], v[150:151], v[102:103]
    v_exp_f32 v184, v184
    v_exp_f32 v185, v185
    v_pk_mul_f32 v[152:153], v[152:153], v[104:105]
    v_exp_f32 v186, v186
    v_exp_f32 v187, v187
    v_pk_mul_f32 v[154:155], v[154:155], v[106:107]
    v_exp_f32 v188, v188
    v_exp_f32 v189, v189
    v_pk_mul_f32 v[156:157], v[156:157], v[108:109]
    v_exp_f32 v190, v190
    v_exp_f32 v191, v191
    v_pk_mul_f32 v[158:159], v[158:159], v[110:111]
    v_pk_add_f32 v[176:177], v[176:177], 1.0 op_sel_hi:[1,0]
    v_pk_add_f32 v[178:179], v[178:179], 1.0 op_sel_hi:[1,0]
    v_pk_add_f32 v[180:181], v[180:181], 1.0 op_sel_hi:[1,0]
    v_pk_add_f32 v[182:183], v[182:183], 1.0 op_sel_hi:[1,0]
    v_pk_add_f32 v[184:185], v[184:185], 1.0 op_sel_hi:[1,0]
    v_pk_add_f32 v[186:187], v[186:187], 1.0 op_sel_hi:[1,0]
    v_pk_add_f32 v[188:189], v[188:189], 1.0 op_sel_hi:[1,0]
    v_pk_add_f32 v[190:191], v[190:191], 1.0 op_sel_hi:[1,0]
    v_rcp_f32 v176, v176
    v_rcp_f32 v177, v177
    v_rcp_f32 v178, v178
    v_rcp_f32 v179, v179
    v_rcp_f32 v180, v180
    v_rcp_f32 v181, v181
    v_rcp_f32 v182, v182
    v_rcp_f32 v183, v183
    v_rcp_f32 v184, v184
    v_rcp_f32 v185, v185
    v_rcp_f32 v186, v186
    v_rcp_f32 v187, v187
    v_rcp_f32 v188, v188
    v_rcp_f32 v189, v189
    v_rcp_f32 v190, v190
    v_rcp_f32 v191, v191
    v_pk_mul_f32 v[176:177], v[176:177], v[144:145]
    v_pk_mul_f32 v[178:179], v[178:179], v[146:147]
    v_pk_mul_f32 v[180:181], v[180:181], v[148:149]
    v_pk_mul_f32 v[182:183], v[182:183], v[150:151]
    v_pk_mul_f32 v[184:185], v[184:185], v[152:153]
    v_pk_mul_f32 v[186:187], v[186:187], v[154:155]
    v_pk_mul_f32 v[188:189], v[188:189], v[156:157]
    v_pk_mul_f32 v[190:191], v[190:191], v[158:159]
    v_cvt_pk_bf16_f32 v96, v176, v177
    v_cvt_pk_bf16_f32 v97, v178, v179
    v_cvt_pk_bf16_f32 v98, v184, v185
    v_cvt_pk_bf16_f32 v99, v186, v187
    v_cvt_pk_bf16_f32 v100, v180, v181
    v_cvt_pk_bf16_f32 v101, v182, v183
    v_cvt_pk_bf16_f32 v102, v188, v189
    v_cvt_pk_bf16_f32 v103, v190, v191
    buffer_store_dwordx4 v[96:99], v8, s[40:43], s57 offen offset:2048 sc1
    buffer_store_dwordx4 v[100:103], v8, s[40:43], s58 offen offset:2048 sc1
P3_ST:
    s_waitcnt vmcnt(0)
    s_barrier
    s_cmp_lg_u32 s3, 0
    s_cbranch_scc1 P3_END
    v_mov_b32 v13, 1
    v_mov_b32 v12, 0
    s_lshl_b32 s48, s33, 8
    s_lshl_b32 s49, s32, 4
    s_add_u32 s49, s49, s48
    s_add_u32 s49, s49, 434176
    s_mov_b64 exec, 1
    buffer_store_dword v13, v12, s[40:43], s49 offen sc1
    s_mov_b64 exec, -1
P3_END:
    s_load_dwordx2 s[8:9], s[0:1], 80
    s_lshl_b32 s54, s6, 6
    s_lshl_b32 s55, s3, 4
    s_add_u32 s54, s54, s55
    s_lshr_b32 s55, s54, 4
    s_mul_i32 s55, s55, 43*1024
    s_add_u32 s55, s55, 9437184
    v_lshlrev_b32 v12, 9, v2
    v_lshl_add_u32 v12, v3, 7, v12
    v_lshl_add_u32 v12, v4, 3, v12
    v_and_b32 v13, 1, v2
    v_xor_b32 v13, v13, v3
    v_lshl_add_u32 v6, v13, 5, v12
    v_xor_b32 v7, 32, v6
    v_xor_b32 v10, 64, v6
    v_xor_b32 v11, 96, v6
    v_add_u32 v32, 0x10000, v6
    v_add_u32 v33, 0x20000, v6
    v_add_u32 v34, 0x10000, v7
    v_add_u32 v35, 0x20000, v7
    v_add_u32 v36, 0x10000, v10
    v_add_u32 v37, 0x20000, v10
    v_add_u32 v38, 0x10000, v11
    v_add_u32 v39, 0x20000, v11
    s_waitcnt lgkmcnt(0)
    s_mov_b32 s12, s8
    s_mov_b32 s13, s9
    s_and_b32 s13, s13, 0xffff
    s_mov_b32 s14, 0x200000
    s_mov_b32 s15, 0x00020000
    s_lshr_b32 s48, s6, 1
    s_lshl_b32 s48, s48, 8
    s_add_u32 s48, s48, 434176
    s_cmp_lg_u32 s3, 0
    s_cbranch_scc1 G4_W
    s_mov_b64 exec, 32767
    s_mov_b32 s49, 0
G4_P:
    buffer_load_dword v13, v8, s[40:43], s48 offen sc1
    s_add_u32 s49, s49, 1
    s_cmp_gt_u32 s49, 400000
    s_cbranch_scc1 G4_W
    s_waitcnt vmcnt(0)
    v_cmp_ne_u32 vcc, 1, v13
    s_cbranch_vccz G4_W
    s_sleep 3
    s_branch G4_P
G4_W:
    s_mov_b64 exec, -1
    s_waitcnt vmcnt(0)
    s_barrier
    s_add_u32 s58, s55, 0
    buffer_load_dwordx4 v[64:67], v8, s[40:43], s58 offen offset:0
    buffer_load_dwordx4 v[68:71], v8, s[40:43], s58 offen offset:1024
    buffer_load_dwordx4 v[72:75], v8, s[40:43], s58 offen offset:2048
    buffer_load_dwordx4 v[76:79], v8, s[40:43], s58 offen offset:3072
    s_add_u32 s58, s55, 4096
    buffer_load_dwordx4 v[80:83], v8, s[40:43], s58 offen offset:0
    buffer_load_dwordx4 v[84:87], v8, s[40:43], s58 offen offset:1024
    buffer_load_dwordx4 v[88:91], v8, s[40:43], s58 offen offset:2048
    buffer_load_dwordx4 v[92:95], v8, s[40:43], s58 offen offset:3072
    s_add_u32 s58, s55, 8192
    buffer_load_dwordx4 v[96:99], v8, s[40:43], s58 offen offset:0
    buffer_load_dwordx4 v[100:103], v8, s[40:43], s58 offen offset:1024
    buffer_load_dwordx4 v[104:107], v8, s[40:43], s58 offen offset:2048
    buffer_load_dwordx4 v[108:111], v8, s[40:43], s58 offen offset:3072
    s_add_u32 s58, s55, 12288
    buffer_load_dwordx4 v[112:115], v8, s[40:43], s58 offen offset:0
    buffer_load_dwordx4 v[116:119], v8, s[40:43], s58 offen offset:1024
    ds_read_b64_tr_b16 a[0:1], v32 offset:45056
    ds_read_b64_tr_b16 a[2:3], v32 offset:47104
    ds_read_b64_tr_b16 a[4:5], v34 offset:45056
    ds_read_b64_tr_b16 a[6:7], v34 offset:47104
    ds_read_b64_tr_b16 a[8:9], v36 offset:45056
    ds_read_b64_tr_b16 a[10:11], v36 offset:47104
    ds_read_b64_tr_b16 a[12:13], v38 offset:45056
    ds_read_b64_tr_b16 a[14:15], v38 offset:47104
    ds_read_b64_tr_b16 a[16:17], v32 offset:49152
    ds_read_b64_tr_b16 a[18:19], v32 offset:51200
    ds_read_b64_tr_b16 a[20:21], v34 offset:49152
    ds_read_b64_tr_b16 a[22:23], v34 offset:51200
    ds_read_b64_tr_b16 a[24:25], v36 offset:49152
    ds_read_b64_tr_b16 a[26:27], v36 offset:51200
    ds_read_b64_tr_b16 a[28:29], v38 offset:49152
    ds_read_b64_tr_b16 a[30:31], v38 offset:51200
    s_waitcnt vmcnt(13)
    s_waitcnt lgkmcnt(8)
    v_mfma_f32_16x16x32_bf16 v[16:19], a[0:3], v[64:67], 0
    buffer_load_dwordx4 v[120:123], v8, s[40:43], s58 offen offset:2048
    ds_read_b64_tr_b16 a[32:33], v32 offset:53248
    ds_read_b64_tr_b16 a[34:35], v32 offset:55296
    v_mfma_f32_16x16x32_bf16 v[20:23], a[4:7], v[64:67], 0
    ds_read_b64_tr_b16 a[36:37], v34 offset:53248
    ds_read_b64_tr_b16 a[38:39], v34 offset:55296
    v_mfma_f32_16x16x32_bf16 v[24:27], a[8:11], v[64:67], 0
    ds_read_b64_tr_b16 a[40:41], v36 offset:53248
    ds_read_b64_tr_b16 a[42:43], v36 offset:55296
    v_mfma_f32_16x16x32_bf16 v[28:31], a[12:15], v[64:67], 0
    ds_read_b64_tr_b16 a[44:45], v38 offset:53248
    ds_read_b64_tr_b16 a[46:47], v38 offset:55296
    s_waitcnt vmcnt(13)
    s_waitcnt lgkmcnt(8)
    v_mfma_f32_16x16x32_bf16 v[16:19], a[16:19], v[68:71], v[16:19]
    buffer_load_dwordx4 v[124:127], v8, s[40:43], s58 offen offset:3072
    ds_read_b64_tr_b16 a[0:1], v32 offset:57344
    ds_read_b64_tr_b16 a[2:3], v32 offset:59392
    v_mfma_f32_16x16x32_bf16 v[20:23], a[20:23], v[68:71], v[20:23]
    ds_read_b64_tr_b16 a[4:5], v34 offset:57344
    ds_read_b64_tr_b16 a[6:7], v34 offset:59392
    v_mfma_f32_16x16x32_bf16 v[24:27], a[24:27], v[68:71], v[24:27]
    ds_read_b64_tr_b16 a[8:9], v36 offset:57344
    ds_read_b64_tr_b16 a[10:11], v36 offset:59392
    v_mfma_f32_16x16x32_bf16 v[28:31], a[28:31], v[68:71], v[28:31]
    ds_read_b64_tr_b16 a[12:13], v38 offset:57344
    ds_read_b64_tr_b16 a[14:15], v38 offset:59392
    s_waitcnt vmcnt(13)
    s_waitcnt lgkmcnt(8)
    v_mfma_f32_16x16x32_bf16 v[16:19], a[32:35], v[72:75], v[16:19]
    s_add_u32 s58, s55, 16384
    buffer_load_dwordx4 v[128:131], v8, s[40:43], s58 offen offset:0
    ds_read_b64_tr_b16 a[16:17], v32 offset:61440
    v_mfma_f32_16x16x32_bf16 v[20:23], a[36:39], v[72:75], v[20:23]
    ds_read_b64_tr_b16 a[18:19], v32 offset:63488
    ds_read_b64_tr_b16 a[20:21], v34 offset:61440
    v_mfma_f32_16x16x32_bf16 v[24:27], a[40:43], v[72:75], v[24:27]
    ds_read_b64_tr_b16 a[22:23], v34 offset:63488
    ds_read_b64_tr_b16 a[24:25], v36 offset:61440
    ds_read_b64_tr_b16 a[26:27], v36 offset:63488
    v_mfma_f32_16x16x32_bf16 v[28:31], a[44:47], v[72:75], v[28:31]
    ds_read_b64_tr_b16 a[28:29], v38 offset:61440
    ds_read_b64_tr_b16 a[30:31], v38 offset:63488
    s_waitcnt vmcnt(13)
    s_waitcnt lgkmcnt(8)
    v_mfma_f32_16x16x32_bf16 v[16:19], a[0:3], v[76:79], v[16:19]
    buffer_load_dwordx4 v[132:135], v8, s[40:43], s58 offen offset:1024
    ds_read_b64_tr_b16 a[32:33], v33 offset:0
    ds_read_b64_tr_b16 a[34:35], v33 offset:2048
    v_mfma_f32_16x16x32_bf16 v[20:23], a[4:7], v[76:79], v[20:23]
    ds_read_b64_tr_b16 a[36:37], v35 offset:0
    ds_read_b64_tr_b16 a[38:39], v35 offset:2048
    v_mfma_f32_16x16x32_bf16 v[24:27], a[8:11], v[76:79], v[24:27]
    ds_read_b64_tr_b16 a[40:41], v37 offset:0
    ds_read_b64_tr_b16 a[42:43], v37 offset:2048
    v_mfma_f32_16x16x32_bf16 v[28:31], a[12:15], v[76:79], v[28:31]
    ds_read_b64_tr_b16 a[44:45], v39 offset:0
    ds_read_b64_tr_b16 a[46:47], v39 offset:2048
    s_barrier
    s_waitcnt vmcnt(13)
    s_waitcnt lgkmcnt(8)
    v_mfma_f32_16x16x32_bf16 v[16:19], a[16:19], v[80:83], v[16:19]
    buffer_load_dwordx4 v[136:139], v8, s[40:43], s58 offen offset:2048
    ds_read_b64_tr_b16 a[0:1], v33 offset:4096
    ds_read_b64_tr_b16 a[2:3], v33 offset:6144
    ds_read_b64_tr_b16 a[4:5], v35 offset:4096
    ds_read_b64_tr_b16 a[6:7], v35 offset:6144
    ds_read_b64_tr_b16 a[8:9], v37 offset:4096
    v_mfma_f32_16x16x32_bf16 v[20:23], a[20:23], v[80:83], v[20:23]
    ds_read_b64_tr_b16 a[10:11], v37 offset:6144
    ds_read_b64_tr_b16 a[12:13], v39 offset:4096
    ds_read_b64_tr_b16 a[14:15], v39 offset:6144
    s_add_u32 m0, s45, 110592
    s_add_u32 s50, s44, 1277952
    v_mfma_f32_16x16x32_bf16 v[24:27], a[24:27], v[80:83], v[24:27]
    buffer_load_dwordx4 v63, s[24:27], s50 offen lds
    s_add_u32 m0, s45, 114688
    s_add_u32 s50, s44, 1310720
    buffer_load_dwordx4 v63, s[24:27], s50 offen lds
    s_add_u32 m0, s45, 118784
    v_mfma_f32_16x16x32_bf16 v[28:31], a[28:31], v[80:83], v[28:31]
    s_add_u32 s50, s44, 1343488
    buffer_load_dwordx4 v63, s[24:27], s50 offen lds
    s_add_u32 m0, s45, 122880
    s_add_u32 s50, s44, 1376256
    buffer_load_dwordx4 v63, s[24:27], s50 offen lds
    s_waitcnt vmcnt(17)
    s_waitcnt lgkmcnt(8)
    v_mfma_f32_16x16x32_bf16 v[16:19], a[32:35], v[84:87], v[16:19]
    buffer_load_dwordx4 v[140:143], v8, s[40:43], s58 offen offset:3072
    ds_read_b64_tr_b16 a[16:17], v33 offset:8192
    ds_read_b64_tr_b16 a[18:19], v33 offset:10240
    v_mfma_f32_16x16x32_bf16 v[20:23], a[36:39], v[84:87], v[20:23]
    ds_read_b64_tr_b16 a[20:21], v35 offset:8192
    ds_read_b64_tr_b16 a[22:23], v35 offset:10240
    v_mfma_f32_16x16x32_bf16 v[24:27], a[40:43], v[84:87], v[24:27]
    ds_read_b64_tr_b16 a[24:25], v37 offset:8192
    ds_read_b64_tr_b16 a[26:27], v37 offset:10240
    v_mfma_f32_16x16x32_bf16 v[28:31], a[44:47], v[84:87], v[28:31]
    ds_read_b64_tr_b16 a[28:29], v39 offset:8192
    ds_read_b64_tr_b16 a[30:31], v39 offset:10240
    s_waitcnt vmcnt(17)
    s_waitcnt lgkmcnt(8)
    v_mfma_f32_16x16x32_bf16 v[16:19], a[0:3], v[88:91], v[16:19]
    s_add_u32 s58, s55, 20480
    buffer_load_dwordx4 v[144:147], v8, s[40:43], s58 offen offset:0
    ds_read_b64_tr_b16 a[32:33], v33 offset:12288
    v_mfma_f32_16x16x32_bf16 v[20:23], a[4:7], v[88:91], v[20:23]
    ds_read_b64_tr_b16 a[34:35], v33 offset:14336
    ds_read_b64_tr_b16 a[36:37], v35 offset:12288
    v_mfma_f32_16x16x32_bf16 v[24:27], a[8:11], v[88:91], v[24:27]
    ds_read_b64_tr_b16 a[38:39], v35 offset:14336
    ds_read_b64_tr_b16 a[40:41], v37 offset:12288
    ds_read_b64_tr_b16 a[42:43], v37 offset:14336
    v_mfma_f32_16x16x32_bf16 v[28:31], a[12:15], v[88:91], v[28:31]
    ds_read_b64_tr_b16 a[44:45], v39 offset:12288
    ds_read_b64_tr_b16 a[46:47], v39 offset:14336
    s_waitcnt vmcnt(17)
    s_waitcnt lgkmcnt(8)
    v_mfma_f32_16x16x32_bf16 v[16:19], a[16:19], v[92:95], v[16:19]
    buffer_load_dwordx4 v[148:151], v8, s[40:43], s58 offen offset:1024
    ds_read_b64_tr_b16 a[0:1], v33 offset:16384
    ds_read_b64_tr_b16 a[2:3], v33 offset:18432
    v_mfma_f32_16x16x32_bf16 v[20:23], a[20:23], v[92:95], v[20:23]
    ds_read_b64_tr_b16 a[4:5], v35 offset:16384
    ds_read_b64_tr_b16 a[6:7], v35 offset:18432
    v_mfma_f32_16x16x32_bf16 v[24:27], a[24:27], v[92:95], v[24:27]
    ds_read_b64_tr_b16 a[8:9], v37 offset:16384
    ds_read_b64_tr_b16 a[10:11], v37 offset:18432
    v_mfma_f32_16x16x32_bf16 v[28:31], a[28:31], v[92:95], v[28:31]
    ds_read_b64_tr_b16 a[12:13], v39 offset:16384
    ds_read_b64_tr_b16 a[14:15], v39 offset:18432
    s_waitcnt vmcnt(17)
    s_waitcnt lgkmcnt(8)
    v_mfma_f32_16x16x32_bf16 v[16:19], a[32:35], v[96:99], v[16:19]
    buffer_load_dwordx4 v[152:155], v8, s[40:43], s58 offen offset:2048
    ds_read_b64_tr_b16 a[16:17], v33 offset:20480
    ds_read_b64_tr_b16 a[18:19], v33 offset:22528
    v_mfma_f32_16x16x32_bf16 v[20:23], a[36:39], v[96:99], v[20:23]
    ds_read_b64_tr_b16 a[20:21], v35 offset:20480
    ds_read_b64_tr_b16 a[22:23], v35 offset:22528
    v_mfma_f32_16x16x32_bf16 v[24:27], a[40:43], v[96:99], v[24:27]
    ds_read_b64_tr_b16 a[24:25], v37 offset:20480
    ds_read_b64_tr_b16 a[26:27], v37 offset:22528
    v_mfma_f32_16x16x32_bf16 v[28:31], a[44:47], v[96:99], v[28:31]
    ds_read_b64_tr_b16 a[28:29], v39 offset:20480
    ds_read_b64_tr_b16 a[30:31], v39 offset:22528
    s_waitcnt vmcnt(17)
    s_waitcnt lgkmcnt(8)
    v_mfma_f32_16x16x32_bf16 v[16:19], a[0:3], v[100:103], v[16:19]
    buffer_load_dwordx4 v[156:159], v8, s[40:43], s58 offen offset:3072
    ds_read_b64_tr_b16 a[32:33], v33 offset:24576
    ds_read_b64_tr_b16 a[34:35], v33 offset:26624
    v_mfma_f32_16x16x32_bf16 v[20:23], a[4:7], v[100:103], v[20:23]
    ds_read_b64_tr_b16 a[36:37], v35 offset:24576
    ds_read_b64_tr_b16 a[38:39], v35 offset:26624
    v_mfma_f32_16x16x32_bf16 v[24:27], a[8:11], v[100:103], v[24:27]
    ds_read_b64_tr_b16 a[40:41], v37 offset:24576
    ds_read_b64_tr_b16 a[42:43], v37 offset:26624
    v_mfma_f32_16x16x32_bf16 v[28:31], a[12:15], v[100:103], v[28:31]
    ds_read_b64_tr_b16 a[44:45], v39 offset:24576
    ds_read_b64_tr_b16 a[46:47], v39 offset:26624
    s_waitcnt vmcnt(17)
    s_waitcnt lgkmcnt(8)
    v_mfma_f32_16x16x32_bf16 v[16:19], a[16:19], v[104:107], v[16:19]
    s_add_u32 s58, s55, 24576
    buffer_load_dwordx4 v[160:163], v8, s[40:43], s58 offen offset:0
    ds_read_b64_tr_b16 a[0:1], v6 offset:0
    v_mfma_f32_16x16x32_bf16 v[20:23], a[20:23], v[104:107], v[20:23]
    ds_read_b64_tr_b16 a[2:3], v6 offset:2048
    ds_read_b64_tr_b16 a[4:5], v7 offset:0
    v_mfma_f32_16x16x32_bf16 v[24:27], a[24:27], v[104:107], v[24:27]
    ds_read_b64_tr_b16 a[6:7], v7 offset:2048
    ds_read_b64_tr_b16 a[8:9], v10 offset:0
    ds_read_b64_tr_b16 a[10:11], v10 offset:2048
    v_mfma_f32_16x16x32_bf16 v[28:31], a[28:31], v[104:107], v[28:31]
    ds_read_b64_tr_b16 a[12:13], v11 offset:0
    ds_read_b64_tr_b16 a[14:15], v11 offset:2048
    s_waitcnt vmcnt(17)
    s_waitcnt lgkmcnt(8)
    v_mfma_f32_16x16x32_bf16 v[16:19], a[32:35], v[108:111], v[16:19]
    buffer_load_dwordx4 v[164:167], v8, s[40:43], s58 offen offset:1024
    ds_read_b64_tr_b16 a[16:17], v6 offset:4096
    ds_read_b64_tr_b16 a[18:19], v6 offset:6144
    v_mfma_f32_16x16x32_bf16 v[20:23], a[36:39], v[108:111], v[20:23]
    ds_read_b64_tr_b16 a[20:21], v7 offset:4096
    ds_read_b64_tr_b16 a[22:23], v7 offset:6144
    v_mfma_f32_16x16x32_bf16 v[24:27], a[40:43], v[108:111], v[24:27]
    ds_read_b64_tr_b16 a[24:25], v10 offset:4096
    ds_read_b64_tr_b16 a[26:27], v10 offset:6144
    v_mfma_f32_16x16x32_bf16 v[28:31], a[44:47], v[108:111], v[28:31]
    ds_read_b64_tr_b16 a[28:29], v11 offset:4096
    ds_read_b64_tr_b16 a[30:31], v11 offset:6144
    s_waitcnt vmcnt(17)
    s_waitcnt lgkmcnt(8)
    v_mfma_f32_16x16x32_bf16 v[16:19], a[0:3], v[112:115], v[16:19]
    buffer_load_dwordx4 v[168:171], v8, s[40:43], s58 offen offset:2048
    ds_read_b64_tr_b16 a[32:33], v6 offset:8192
    ds_read_b64_tr_b16 a[34:35], v6 offset:10240
    v_mfma_f32_16x16x32_bf16 v[20:23], a[4:7], v[112:115], v[20:23]
    ds_read_b64_tr_b16 a[36:37], v7 offset:8192
    ds_read_b64_tr_b16 a[38:39], v7 offset:10240
    v_mfma_f32_16x16x32_bf16 v[24:27], a[8:11], v[112:115], v[24:27]
    ds_read_b64_tr_b16 a[40:41], v10 offset:8192
    ds_read_b64_tr_b16 a[42:43], v10 offset:10240
    v_mfma_f32_16x16x32_bf16 v[28:31], a[12:15], v[112:115], v[28:31]
    ds_read_b64_tr_b16 a[44:45], v11 offset:8192
    ds_read_b64_tr_b16 a[46:47], v11 offset:10240
    s_waitcnt vmcnt(17)
    s_waitcnt lgkmcnt(8)
    v_mfma_f32_16x16x32_bf16 v[16:19], a[16:19], v[116:119], v[16:19]
    buffer_load_dwordx4 v[172:175], v8, s[40:43], s58 offen offset:3072
    ds_read_b64_tr_b16 a[0:1], v6 offset:12288
    ds_read_b64_tr_b16 a[2:3], v6 offset:14336
    v_mfma_f32_16x16x32_bf16 v[20:23], a[20:23], v[116:119], v[20:23]
    ds_read_b64_tr_b16 a[4:5], v7 offset:12288
    ds_read_b64_tr_b16 a[6:7], v7 offset:14336
    v_mfma_f32_16x16x32_bf16 v[24:27], a[24:27], v[116:119], v[24:27]
    ds_read_b64_tr_b16 a[8:9], v10 offset:12288
    ds_read_b64_tr_b16 a[10:11], v10 offset:14336
    v_mfma_f32_16x16x32_bf16 v[28:31], a[28:31], v[116:119], v[28:31]
    ds_read_b64_tr_b16 a[12:13], v11 offset:12288
    ds_read_b64_tr_b16 a[14:15], v11 offset:14336
    s_waitcnt vmcnt(17)
    s_waitcnt lgkmcnt(8)
    v_mfma_f32_16x16x32_bf16 v[16:19], a[32:35], v[120:123], v[16:19]
    s_add_u32 s58, s55, 28672
    buffer_load_dwordx4 v[176:179], v8, s[40:43], s58 offen offset:0
    ds_read_b64_tr_b16 a[16:17], v6 offset:16384
    v_mfma_f32_16x16x32_bf16 v[20:23], a[36:39], v[120:123], v[20:23]
    ds_read_b64_tr_b16 a[18:19], v6 offset:18432
    ds_read_b64_tr_b16 a[20:21], v7 offset:16384
    v_mfma_f32_16x16x32_bf16 v[24:27], a[40:43], v[120:123], v[24:27]
    ds_read_b64_tr_b16 a[22:23], v7 offset:18432
    ds_read_b64_tr_b16 a[24:25], v10 offset:16384
    ds_read_b64_tr_b16 a[26:27], v10 offset:18432
    v_mfma_f32_16x16x32_bf16 v[28:31], a[44:47], v[120:123], v[28:31]
    ds_read_b64_tr_b16 a[28:29], v11 offset:16384
PG176:
    s_cbranch_execz PW_S3
    ds_read_b64_tr_b16 a[30:31], v11 offset:18432
    s_waitcnt vmcnt(17)
    s_waitcnt lgkmcnt(8)
    v_mfma_f32_16x16x32_bf16 v[16:19], a[0:3], v[124:127], v[16:19]
    buffer_load_dwordx4 v[180:183], v8, s[40:43], s58 offen offset:1024
    ds_read_b64_tr_b16 a[32:33], v6 offset:20480
    ds_read_b64_tr_b16 a[34:35], v6 offset:22528
    v_mfma_f32_16x16x32_bf16 v[20:23], a[4:7], v[124:127], v[20:23]
    ds_read_b64_tr_b16 a[36:37], v7 offset:20480
    ds_read_b64_tr_b16 a[38:39], v7 offset:22528
    v_mfma_f32_16x16x32_bf16 v[24:27], a[8:11], v[124:127], v[24:27]
    ds_read_b64_tr_b16 a[40:41], v10 offset:20480
    ds_read_b64_tr_b16 a[42:43], v10 offset:22528
    v_mfma_f32_16x16x32_bf16 v[28:31], a[12:15], v[124:127], v[28:31]
    ds_read_b64_tr_b16 a[44:45], v11 offset:20480
    ds_read_b64_tr_b16 a[46:47], v11 offset:22528
    s_waitcnt vmcnt(17)
    s_waitcnt lgkmcnt(8)
    v_mfma_f32_16x16x32_bf16 v[16:19], a[16:19], v[128:131], v[16:19]
    buffer_load_dwordx4 v[184:187], v8, s[40:43], s58 offen offset:2048
    ds_read_b64_tr_b16 a[0:1], v6 offset:24576
    ds_read_b64_tr_b16 a[2:3], v6 offset:26624
    v_mfma_f32_16x16x32_bf16 v[20:23], a[20:23], v[128:131], v[20:23]
    ds_read_b64_tr_b16 a[4:5], v7 offset:24576
    ds_read_b64_tr_b16 a[6:7], v7 offset:26624
    v_mfma_f32_16x16x32_bf16 v[24:27], a[24:27], v[128:131], v[24:27]
    ds_read_b64_tr_b16 a[8:9], v10 offset:24576
    ds_read_b64_tr_b16 a[10:11], v10 offset:26624
    v_mfma_f32_16x16x32_bf16 v[28:31], a[28:31], v[128:131], v[28:31]
    ds_read_b64_tr_b16 a[12:13], v11 offset:24576
    ds_read_b64_tr_b16 a[14:15], v11 offset:26624
    s_waitcnt vmcnt(17)
    s_waitcnt lgkmcnt(8)
    v_mfma_f32_16x16x32_bf16 v[16:19], a[32:35], v[132:135], v[16:19]
    buffer_load_dwordx4 v[188:191], v8, s[40:43], s58 offen offset:3072
    ds_read_b64_tr_b16 a[16:17], v6 offset:28672
    ds_read_b64_tr_b16 a[18:19], v6 offset:30720
    v_mfma_f32_16x16x32_bf16 v[20:23], a[36:39], v[132:135], v[20:23]
    ds_read_b64_tr_b16 a[20:21], v7 offset:28672
    ds_read_b64_tr_b16 a[22:23], v7 offset:30720
    v_mfma_f32_16x16x32_bf16 v[24:27], a[40:43], v[132:135], v[24:27]
    ds_read_b64_tr_b16 a[24:25], v10 offset:28672
    ds_read_b64_tr_b16 a[26:27], v10 offset:30720
    v_mfma_f32_16x16x32_bf16 v[28:31], a[44:47], v[132:135], v[28:31]
    ds_read_b64_tr_b16 a[28:29], v11 offset:28672
    ds_read_b64_tr_b16 a[30:31], v11 offset:30720
    s_waitcnt vmcnt(17)
    s_waitcnt lgkmcnt(8)
    v_mfma_f32_16x16x32_bf16 v[16:19], a[0:3], v[136:139], v[16:19]
    s_add_u32 s58, s55, 32768
    buffer_load_dwordx4 v[192:195], v8, s[40:43], s58 offen offset:0
    ds_read_b64_tr_b16 a[32:33], v6 offset:32768
    v_mfma_f32_16x16x32_bf16 v[20:23], a[4:7], v[136:139], v[20:23]
    ds_read_b64_tr_b16 a[34:35], v6 offset:34816
    ds_read_b64_tr_b16 a[36:37], v7 offset:32768
    v_mfma_f32_16x16x32_bf16 v[24:27], a[8:11], v[136:139], v[24:27]
    ds_read_b64_tr_b16 a[38:39], v7 offset:34816
    ds_read_b64_tr_b16 a[40:41], v10 offset:32768
    ds_read_b64_tr_b16 a[42:43], v10 offset:34816
    v_mfma_f32_16x16x32_bf16 v[28:31], a[12:15], v[136:139], v[28:31]
    ds_read_b64_tr_b16 a[44:45], v11 offset:32768
    ds_read_b64_tr_b16 a[46:47], v11 offset:34816
    s_waitcnt vmcnt(13)
    s_waitcnt lgkmcnt(8)
    v_mfma_f32_16x16x32_bf16 v[16:19], a[16:19], v[140:143], v[16:19]
    buffer_load_dwordx4 v[196:199], v8, s[40:43], s58 offen offset:1024
    ds_read_b64_tr_b16 a[0:1], v6 offset:36864
    ds_read_b64_tr_b16 a[2:3], v6 offset:38912
    v_mfma_f32_16x16x32_bf16 v[20:23], a[20:23], v[140:143], v[20:23]
    ds_read_b64_tr_b16 a[4:5], v7 offset:36864
    ds_read_b64_tr_b16 a[6:7], v7 offset:38912
    v_mfma_f32_16x16x32_bf16 v[24:27], a[24:27], v[140:143], v[24:27]
    ds_read_b64_tr_b16 a[8:9], v10 offset:36864
    ds_read_b64_tr_b16 a[10:11], v10 offset:38912
    v_mfma_f32_16x16x32_bf16 v[28:31], a[28:31], v[140:143], v[28:31]
    ds_read_b64_tr_b16 a[12:13], v11 offset:36864
    ds_read_b64_tr_b16 a[14:15], v11 offset:38912
    s_waitcnt vmcnt(13)
    s_waitcnt lgkmcnt(8)
    v_mfma_f32_16x16x32_bf16 v[16:19], a[32:35], v[144:147], v[16:19]
    buffer_load_dwordx4 v[200:203], v8, s[40:43], s58 offen offset:2048
    ds_read_b64_tr_b16 a[16:17], v6 offset:40960
    ds_read_b64_tr_b16 a[18:19], v6 offset:43008
    v_mfma_f32_16x16x32_bf16 v[20:23], a[36:39], v[144:147], v[20:23]
    ds_read_b64_tr_b16 a[20:21], v7 offset:40960
    ds_read_b64_tr_b16 a[22:23], v7 offset:43008
    v_mfma_f32_16x16x32_bf16 v[24:27], a[40:43], v[144:147], v[24:27]
    ds_read_b64_tr_b16 a[24:25], v10 offset:40960
    ds_read_b64_tr_b16 a[26:27], v10 offset:43008
    v_mfma_f32_16x16x32_bf16 v[28:31], a[44:47], v[144:147], v[28:31]
    ds_read_b64_tr_b16 a[28:29], v11 offset:40960
    ds_read_b64_tr_b16 a[30:31], v11 offset:43008
    s_waitcnt vmcnt(13)
    s_waitcnt lgkmcnt(8)
    v_mfma_f32_16x16x32_bf16 v[16:19], a[0:3], v[148:151], v[16:19]
    buffer_load_dwordx4 v[204:207], v8, s[40:43], s58 offen offset:3072
    ds_read_b64_tr_b16 a[32:33], v6 offset:45056
    ds_read_b64_tr_b16 a[34:35], v6 offset:47104
    v_mfma_f32_16x16x32_bf16 v[20:23], a[4:7], v[148:151], v[20:23]
    ds_read_b64_tr_b16 a[36:37], v7 offset:45056
    ds_read_b64_tr_b16 a[38:39], v7 offset:47104
    v_mfma_f32_16x16x32_bf16 v[24:27], a[8:11], v[148:151], v[24:27]
    ds_read_b64_tr_b16 a[40:41], v10 offset:45056
    ds_read_b64_tr_b16 a[42:43], v10 offset:47104
    v_mfma_f32_16x16x32_bf16 v[28:31], a[12:15], v[148:151], v[28:31]
    ds_read_b64_tr_b16 a[44:45], v11 offset:45056
    ds_read_b64_tr_b16 a[46:47], v11 offset:47104
    s_waitcnt vmcnt(13)
    s_waitcnt lgkmcnt(8)
    v_mfma_f32_16x16x32_bf16 v[16:19], a[16:19], v[152:155], v[16:19]
    s_add_u32 s58, s55, 36864
    buffer_load_dwordx4 v[208:211], v8, s[40:43], s58 offen offset:0
    ds_read_b64_tr_b16 a[0:1], v6 offset:49152
    v_mfma_f32_16x16x32_bf16 v[20:23], a[20:23], v[152:155], v[20:23]
    ds_read_b64_tr_b16 a[2:3], v6 offset:51200
    ds_read_b64_tr_b16 a[4:5], v7 offset:49152
    v_mfma_f32_16x16x32_bf16 v[24:27], a[24:27], v[152:155], v[24:27]
    ds_read_b64_tr_b16 a[6:7], v7 offset:51200
    ds_read_b64_tr_b16 a[8:9], v10 offset:49152
    ds_read_b64_tr_b16 a[10:11], v10 offset:51200
    v_mfma_f32_16x16x32_bf16 v[28:31], a[28:31], v[152:155], v[28:31]
    ds_read_b64_tr_b16 a[12:13], v11 offset:49152
    ds_read_b64_tr_b16 a[14:15], v11 offset:51200
    s_waitcnt vmcnt(13)
    s_waitcnt lgkmcnt(8)
    v_mfma_f32_16x16x32_bf16 v[16:19], a[32:35], v[156:159], v[16:19]
    buffer_load_dwordx4 v[212:215], v8, s[40:43], s58 offen offset:1024
    ds_read_b64_tr_b16 a[16:17], v6 offset:53248
    ds_read_b64_tr_b16 a[18:19], v6 offset:55296
    v_mfma_f32_16x16x32_bf16 v[20:23], a[36:39], v[156:159], v[20:23]
    ds_read_b64_tr_b16 a[20:21], v7 offset:53248
    ds_read_b64_tr_b16 a[22:23], v7 offset:55296
    v_mfma_f32_16x16x32_bf16 v[24:27], a[40:43], v[156:159], v[24:27]
    ds_read_b64_tr_b16 a[24:25], v10 offset:53248
    ds_read_b64_tr_b16 a[26:27], v10 offset:55296
    v_mfma_f32_16x16x32_bf16 v[28:31], a[44:47], v[156:159], v[28:31]
    ds_read_b64_tr_b16 a[28:29], v11 offset:53248
    ds_read_b64_tr_b16 a[30:31], v11 offset:55296
    s_waitcnt vmcnt(13)
    s_waitcnt lgkmcnt(8)
    v_mfma_f32_16x16x32_bf16 v[16:19], a[0:3], v[160:163], v[16:19]
    buffer_load_dwordx4 v[216:219], v8, s[40:43], s58 offen offset:2048
    ds_read_b64_tr_b16 a[32:33], v6 offset:57344
    ds_read_b64_tr_b16 a[34:35], v6 offset:59392
    v_mfma_f32_16x16x32_bf16 v[20:23], a[4:7], v[160:163], v[20:23]
    ds_read_b64_tr_b16 a[36:37], v7 offset:57344
    ds_read_b64_tr_b16 a[38:39], v7 offset:59392
    v_mfma_f32_16x16x32_bf16 v[24:27], a[8:11], v[160:163], v[24:27]
    ds_read_b64_tr_b16 a[40:41], v10 offset:57344
    ds_read_b64_tr_b16 a[42:43], v10 offset:59392
    v_mfma_f32_16x16x32_bf16 v[28:31], a[12:15], v[160:163], v[28:31]
    ds_read_b64_tr_b16 a[44:45], v11 offset:57344
    ds_read_b64_tr_b16 a[46:47], v11 offset:59392
    s_waitcnt vmcnt(13)
    s_waitcnt lgkmcnt(8)
    v_mfma_f32_16x16x32_bf16 v[16:19], a[16:19], v[164:167], v[16:19]
    buffer_load_dwordx4 v[220:223], v8, s[40:43], s58 offen offset:3072
    ds_read_b64_tr_b16 a[0:1], v6 offset:61440
    ds_read_b64_tr_b16 a[2:3], v6 offset:63488
    v_mfma_f32_16x16x32_bf16 v[20:23], a[20:23], v[164:167], v[20:23]
    ds_read_b64_tr_b16 a[4:5], v7 offset:61440
    ds_read_b64_tr_b16 a[6:7], v7 offset:63488
    v_mfma_f32_16x16x32_bf16 v[24:27], a[24:27], v[164:167], v[24:27]
    ds_read_b64_tr_b16 a[8:9], v10 offset:61440
    ds_read_b64_tr_b16 a[10:11], v10 offset:63488
    v_mfma_f32_16x16x32_bf16 v[28:31], a[28:31], v[164:167], v[28:31]
    ds_read_b64_tr_b16 a[12:13], v11 offset:61440
    ds_read_b64_tr_b16 a[14:15], v11 offset:63488
    s_waitcnt vmcnt(13)
    s_waitcnt lgkmcnt(8)
    v_mfma_f32_16x16x32_bf16 v[16:19], a[32:35], v[168:171], v[16:19]
    s_add_u32 s58, s55, 40960
    buffer_load_dwordx4 v[224:227], v8, s[40:43], s58 offen offset:0
    ds_read_b64_tr_b16 a[16:17], v32 offset:0
    v_mfma_f32_16x16x32_bf16 v[20:23], a[36:39], v[168:171], v[20:23]
    ds_read_b64_tr_b16 a[18:19], v32 offset:2048
    ds_read_b64_tr_b16 a[20:21], v34 offset:0
    v_mfma_f32_16x16x32_bf16 v[24:27], a[40:43], v[168:171], v[24:27]
    ds_read_b64_tr_b16 a[22:23], v34 offset:2048
    ds_read_b64_tr_b16 a[24:25], v36 offset:0
    ds_read_b64_tr_b16 a[26:27], v36 offset:2048
    v_mfma_f32_16x16x32_bf16 v[28:31], a[44:47], v[168:171], v[28:31]
    ds_read_b64_tr_b16 a[28:29], v38 offset:0
    ds_read_b64_tr_b16 a[30:31], v38 offset:2048
    s_waitcnt vmcnt(13)
    s_waitcnt lgkmcnt(8)
    v_mfma_f32_16x16x32_bf16 v[16:19], a[0:3], v[172:175], v[16:19]
    buffer_load_dwordx4 v[228:231], v8, s[40:43], s58 offen offset:1024
    ds_read_b64_tr_b16 a[32:33], v32 offset:4096
    ds_read_b64_tr_b16 a[34:35], v32 offset:6144
    v_mfma_f32_16x16x32_bf16 v[20:23], a[4:7], v[172:175], v[20:23]
    ds_read_b64_tr_b16 a[36:37], v34 offset:4096
    ds_read_b64_tr_b16 a[38:39], v34 offset:6144
    v_mfma_f32_16x16x32_bf16 v[24:27], a[8:11], v[172:175], v[24:27]
    ds_read_b64_tr_b16 a[40:41], v36 offset:4096
    ds_read_b64_tr_b16 a[42:43], v36 offset:6144
    v_mfma_f32_16x16x32_bf16 v[28:31], a[12:15], v[172:175], v[28:31]
    ds_read_b64_tr_b16 a[44:45], v38 offset:4096
    ds_read_b64_tr_b16 a[46:47], v38 offset:6144
    s_waitcnt vmcnt(13)
    s_waitcnt lgkmcnt(8)
    v_mfma_f32_16x16x32_bf16 v[16:19], a[16:19], v[176:179], v[16:19]
    buffer_load_dwordx4 v[232:235], v8, s[40:43], s58 offen offset:2048
    ds_read_b64_tr_b16 a[0:1], v32 offset:8192
    ds_read_b64_tr_b16 a[2:3], v32 offset:10240
    v_mfma_f32_16x16x32_bf16 v[20:23], a[20:23], v[176:179], v[20:23]
    ds_read_b64_tr_b16 a[4:5], v34 offset:8192
    ds_read_b64_tr_b16 a[6:7], v34 offset:10240
    v_mfma_f32_16x16x32_bf16 v[24:27], a[24:27], v[176:179], v[24:27]
    ds_read_b64_tr_b16 a[8:9], v36 offset:8192
    ds_read_b64_tr_b16 a[10:11], v36 offset:10240
    v_mfma_f32_16x16x32_bf16 v[28:31], a[28:31], v[176:179], v[28:31]
    ds_read_b64_tr_b16 a[12:13], v38 offset:8192
    ds_read_b64_tr_b16 a[14:15], v38 offset:10240
    s_waitcnt vmcnt(13)
    s_waitcnt lgkmcnt(8)
    v_mfma_f32_16x16x32_bf16 v[16:19], a[32:35], v[180:183], v[16:19]
    ds_read_b64_tr_b16 a[16:17], v32 offset:12288
    ds_read_b64_tr_b16 a[18:19], v32 offset:14336
    v_mfma_f32_16x16x32_bf16 v[20:23], a[36:39], v[180:183], v[20:23]
    ds_read_b64_tr_b16 a[20:21], v34 offset:12288
    ds_read_b64_tr_b16 a[22:23], v34 offset:14336
    v_mfma_f32_16x16x32_bf16 v[24:27], a[40:43], v[180:183], v[24:27]
    ds_read_b64_tr_b16 a[24:25], v36 offset:12288
    ds_read_b64_tr_b16 a[26:27], v36 offset:14336
    v_mfma_f32_16x16x32_bf16 v[28:31], a[44:47], v[180:183], v[28:31]
    ds_read_b64_tr_b16 a[28:29], v38 offset:12288
    ds_read_b64_tr_b16 a[30:31], v38 offset:14336
    s_waitcnt vmcnt(12)
    s_waitcnt lgkmcnt(8)
    v_mfma_f32_16x16x32_bf16 v[16:19], a[0:3], v[184:187], v[16:19]
    ds_read_b64_tr_b16 a[32:33], v32 offset:16384
    ds_read_b64_tr_b16 a[34:35], v32 offset:18432
    v_mfma_f32_16x16x32_bf16 v[20:23], a[4:7], v[184:187], v[20:23]
    ds_read_b64_tr_b16 a[36:37], v34 offset:16384
    ds_read_b64_tr_b16 a[38:39], v34 offset:18432
    v_mfma_f32_16x16x32_bf16 v[24:27], a[8:11], v[184:187], v[24:27]
    ds_read_b64_tr_b16 a[40:41], v36 offset:16384
    ds_read_b64_tr_b16 a[42:43], v36 offset:18432
    v_mfma_f32_16x16x32_bf16 v[28:31], a[12:15], v[184:187], v[28:31]
    ds_read_b64_tr_b16 a[44:45], v38 offset:16384
    ds_read_b64_tr_b16 a[46:47], v38 offset:18432
    s_waitcnt vmcnt(11)
    s_waitcnt lgkmcnt(8)
    v_mfma_f32_16x16x32_bf16 v[16:19], a[16:19], v[188:191], v[16:19]
    ds_read_b64_tr_b16 a[0:1], v32 offset:20480
    ds_read_b64_tr_b16 a[2:3], v32 offset:22528
    v_mfma_f32_16x16x32_bf16 v[20:23], a[20:23], v[188:191], v[20:23]
    ds_read_b64_tr_b16 a[4:5], v34 offset:20480
    ds_read_b64_tr_b16 a[6:7], v34 offset:22528
    v_mfma_f32_16x16x32_bf16 v[24:27], a[24:27], v[188:191], v[24:27]
    ds_read_b64_tr_b16 a[8:9], v36 offset:20480
    ds_read_b64_tr_b16 a[10:11], v36 offset:22528
    v_mfma_f32_16x16x32_bf16 v[28:31], a[28:31], v[188:191], v[28:31]
    ds_read_b64_tr_b16 a[12:13], v38 offset:20480
    ds_read_b64_tr_b16 a[14:15], v38 offset:22528
    s_waitcnt vmcnt(10)
    s_waitcnt lgkmcnt(8)
    v_mfma_f32_16x16x32_bf16 v[16:19], a[32:35], v[192:195], v[16:19]
    ds_read_b64_tr_b16 a[16:17], v32 offset:24576
    ds_read_b64_tr_b16 a[18:19], v32 offset:26624
    v_mfma_f32_16x16x32_bf16 v[20:23], a[36:39], v[192:195], v[20:23]
    ds_read_b64_tr_b16 a[20:21], v34 offset:24576
    ds_read_b64_tr_b16 a[22:23], v34 offset:26624
    v_mfma_f32_16x16x32_bf16 v[24:27], a[40:43], v[192:195], v[24:27]
    ds_read_b64_tr_b16 a[24:25], v36 offset:24576
    ds_read_b64_tr_b16 a[26:27], v36 offset:26624
    v_mfma_f32_16x16x32_bf16 v[28:31], a[44:47], v[192:195], v[28:31]
    ds_read_b64_tr_b16 a[28:29], v38 offset:24576
    ds_read_b64_tr_b16 a[30:31], v38 offset:26624
    s_waitcnt vmcnt(9)
    s_waitcnt lgkmcnt(8)
    v_mfma_f32_16x16x32_bf16 v[16:19], a[0:3], v[196:199], v[16:19]
    ds_read_b64_tr_b16 a[32:33], v32 offset:28672
    ds_read_b64_tr_b16 a[34:35], v32 offset:30720
    v_mfma_f32_16x16x32_bf16 v[20:23], a[4:7], v[196:199], v[20:23]
    ds_read_b64_tr_b16 a[36:37], v34 offset:28672
    ds_read_b64_tr_b16 a[38:39], v34 offset:30720
    v_mfma_f32_16x16x32_bf16 v[24:27], a[8:11], v[196:199], v[24:27]
    ds_read_b64_tr_b16 a[40:41], v36 offset:28672
    ds_read_b64_tr_b16 a[42:43], v36 offset:30720
    v_mfma_f32_16x16x32_bf16 v[28:31], a[12:15], v[196:199], v[28:31]
    ds_read_b64_tr_b16 a[44:45], v38 offset:28672
    ds_read_b64_tr_b16 a[46:47], v38 offset:30720
    s_waitcnt vmcnt(8)
    s_waitcnt lgkmcnt(8)
    v_mfma_f32_16x16x32_bf16 v[16:19], a[16:19], v[200:203], v[16:19]
    ds_read_b64_tr_b16 a[0:1], v32 offset:32768
    ds_read_b64_tr_b16 a[2:3], v32 offset:34816
    v_mfma_f32_16x16x32_bf16 v[20:23], a[20:23], v[200:203], v[20:23]
    ds_read_b64_tr_b16 a[4:5], v34 offset:32768
    ds_read_b64_tr_b16 a[6:7], v34 offset:34816
    v_mfma_f32_16x16x32_bf16 v[24:27], a[24:27], v[200:203], v[24:27]
    ds_read_b64_tr_b16 a[8:9], v36 offset:32768
    ds_read_b64_tr_b16 a[10:11], v36 offset:34816
    v_mfma_f32_16x16x32_bf16 v[28:31], a[28:31], v[200:203], v[28:31]
    ds_read_b64_tr_b16 a[12:13], v38 offset:32768
    ds_read_b64_tr_b16 a[14:15], v38 offset:34816
    s_waitcnt vmcnt(7)
    s_waitcnt lgkmcnt(8)
    v_mfma_f32_16x16x32_bf16 v[16:19], a[32:35], v[204:207], v[16:19]
    ds_read_b64_tr_b16 a[16:17], v32 offset:36864
    ds_read_b64_tr_b16 a[18:19], v32 offset:38912
    v_mfma_f32_16x16x32_bf16 v[20:23], a[36:39], v[204:207], v[20:23]
    ds_read_b64_tr_b16 a[20:21], v34 offset:36864
    ds_read_b64_tr_b16 a[22:23], v34 offset:38912
    v_mfma_f32_16x16x32_bf16 v[24:27], a[40:43], v[204:207], v[24:27]
    ds_read_b64_tr_b16 a[24:25], v36 offset:36864
    ds_read_b64_tr_b16 a[26:27], v36 offset:38912
    v_mfma_f32_16x16x32_bf16 v[28:31], a[44:47], v[204:207], v[28:31]
    ds_read_b64_tr_b16 a[28:29], v38 offset:36864
    ds_read_b64_tr_b16 a[30:31], v38 offset:38912
    s_waitcnt vmcnt(24)
    s_barrier
    s_waitcnt vmcnt(6)
    s_waitcnt lgkmcnt(8)
    v_mfma_f32_16x16x32_bf16 v[16:19], a[0:3], v[208:211], v[16:19]
    ds_read_b64_tr_b16 a[32:33], v32 offset:40960
    ds_read_b64_tr_b16 a[34:35], v32 offset:43008
    v_mfma_f32_16x16x32_bf16 v[20:23], a[4:7], v[208:211], v[20:23]
    ds_read_b64_tr_b16 a[36:37], v34 offset:40960
    ds_read_b64_tr_b16 a[38:39], v34 offset:43008
    v_mfma_f32_16x16x32_bf16 v[24:27], a[8:11], v[208:211], v[24:27]
    ds_read_b64_tr_b16 a[40:41], v36 offset:40960
    ds_read_b64_tr_b16 a[42:43], v36 offset:43008
    v_mfma_f32_16x16x32_bf16 v[28:31], a[12:15], v[208:211], v[28:31]
    ds_read_b64_tr_b16 a[44:45], v38 offset:40960
    ds_read_b64_tr_b16 a[46:47], v38 offset:43008
    s_waitcnt vmcnt(5)
    s_waitcnt lgkmcnt(8)
    v_mfma_f32_16x16x32_bf16 v[16:19], a[16:19], v[212:215], v[16:19]
    ds_read_b64_tr_b16 a[0:1], v32 offset:45056
    ds_read_b64_tr_b16 a[2:3], v32 offset:47104
    v_mfma_f32_16x16x32_bf16 v[20:23], a[20:23], v[212:215], v[20:23]
    ds_read_b64_tr_b16 a[4:5], v34 offset:45056
    ds_read_b64_tr_b16 a[6:7], v34 offset:47104
    v_mfma_f32_16x16x32_bf16 v[24:27], a[24:27], v[212:215], v[24:27]
    ds_read_b64_tr_b16 a[8:9], v36 offset:45056
    ds_read_b64_tr_b16 a[10:11], v36 offset:47104
    v_mfma_f32_16x16x32_bf16 v[28:31], a[28:31], v[212:215], v[28:31]
    ds_read_b64_tr_b16 a[12:13], v38 offset:45056
    ds_read_b64_tr_b16 a[14:15], v38 offset:47104
    s_waitcnt vmcnt(4)
    s_waitcnt lgkmcnt(8)
    v_mfma_f32_16x16x32_bf16 v[16:19], a[32:35], v[216:219], v[16:19]
    ds_read_b64_tr_b16 a[16:17], v32 offset:49152
    ds_read_b64_tr_b16 a[18:19], v32 offset:51200
    v_mfma_f32_16x16x32_bf16 v[20:23], a[36:39], v[216:219], v[20:23]
    ds_read_b64_tr_b16 a[20:21], v34 offset:49152
    ds_read_b64_tr_b16 a[22:23], v34 offset:51200
    v_mfma_f32_16x16x32_bf16 v[24:27], a[40:43], v[216:219], v[24:27]
    ds_read_b64_tr_b16 a[24:25], v36 offset:49152
    ds_read_b64_tr_b16 a[26:27], v36 offset:51200
    v_mfma_f32_16x16x32_bf16 v[28:31], a[44:47], v[216:219], v[28:31]
    ds_read_b64_tr_b16 a[28:29], v38 offset:49152
    ds_read_b64_tr_b16 a[30:31], v38 offset:51200
    s_waitcnt vmcnt(3)
    s_waitcnt lgkmcnt(8)
    v_mfma_f32_16x16x32_bf16 v[16:19], a[0:3], v[220:223], v[16:19]
    ds_read_b64_tr_b16 a[32:33], v32 offset:53248
    ds_read_b64_tr_b16 a[34:35], v32 offset:55296
    v_mfma_f32_16x16x32_bf16 v[20:23], a[4:7], v[220:223], v[20:23]
    ds_read_b64_tr_b16 a[36:37], v34 offset:53248
    ds_read_b64_tr_b16 a[38:39], v34 offset:55296
    v_mfma_f32_16x16x32_bf16 v[24:27], a[8:11], v[220:223], v[24:27]
    ds_read_b64_tr_b16 a[40:41], v36 offset:53248
    ds_read_b64_tr_b16 a[42:43], v36 offset:55296
    v_mfma_f32_16x16x32_bf16 v[28:31], a[12:15], v[220:223], v[28:31]
    ds_read_b64_tr_b16 a[44:45], v38 offset:53248
    ds_read_b64_tr_b16 a[46:47], v38 offset:55296
    s_waitcnt vmcnt(2)
    s_waitcnt lgkmcnt(8)
    v_mfma_f32_16x16x32_bf16 v[16:19], a[16:19], v[224:227], v[16:19]
    ds_read_b64_tr_b16 a[0:1], v32 offset:57344
    ds_read_b64_tr_b16 a[2:3], v32 offset:59392
    v_mfma_f32_16x16x32_bf16 v[20:23], a[20:23], v[224:227], v[20:23]
    ds_read_b64_tr_b16 a[4:5], v34 offset:57344
    ds_read_b64_tr_b16 a[6:7], v34 offset:59392
    v_mfma_f32_16x16x32_bf16 v[24:27], a[24:27], v[224:227], v[24:27]
    ds_read_b64_tr_b16 a[8:9], v36 offset:57344
    ds_read_b64_tr_b16 a[10:11], v36 offset:59392
    v_mfma_f32_16x16x32_bf16 v[28:31], a[28:31], v[224:227], v[28:31]
    ds_read_b64_tr_b16 a[12:13], v38 offset:57344
    ds_read_b64_tr_b16 a[14:15], v38 offset:59392
    s_waitcnt vmcnt(1)
    s_waitcnt lgkmcnt(8)
    v_mfma_f32_16x16x32_bf16 v[16:19], a[32:35], v[228:231], v[16:19]
    v_mfma_f32_16x16x32_bf16 v[20:23], a[36:39], v[228:231], v[20:23]
    v_mfma_f32_16x16x32_bf16 v[24:27], a[40:43], v[228:231], v[24:27]
    v_mfma_f32_16x16x32_bf16 v[28:31], a[44:47], v[228:231], v[28:31]
    s_waitcnt vmcnt(0)
    s_waitcnt lgkmcnt(0)
    v_mfma_f32_16x16x32_bf16 v[16:19], a[0:3], v[232:235], v[16:19]
    v_mfma_f32_16x16x32_bf16 v[20:23], a[4:7], v[232:235], v[20:23]
    v_mfma_f32_16x16x32_bf16 v[24:27], a[8:11], v[232:235], v[24:27]
    v_mfma_f32_16x16x32_bf16 v[28:31], a[12:15], v[232:235], v[28:31]
    v_lshlrev_b32 v37, 4, v2
    v_add_u32 v37, 160000, v37
    s_lshl_b32 s56, s54, 10
    s_lshl_b32 s57, s7, 7
    s_add_u32 s56, s56, s57
    ds_read_b128 v[48:51], v37 offset:0
    ds_read_b128 v[52:55], v37 offset:64
    ds_read_b128 v[56:59], v37 offset:128
    ds_read_b128 v[60:63], v37 offset:192
    v_accvgpr_read_b32 v40, a248
    v_accvgpr_read_b32 v41, a249
    v_accvgpr_read_b32 v42, a250
    v_accvgpr_read_b32 v43, a251
    v_accvgpr_read_b32 v44, a252
    v_accvgpr_read_b32 v45, a253
    v_accvgpr_read_b32 v46, a254
    v_accvgpr_read_b32 v47, a255
    v_cvt_pk_bf16_f32 v16, v16, v17
    v_cvt_pk_bf16_f32 v18, v18, v19
    v_cvt_pk_bf16_f32 v20, v20, v21
    v_cvt_pk_bf16_f32 v22, v22, v23
    v_cvt_pk_bf16_f32 v24, v24, v25
    v_cvt_pk_bf16_f32 v26, v26, v27
    v_cvt_pk_bf16_f32 v28, v28, v29
    v_cvt_pk_bf16_f32 v30, v30, v31
    v_and_b32 v17, 0xffff0000, v16
    v_lshlrev_b32 v16, 16, v16
    v_and_b32 v19, 0xffff0000, v18
    v_lshlrev_b32 v18, 16, v18
    v_and_b32 v21, 0xffff0000, v20
    v_lshlrev_b32 v20, 16, v20
    v_and_b32 v23, 0xffff0000, v22
    v_lshlrev_b32 v22, 16, v22
    v_and_b32 v25, 0xffff0000, v24
    v_lshlrev_b32 v24, 16, v24
    v_and_b32 v27, 0xffff0000, v26
    v_lshlrev_b32 v26, 16, v26
    v_and_b32 v29, 0xffff0000, v28
    v_lshlrev_b32 v28, 16, v28
    v_and_b32 v31, 0xffff0000, v30
    v_lshlrev_b32 v30, 16, v30
    s_waitcnt lgkmcnt(0)
    v_mul_f32 v16, v16, v48
    v_mul_f32 v17, v17, v49
    v_mul_f32 v18, v18, v50
    v_mul_f32 v19, v19, v51
    v_mul_f32 v20, v20, v52
    v_mul_f32 v21, v21, v53
    v_mul_f32 v22, v22, v54
    v_mul_f32 v23, v23, v55
    v_mul_f32 v24, v24, v56
    v_mul_f32 v25, v25, v57
    v_mul_f32 v26, v26, v58
    v_mul_f32 v27, v27, v59
    v_mul_f32 v28, v28, v60
    v_mul_f32 v29, v29, v61
    v_mul_f32 v30, v30, v62
    v_mul_f32 v31, v31, v63
    v_cvt_pk_bf16_f32 v16, v16, v17
    v_cvt_pk_bf16_f32 v18, v18, v19
    v_cvt_pk_bf16_f32 v20, v20, v21
    v_cvt_pk_bf16_f32 v22, v22, v23
    v_cvt_pk_bf16_f32 v24, v24, v25
    v_cvt_pk_bf16_f32 v26, v26, v27
    v_cvt_pk_bf16_f32 v28, v28, v29
    v_cvt_pk_bf16_f32 v30, v30, v31
    v_and_b32 v17, 0xffff0000, v16
    v_lshlrev_b32 v16, 16, v16
    v_and_b32 v19, 0xffff0000, v18
    v_lshlrev_b32 v18, 16, v18
    v_and_b32 v21, 0xffff0000, v20
    v_lshlrev_b32 v20, 16, v20
    v_and_b32 v23, 0xffff0000, v22
    v_lshlrev_b32 v22, 16, v22
    v_and_b32 v25, 0xffff0000, v24
    v_lshlrev_b32 v24, 16, v24
    v_and_b32 v27, 0xffff0000, v26
    v_lshlrev_b32 v26, 16, v26
    v_and_b32 v29, 0xffff0000, v28
    v_lshlrev_b32 v28, 16, v28
    v_and_b32 v31, 0xffff0000, v30
    v_lshlrev_b32 v30, 16, v30
    v_lshlrev_b32 v64, 16, v40
    v_and_b32 v65, 0xffff0000, v40
    v_lshlrev_b32 v66, 16, v41
    v_and_b32 v67, 0xffff0000, v41
    v_lshlrev_b32 v68, 16, v42
    v_and_b32 v69, 0xffff0000, v42
    v_lshlrev_b32 v70, 16, v43
    v_and_b32 v71, 0xffff0000, v43
    v_lshlrev_b32 v72, 16, v44
    v_and_b32 v73, 0xffff0000, v44
    v_lshlrev_b32 v74, 16, v45
    v_and_b32 v75, 0xffff0000, v45
    v_lshlrev_b32 v76, 16, v46
    v_and_b32 v77, 0xffff0000, v46
    v_lshlrev_b32 v78, 16, v47
    v_and_b32 v79, 0xffff0000, v47
    v_add_f32 v64, v64, v16
    v_add_f32 v65, v65, v17
    v_add_f32 v66, v66, v18
    v_add_f32 v67, v67, v19
    v_add_f32 v68, v68, v20
    v_add_f32 v69, v69, v21
    v_add_f32 v70, v70, v22
    v_add_f32 v71, v71, v23
    v_add_f32 v72, v72, v24
    v_add_f32 v73, v73, v25
    v_add_f32 v74, v74, v26
    v_add_f32 v75, v75, v27
    v_add_f32 v76, v76, v28
    v_add_f32 v77, v77, v29
    v_add_f32 v78, v78, v30
    v_add_f32 v79, v79, v31
    v_cvt_pk_bf16_f32 v80, v64, v65
    v_cvt_pk_bf16_f32 v81, v66, v67
    v_cvt_pk_bf16_f32 v82, v68, v69
    v_cvt_pk_bf16_f32 v83, v70, v71
    v_cvt_pk_bf16_f32 v84, v72, v73
    v_cvt_pk_bf16_f32 v85, v74, v75
    v_cvt_pk_bf16_f32 v86, v76, v77
    v_cvt_pk_bf16_f32 v87, v78, v79
    v_and_b32 v92, 1, v2
    v_lshrrev_b32 v93, 1, v2
    v_lshlrev_b32 v94, 10, v5
    v_lshl_add_u32 v94, v92, 5, v94
    v_lshl_add_u32 v94, v93, 4, v94
    v_permlane16_swap_b32 v80, v82
    v_permlane16_swap_b32 v81, v83
    v_permlane16_swap_b32 v84, v86
    v_permlane16_swap_b32 v85, v87
    s_nop 0
    buffer_store_dwordx4 v[80:83], v94, s[12:15], s56 offen sc1
    buffer_store_dwordx4 v[84:87], v94, s[12:15], s56 offen offset:64 sc1
MK_END:
    s_endpgm
.section .rodata,"a"
.p2align 6
.amdhsa_kernel mk_kernel
  .amdhsa_next_free_vgpr 512
  .amdhsa_next_free_sgpr 102
  .amdhsa_accum_offset 256
  .amdhsa_group_segment_fixed_size 0
  .amdhsa_kernarg_size 104
  .amdhsa_user_sgpr_count 2
  .amdhsa_user_sgpr_kernarg_segment_ptr 1
  .amdhsa_system_sgpr_workgroup_id_x 1
.end_amdhsa_kernel
```
